```python
import torch

def _softmax(x, axis=-1):
    return torch.softmax(x, dim=axis)
def _gelu(x):
    return torch.nn.functional.gelu(x, approximate="tanh")
def _silu(x):
    return torch.nn.functional.silu(x)
def _sigmoid(x):
    return torch.sigmoid(x)
def _layernorm(x, axis=-1, eps=1e-5):
    m = x.mean(dim=axis, keepdim=True)
    v = x.var(dim=axis, keepdim=True, unbiased=False)
    return (x - m) / torch.sqrt(v + eps)
def _scatter_add(tgt, idx, src, axis=0):
    return tgt.clone().index_add_(axis, idx, src)
def _segment_sum(src, seg, n):
    out = torch.zeros((n,) + src.shape[1:], dtype=src.dtype)
    return out.index_add_(0, seg, src)
def _pad(x, pw):
    flat = tuple(v for pair in reversed(pw) for v in pair)
    return torch.nn.functional.pad(x, flat)

kernel_name = 'concat_heads__linear_kernel_hedgehog__compressed_kv_cla__prompt'

def setup_inputs():

    _w = (lambda a: (lambda t: t.to(torch.bfloat16) if t.is_floating_point() else t)(torch.as_tensor(a)))
    def _A_setup():
        B, S, D, H = 1, 2048, 640, 32
        Dh = D // H
        return {
            "x": _w((lambda *s: torch.randn(*s, dtype=torch.bfloat16) * 0.4)(B, S, D)),
            "wqkv": _w((lambda *s: torch.randn(*s, dtype=torch.bfloat16) * 0.4)(D, 3 * D)),
            "w_phi": _w((lambda *s: torch.randn(*s, dtype=torch.bfloat16) * 0.4)(H, Dh, Dh) * (Dh ** -0.5)),
            "wo": _w((lambda *s: torch.randn(*s, dtype=torch.bfloat16) * 0.05)(D, D)),
        }
    _A_in = _A_setup()

    def _B_setup():
        B, H, Sq, Sk, D, M = 1, 32, 2048, 2048, 128, 640
        Dc = 4 * D
        return {
            "x": _w((lambda *s: torch.randn(*s, dtype=torch.bfloat16) * 0.8)(B, Sq, M)),
            "c_kv": _w((lambda *s: torch.randn(*s, dtype=torch.bfloat16) * 0.4)(B, Sk, Dc)),
            "w_q": _w((lambda *s: torch.randn(*s, dtype=torch.bfloat16) * 6.4)(M, H, D) * (M ** -0.5)),
            "w_uk": _w((lambda *s: torch.randn(*s, dtype=torch.bfloat16) * 6.4)(Dc, H, D) * (Dc ** -0.5)),
            "w_uv": _w((lambda *s: torch.randn(*s, dtype=torch.bfloat16) * 0.4)(Dc, H, D) * (Dc ** -0.5)),
            "w_o": _w((lambda *s: torch.randn(*s, dtype=torch.bfloat16) * 0.4)(H, D, M) * ((H * D) ** -0.5)),
        }
    _B_in = _B_setup()

    return {
        "A_x": _A_in["x"],
        "A_wqkv": _A_in["wqkv"],
        "A_w_phi": _A_in["w_phi"],
        "A_wo": _A_in["wo"],
        "B_x": _B_in["x"],
        "B_c_kv": _B_in["c_kv"],
        "B_w_q": _B_in["w_q"],
        "B_w_uk": _B_in["w_uk"],
        "B_w_uv": _B_in["w_uv"],
        "B_w_o": _B_in["w_o"],
    }

def reference(A_x, A_wqkv, A_w_phi, A_wo, B_x, B_c_kv, B_w_q, B_w_uk, B_w_uv, B_w_o):
    def _A_ref(x, wqkv, w_phi, wo):
        B, S, D = x.shape
        H = 32; Dh = D // H
        qkv = (lambda x, *d: x.permute(*d))((x @ wqkv).reshape(B, S, 3, H, Dh), 2, 0, 3, 1, 4)
        q, k, v = qkv[0], qkv[1], qkv[2]
        pq = torch.einsum("bhsd,hdf->bhsf", q, w_phi)
        pk = torch.einsum("bhsd,hdf->bhsf", k, w_phi)
        phi_q = torch.concatenate([_softmax(pq, axis=-1), _softmax(-pq, axis=-1)], axis=-1)
        phi_k = torch.concatenate([_softmax(pk, axis=-1), _softmax(-pk, axis=-1)], axis=-1)
        kv = torch.einsum("bhsf,bhsd->bhfd", phi_k, v)
        z  = torch.einsum("bhsf->bhf", phi_k)
        num = torch.einsum("bhqf,bhfd->bhqd", phi_q, kv)
        den = torch.einsum("bhqf,bhf->bhq", phi_q, z)[..., None] + 1e-6
        o = num / den
        return (lambda x, *d: x.permute(*d))(o, 0, 2, 1, 3).reshape(B, S, D) @ wo

    def _B_ref(x, c_kv, w_q, w_uk, w_uv, w_o):
        B, Sq, M = x.shape[0], x.shape[1], x.shape[2]
        Sk = c_kv.shape[1]
        H, D = w_q.shape[1], w_q.shape[2]
        q = torch.einsum("bqm,mhd->bhqd", x, w_q)
        k = torch.einsum("bkc,chd->bhkd", c_kv, w_uk)
        v = torch.einsum("bkc,chd->bhkd", c_kv, w_uv)
        scores = torch.einsum("bhqd,bhkd->bhqk", q, k) * (D ** -0.5)
        off = Sk - Sq
        qi = torch.arange(Sq)[:, None]
        kj = torch.arange(Sk)[None, :]
        cmask = kj <= (qi + off)
        scores = torch.where(cmask[None, None], scores, -1e9)
        p = _softmax(scores, axis=-1)
        ctx = torch.einsum("bhqk,bhkd->bhqd", p, v)
        return torch.einsum("bhqd,hdm->bqm", ctx, w_o)

    a = _A_ref(A_x, A_wqkv, A_w_phi, A_wo)
    b = _B_ref(B_x, B_c_kv, B_w_q, B_w_uk, B_w_uv, B_w_o)
    return torch.concatenate([a, b], axis=-1)
```

```asm
; @launch kernel=k1_kernel grid=(256,1,1) block=(512,1,1) lds=163840
.amdgcn_target "amdgcn-amd-amdhsa--gfx950"
.text
.globl k1_kernel
.p2align 8
.type k1_kernel,@function
k1_kernel:
  s_cmp_ge_u32 s2, 256
  s_cbranch_scc1 K1_END
  s_mov_b32 s89, s2
K1_AGAIN:
  s_load_dwordx16 s[8:23], s[0:1], 0
  s_load_dwordx8 s[24:31], s[0:1], 64
  s_load_dwordx2 s[32:33], s[0:1], 96
  s_getpc_b64 s[96:97]
K1_PC:
  v_lshlrev_b32 v6, 7, v0
  s_add_u32 s96, s96, k1_kernel-K1_PC
  s_addc_u32 s97, s97, -1
  v_min_u32 v6, K3_END-k1_kernel-4, v6
  global_load_dword v4, v6, s[96:97]
  v_lshrrev_b32 v2, 6, v0
  v_and_b32 v1, 63, v0
  v_readfirstlane_b32 s3, v2
  s_and_b32 s64, s2, 7
  s_bfe_u32 s4, s2, 0x30003
  s_bfe_u32 s67, s2, 0x10006
  s_lshl1_add_u32 s5, s64, s67
  s_lshr_b32 s6, s2, 7
  s_lshl3_add_u32 s64, s4, s3
  s_lshl_b32 s64, s64, 5
  v_lshrrev_b32 v96, 3, v1
  v_add_u32 v96, s64, v96
  v_mul_u32_u24 v96, 1024, v96
  v_and_b32 v97, 7, v1
  v_lshrrev_b32 v98, 4, v1
  v_xor_b32 v97, v97, v98
  v_lshl_add_u32 v16, v97, 4, v96
  v_xor_b32 v17, 64, v16
  v_add_u32 v17, 7168, v17
  v_lshrrev_b32 v96, 5, v1
  s_lshl_b32 s64, s3, 2
  v_add_u32 v104, s64, v96
  v_and_b32 v98, 31, v1
  v_lshlrev_b32 v99, 1, v96
  s_and_b32 s64, s64, 8
  v_xor_b32 v102, v98, v99
  v_xor_b32 v102, s64, v102
  v_xor_b32 v103, 4, v102
  s_lshl_b32 s64, s5, 9
  v_lshl_add_u32 v100, v104, 13, s64
  v_lshl_add_u32 v18, v102, 4, v100
  v_lshl_add_u32 v19, v103, 4, v100
  v_add_u32 v19, 15360, v19
  s_lshl_b32 s86, s3, 11
  s_lshl1_add_u32 s88, s86, 65536
  s_mov_b32 s60, s88
  s_mov_b32 s84, 16384
  s_mov_b32 s87, -16256
  s_mov_b32 s56, 0
  s_mov_b32 s57, 0
  s_mov_b32 s58, 262144
  s_mov_b32 s42, 4194304
  s_mov_b32 s43, 0x00020000
  s_waitcnt lgkmcnt(0)
  s_cmp_eq_u32 s6, 0
  s_mov_b32 s44, s18
  s_mov_b32 s45, s19
  s_mov_b32 s46, 2097152
  s_mov_b32 s47, 0x00020000
  s_cselect_b32 s40, s22, s24
  s_cselect_b32 s41, s23, s25
  s_mov_b32 m0, s60
  s_add_u32 s60, s60, 2048
  buffer_load_dwordx4 v16, s[44:47], s56 offen lds
  buffer_load_dwordx4 v17, s[44:47], s56 offen offset:1024 lds
  s_add_u32 s56, s56, s84
  s_mov_b32 m0, s60
  s_add_u32 s60, s60, 30720
  buffer_load_dwordx4 v16, s[44:47], s56 offen lds
  buffer_load_dwordx4 v17, s[44:47], s56 offen offset:1024 lds
  s_add_u32 s56, s56, s87
  s_cmp_ge_u32 s60, 163840
  s_cselect_b32 s60, s88, s60
  s_mov_b32 m0, s86
  s_add_u32 s86, s86, 16384
  buffer_load_dwordx4 v18, s[40:43], s57 offen nt lds
  buffer_load_dwordx4 v19, s[40:43], s57 offen offset:1024 nt lds
  s_and_b32 s86, s86, 0xffff
  s_add_u32 s57, s57, s58
  s_mov_b32 m0, s86
  s_add_u32 s86, s86, 16384
  buffer_load_dwordx4 v18, s[40:43], s57 offen nt lds
  buffer_load_dwordx4 v19, s[40:43], s57 offen offset:1024 nt lds
  s_and_b32 s86, s86, 0xffff
  s_add_u32 s57, s57, s58
  s_mov_b32 m0, s60
  s_add_u32 s60, s60, 2048
  buffer_load_dwordx4 v16, s[44:47], s56 offen lds
  buffer_load_dwordx4 v17, s[44:47], s56 offen offset:1024 lds
  s_add_u32 s56, s56, s84
  s_and_b32 s64, s3, 1
  s_lshl_b32 s81, s64, 7
  s_and_b32 s82, s3, 6
  s_lshl_b32 s82, s82, 1
  s_lshl_b32 s64, s81, 7
  s_add_u32 s64, s64, 65536
  v_and_b32 v96, 15, v1
  v_lshrrev_b32 v99, 4, v1
  v_bfe_u32 v98, v1, 1, 3
  v_xor_b32 v98, v98, v99
  v_lshlrev_b32 v98, 4, v98
  v_lshl_add_u32 v101, v96, 7, v98
  v_add_u32 v8, s64, v101
  v_xor_b32 v15, 64, v8
  v_bfe_u32 v96, v1, 2, 2
  v_lshl_add_u32 v102, v99, 3, v96
  v_and_b32 v103, 3, v1
  v_lshlrev_b32 v103, 3, v103
  v_lshl_add_u32 v97, v102, 9, v103
  v_bfe_u32 v98, v1, 2, 3
  v_xor_b32 v100, s82, v98
  v_lshl_add_u32 v9, v100, 5, v97
  v_xor_b32 v10, 32, v9
  v_xor_b32 v11, 64, v9
  v_xor_b32 v12, 96, v9
  v_add_u32 v13, 65536, v8
  v_add_u32 v14, 65536, v15
  s_mov_b32 m0, s86
  s_add_u32 s86, s86, 16384
  buffer_load_dwordx4 v18, s[40:43], s57 offen nt lds
  buffer_load_dwordx4 v19, s[40:43], s57 offen offset:1024 nt lds
  s_and_b32 s86, s86, 0xffff
  s_add_u32 s57, s57, s58
  s_mov_b32 m0, s60
  s_add_u32 s60, s60, 30720
  buffer_load_dwordx4 v16, s[44:47], s56 offen lds
  buffer_load_dwordx4 v17, s[44:47], s56 offen offset:1024 lds
  s_add_u32 s56, s56, s87
  s_cmp_ge_u32 s60, 163840
  s_cselect_b32 s60, s88, s60
  s_mov_b32 m0, s86
  s_add_u32 s86, s86, 16384
  buffer_load_dwordx4 v18, s[40:43], s57 offen nt lds
  buffer_load_dwordx4 v19, s[40:43], s57 offen offset:1024 nt lds
  s_and_b32 s86, s86, 0xffff
  s_add_u32 s57, s57, s58
  s_mov_b32 m0, s60
  s_add_u32 s60, s60, 2048
  buffer_load_dwordx4 v16, s[44:47], s56 offen lds
  buffer_load_dwordx4 v17, s[44:47], s56 offen offset:1024 lds
  s_add_u32 s56, s56, s84
  s_and_b32 s64, s3, 3
  s_lshl_b32 s64, s64, 13
  s_add_u32 s64, s64, 65536
  v_add_u32 v120, s64, v101
  v_xor_b32 v121, 64, v120
  v_add_u32 v122, 65536, v120
  v_add_u32 v123, 65536, v121
  v_lshl_add_u32 v97, v102, 8, v103
  s_and_b32 s64, s3, 4
  v_xor_b32 v98, s64, v98
  v_lshl_add_u32 v124, v98, 5, v97
  v_xor_b32 v125, 32, v124
  v_xor_b32 v126, 64, v124
  v_xor_b32 v127, 96, v124
  s_mov_b32 s36, s32
  s_mov_b32 s37, s33
  s_mov_b32 s38, 268435456
  s_mov_b32 s39, 0x00020000
  s_lshr_b32 s64, s3, 2
  s_lshl1_add_u32 s64, s5, s64
  s_lshl_b32 s48, s64, 19
  s_lshl_b32 s64, s4, 16
  s_add_u32 s48, s48, s64
  s_lshl_b32 s65, s81, 8
  s_add_u32 s48, s48, s65
  s_bfe_u32 s64, s3, 0x10001
  s_add_u32 s65, s6, 11
  s_lshl_b32 s64, s64, s65
  s_add_u32 s48, s48, s64
  s_lshr_b32 s34, 4096, s6
  s_lshl_b32 s35, s6, 12
  s_lshl_b32 s64, s6, 24
  s_add_u32 s48, s48, s64
  s_add_u32 s48, s48, 16777216
  s_mov_b32 s99, 0x00020000
  s_mov_b32 s96, s14
  s_mov_b32 s97, s15
  s_mov_b32 s98, 819200
  s_mov_b32 s101, 100352
  s_mov_b32 s64, 242
  s_cmp_lt_u32 s2, 242
  s_cselect_b32 s96, s26, s96
  s_cselect_b32 s97, s27, s97
  s_cselect_b32 s98, 5242880, s98
  s_cselect_b32 s101, 573440, s101
  s_cselect_b32 s64, 162, s64
  s_cmp_lt_u32 s2, 162
  s_cselect_b32 s96, s20, s96
  s_cselect_b32 s97, s21, s97
  s_cselect_b32 s98, 5242880, s98
  s_cselect_b32 s101, 645120, s101
  s_cselect_b32 s64, 72, s64
  s_cmp_lt_u32 s2, 72
  s_cselect_b32 s96, s8, s96
  s_cselect_b32 s97, s9, s97
  s_cselect_b32 s98, 2621440, s98
  s_cselect_b32 s101, 516096, s101
  s_cselect_b32 s64, 0, s64
  v_mov_b32 v5, 2146435072
  s_lshl3_add_u32 s65, s2, s3
  s_lshl_b32 s65, s65, 10
  v_lshlrev_b32 v3, 7, v1
  v_cmp_gt_u32 vcc, 8, v1
  s_nop 1
  v_cndmask_b32 v6, v5, v3, vcc
  s_sub_u32 s64, s2, s64
  s_lshl3_add_u32 s64, s64, s3
  s_mul_i32 s64, s64, 7
  buffer_load_dword v4, v6, s[44:47], s65 offen
  v_add_lshl_u32 v6, s64, v1, 7
  v_cmp_gt_u32 vcc, 7, v1
  s_nop 1
  v_cndmask_b32 v6, v5, v6, vcc
  s_mov_b32 s100, 0
  s_and_b32 s64, s2, 1
  s_bfe_u32 s83, s2, 0x30003
  s_lshl3_add_u32 s83, s64, s83
  s_bfe_u32 s64, s2, 0x20001
  s_lshr_b32 s80, s2, 6
  s_lshl2_add_u32 s80, s64, s80
  s_lshl3_add_u32 s64, s83, s3
  s_lshl_b32 s64, s64, 4
  v_lshrrev_b32 v96, 3, v1
  v_add_u32 v96, s64, v96
  v_mul_u32_u24 v96, 1280, v96
  v_and_b32 v97, 7, v1
  v_lshrrev_b32 v98, 4, v1
  v_xor_b32 v97, v97, v98
  v_lshl_add_u32 v20, v97, 4, v96
  v_xor_b32 v21, 64, v20
  v_add_u32 v21, 9216, v21
  v_lshlrev_b32 v2, 4, v1
  s_mul_i32 s64, s80, 1600
  s_add_u32 s52, s12, s64
  s_addc_u32 s53, s13, 0
  s_movk_i32 s54, 1600
  s_mov_b32 s55, 0x00020000
  buffer_load_dword v4, v3, s[52:55], 0 offen
  v_lshrrev_b32 v96, 4, v1
  v_and_b32 v97, 15, v1
  v_mul_u32_u24 v84, 1280, v97
  v_lshl_add_u32 v84, v96, 4, v84
  v_lshlrev_b32 v98, 1, v96
  v_xor_b32 v97, v97, v98
  v_mul_u32_u24 v96, 3840, v96
  v_lshl_add_u32 v96, v97, 4, v96
  v_mov_b32 v85, v5
  v_add_u32 v98, 2400, v96
  v_cmp_gt_u32 vcc, 15, v97
  s_nop 1
  v_cndmask_b32 v85, v85, v98, vcc
  v_add_u32 v98, 1152, v96
  v_cmp_gt_u32 vcc, 13, v97
  s_nop 1
  v_cndmask_b32 v85, v85, v98, vcc
  v_add_u32 v98, 2480, v96
  v_cmp_gt_u32 vcc, 8, v97
  s_nop 1
  v_cndmask_b32 v85, v85, v98, vcc
  v_add_u32 v98, 0, v96
  v_cmp_gt_u32 vcc, 5, v97
  s_nop 1
  v_cndmask_b32 v85, v85, v98, vcc
  s_mov_b32 s68, s16
  s_mov_b32 s69, s17
  s_mov_b32 s70, 2621440
  s_mov_b32 s71, 0x00020000
  s_mov_b32 s72, s10
  s_mov_b32 s73, s11
  s_mov_b32 s74, 2457600
  s_mov_b32 s75, 0x00020000
  s_and_b32 s65, s3, 1
  s_or_b32 s65, s65, 8
  s_and_b32 s64, s80, 3
  s_mul_i32 s64, s64, 10
  s_add_u32 s64, s64, s65
  s_lshr_b32 s61, s80, 2
  s_lshl2_add_u32 s61, s83, s61
  s_mul_i32 s61, s61, 40960
  s_and_b32 s59, s64, 1
  s_mul_i32 s59, s59, 20448
  s_add_u32 s59, s59, s61
  s_lshl_b32 s64, s64, 5
  s_add_u32 s59, s59, s64
  s_lshl_b32 s64, s64, 5
  s_add_u32 s61, s61, s64
  s_mul_i32 s64, s83, 10
  s_add_u32 s64, s64, s65
  s_mul_i32 s62, s64, 15360
  s_mul_i32 s63, s80, 80
  s_add_u32 s62, s62, s63
  s_lshl1_add_u32 s63, s63, s64
  s_lshl_b32 s63, s63, 10
  s_add_u32 s63, s63, 88080384
  s_lshl_b32 s64, s64, 6
  s_and_b32 s64, s64, 128
  v_xor_b32 v88, s64, v2
  s_cmp_lt_u32 s3, 2
  s_cselect_b32 s81, s59, s62
  s_cselect_b32 s82, s61, s63
  s_cselect_b32 s76, s68, s72
  s_cselect_b32 s77, s69, s73
  s_cselect_b32 s78, s70, s74
  s_cselect_b64 vcc, -1, 0
  s_mov_b32 s79, 0x00020000
  v_cndmask_b32 v86, v85, v84, vcc
  v_cndmask_b32 v88, v88, v2, vcc
  s_and_b32 s64, s80, 3
  s_mul_i32 s64, s64, 10
  s_add_u32 s64, s64, s3
  s_lshr_b32 s61, s80, 2
  s_lshl2_add_u32 s61, s83, s61
  s_mul_i32 s61, s61, 40960
  s_and_b32 s59, s64, 1
  s_mul_i32 s59, s59, 20448
  s_add_u32 s59, s59, s61
  s_lshl_b32 s64, s64, 5
  s_add_u32 s59, s59, s64
  s_lshl_b32 s64, s64, 5
  s_add_u32 s61, s61, s64
  s_mul_i32 s64, s83, 10
  s_add_u32 s64, s64, s3
  s_mul_i32 s62, s64, 15360
  s_mul_i32 s63, s80, 80
  s_add_u32 s62, s62, s63
  s_lshl1_add_u32 s63, s63, s64
  s_lshl_b32 s63, s63, 10
  s_add_u32 s63, s63, 88080384
  s_lshl_b32 s64, s64, 6
  s_and_b32 s64, s64, 128
  v_xor_b32 v87, s64, v2
  s_mov_b32 s28, s30
  s_mov_b32 s29, s31
  s_movk_i32 s30, 256
  s_mov_b32 s31, 0x00020000
  s_lshl4_add_u32 s16, s80, s83
  v_mov_b32 v91, 1
  v_mov_b32 v90, 0
  s_lshl_b32 s17, s16, 8
  s_add_u32 s17, s17, 93323264
  s_and_b32 s64, s89, 524288
  s_or_b32 s64, s64, s3
  s_cselect_b32 s17, 0, s17
  s_lshr_b32 s64, s2, 5
  s_xor_b32 s65, s64, 15
  s_lshl_b32 s66, s80, 4
  v_and_b32 v96, 15, v1
  v_add_u32 v89, s66, v96
  v_lshl_add_u32 v97, v96, 4, s64
  v_cmp_gt_u32 vcc, 32, v1
  s_nop 1
  v_cndmask_b32 v89, v89, v97, vcc
  v_lshl_add_u32 v97, v96, 4, s65
  v_cmp_gt_u32 vcc, 16, v1
  s_nop 1
  v_cndmask_b32 v89, v89, v97, vcc
  v_lshlrev_b32 v93, 8, v89
  v_add_u32 v93, 93323264, v93
  s_cmp_lg_u32 s17, 0
  s_cbranch_scc0 K1_CLR
  s_mov_b64 exec, 1
  buffer_store_dword v90, off, s[36:39], s17 sc1
  s_mov_b64 exec, -1
K1_CLR:
  s_waitcnt vmcnt(14)
  s_barrier
  ds_read_b128 v[24:27], v8 offset:0
  ds_read_b64_tr_b16 v[40:41], v9 offset:0
  ds_read_b64_tr_b16 v[42:43], v9 offset:2048
  ds_read_b64_tr_b16 v[44:45], v10 offset:0
  ds_read_b64_tr_b16 v[46:47], v10 offset:2048
  ds_read_b64_tr_b16 v[48:49], v11 offset:0
  ds_read_b64_tr_b16 v[50:51], v11 offset:2048
  ds_read_b64_tr_b16 v[52:53], v12 offset:0
  ds_read_b64_tr_b16 v[54:55], v12 offset:2048
  ds_read_b128 v[28:31], v8 offset:2048
  s_cmp_eq_u32 s6, 0
  s_cbranch_scc0 K1_LOOPV
K1_LOOPK:
  s_waitcnt lgkmcnt(7)
  v_mfma_f32_16x16x32_bf16 v[128:131], v[40:43], v[24:27], 0
  ds_read_b128 v[32:35], v8 offset:4096
  s_waitcnt lgkmcnt(6)
  v_mfma_f32_16x16x32_bf16 v[132:135], v[44:47], v[24:27], 0
  ds_read_b128 v[36:39], v8 offset:6144
  s_waitcnt lgkmcnt(5)
  v_mfma_f32_16x16x32_bf16 v[136:139], v[48:51], v[24:27], 0
  s_waitcnt lgkmcnt(3)
  v_mfma_f32_16x16x32_bf16 v[140:143], v[52:55], v[24:27], 0
  s_waitcnt lgkmcnt(2)
  v_mfma_f32_16x16x32_bf16 v[144:147], v[40:43], v[28:31], 0
  ds_read_b128 v[24:27], v8 offset:8192
  v_mfma_f32_16x16x32_bf16 v[148:151], v[44:47], v[28:31], 0
  v_mfma_f32_16x16x32_bf16 v[152:155], v[48:51], v[28:31], 0
  v_mfma_f32_16x16x32_bf16 v[156:159], v[52:55], v[28:31], 0
  s_waitcnt lgkmcnt(2)
  v_mfma_f32_16x16x32_bf16 v[160:163], v[40:43], v[32:35], 0
  ds_read_b128 v[28:31], v8 offset:10240
  v_mfma_f32_16x16x32_bf16 v[164:167], v[44:47], v[32:35], 0
  v_mfma_f32_16x16x32_bf16 v[168:171], v[48:51], v[32:35], 0
  v_mfma_f32_16x16x32_bf16 v[172:175], v[52:55], v[32:35], 0
  s_waitcnt lgkmcnt(2)
  v_mfma_f32_16x16x32_bf16 v[176:179], v[40:43], v[36:39], 0
  ds_read_b128 v[32:35], v8 offset:12288
  v_mfma_f32_16x16x32_bf16 v[180:183], v[44:47], v[36:39], 0
  v_mfma_f32_16x16x32_bf16 v[184:187], v[48:51], v[36:39], 0
  v_mfma_f32_16x16x32_bf16 v[188:191], v[52:55], v[36:39], 0
  s_waitcnt lgkmcnt(2)
  v_mfma_f32_16x16x32_bf16 v[192:195], v[40:43], v[24:27], 0
  ds_read_b128 v[36:39], v8 offset:14336
  v_mfma_f32_16x16x32_bf16 v[196:199], v[44:47], v[24:27], 0
  v_mfma_f32_16x16x32_bf16 v[200:203], v[48:51], v[24:27], 0
  v_mfma_f32_16x16x32_bf16 v[204:207], v[52:55], v[24:27], 0
  s_waitcnt lgkmcnt(2)
  v_mfma_f32_16x16x32_bf16 v[208:211], v[40:43], v[28:31], 0
  v_mfma_f32_16x16x32_bf16 v[212:215], v[44:47], v[28:31], 0
  v_mfma_f32_16x16x32_bf16 v[216:219], v[48:51], v[28:31], 0
  v_mfma_f32_16x16x32_bf16 v[220:223], v[52:55], v[28:31], 0
  s_waitcnt vmcnt(12) lgkmcnt(0)
  s_barrier
  v_mfma_f32_16x16x32_bf16 v[224:227], v[40:43], v[32:35], 0
  ds_read_b128 v[24:27], v15 offset:0
  ds_read_b64_tr_b16 v[56:57], v9 offset:16384
  s_mov_b32 m0, s86
  s_add_u32 s86, s86, 16384
  buffer_load_dwordx4 v18, s[40:43], s57 offen nt lds
  v_mfma_f32_16x16x32_bf16 v[228:231], v[44:47], v[32:35], 0
  ds_read_b64_tr_b16 v[58:59], v9 offset:18432
  ds_read_b64_tr_b16 v[60:61], v10 offset:16384
  buffer_load_dwordx4 v19, s[40:43], s57 offen offset:1024 nt lds
  s_and_b32 s86, s86, 0xffff
  s_add_u32 s57, s57, s58
  v_mfma_f32_16x16x32_bf16 v[232:235], v[48:51], v[32:35], 0
  ds_read_b64_tr_b16 v[62:63], v10 offset:18432
  v_mfma_f32_16x16x32_bf16 v[236:239], v[52:55], v[32:35], 0
  ds_read_b128 v[28:31], v15 offset:2048
  ds_read_b64_tr_b16 v[64:65], v11 offset:16384
  s_mov_b32 m0, s60
  s_add_u32 s60, s60, 30720
  buffer_load_dwordx4 v16, s[44:47], s56 offen lds
  v_mfma_f32_16x16x32_bf16 v[240:243], v[40:43], v[36:39], 0
  ds_read_b64_tr_b16 v[66:67], v11 offset:18432
  ds_read_b64_tr_b16 v[68:69], v12 offset:16384
  buffer_load_dwordx4 v17, s[44:47], s56 offen offset:1024 lds
  s_add_u32 s56, s56, s87
  s_cmp_ge_u32 s60, 163840
  s_cselect_b32 s60, s88, s60
  v_mfma_f32_16x16x32_bf16 v[244:247], v[44:47], v[36:39], 0
  ds_read_b64_tr_b16 v[70:71], v12 offset:18432
  v_mfma_f32_16x16x32_bf16 v[248:251], v[48:51], v[36:39], 0
  v_mfma_f32_16x16x32_bf16 v[252:255], v[52:55], v[36:39], 0
  s_waitcnt lgkmcnt(7)
  v_mfma_f32_16x16x32_bf16 v[128:131], v[56:59], v[24:27], v[128:131]
  ds_read_b128 v[32:35], v15 offset:4096
  s_waitcnt lgkmcnt(6)
  v_mfma_f32_16x16x32_bf16 v[132:135], v[60:63], v[24:27], v[132:135]
  ds_read_b128 v[36:39], v15 offset:6144
  s_waitcnt lgkmcnt(4)
  v_mfma_f32_16x16x32_bf16 v[136:139], v[64:67], v[24:27], v[136:139]
  s_waitcnt lgkmcnt(2)
  v_mfma_f32_16x16x32_bf16 v[140:143], v[68:71], v[24:27], v[140:143]
  v_mfma_f32_16x16x32_bf16 v[144:147], v[56:59], v[28:31], v[144:147]
  ds_read_b128 v[24:27], v15 offset:8192
  v_mfma_f32_16x16x32_bf16 v[148:151], v[60:63], v[28:31], v[148:151]
  v_mfma_f32_16x16x32_bf16 v[152:155], v[64:67], v[28:31], v[152:155]
  buffer_load_dwordx4 v[72:75], v84, s[68:71], s59 offen
  v_mfma_f32_16x16x32_bf16 v[156:159], v[68:71], v[28:31], v[156:159]
  s_waitcnt lgkmcnt(2)
  v_mfma_f32_16x16x32_bf16 v[160:163], v[56:59], v[32:35], v[160:163]
  ds_read_b128 v[28:31], v15 offset:10240
  v_mfma_f32_16x16x32_bf16 v[164:167], v[60:63], v[32:35], v[164:167]
  v_mfma_f32_16x16x32_bf16 v[168:171], v[64:67], v[32:35], v[168:171]
  v_mfma_f32_16x16x32_bf16 v[172:175], v[68:71], v[32:35], v[172:175]
  buffer_load_dwordx4 v[76:79], v85, s[72:75], s62 offen
  s_waitcnt lgkmcnt(2)
  v_mfma_f32_16x16x32_bf16 v[176:179], v[56:59], v[36:39], v[176:179]
  ds_read_b128 v[32:35], v15 offset:12288
  v_mfma_f32_16x16x32_bf16 v[180:183], v[60:63], v[36:39], v[180:183]
  v_mfma_f32_16x16x32_bf16 v[184:187], v[64:67], v[36:39], v[184:187]
  v_mfma_f32_16x16x32_bf16 v[188:191], v[68:71], v[36:39], v[188:191]
  s_waitcnt lgkmcnt(2)
  v_mfma_f32_16x16x32_bf16 v[192:195], v[56:59], v[24:27], v[192:195]
  ds_read_b128 v[36:39], v15 offset:14336
  v_mfma_f32_16x16x32_bf16 v[196:199], v[60:63], v[24:27], v[196:199]
  v_mfma_f32_16x16x32_bf16 v[200:203], v[64:67], v[24:27], v[200:203]
  v_mfma_f32_16x16x32_bf16 v[204:207], v[68:71], v[24:27], v[204:207]
  s_waitcnt lgkmcnt(2)
  v_mfma_f32_16x16x32_bf16 v[208:211], v[56:59], v[28:31], v[208:211]
  v_mfma_f32_16x16x32_bf16 v[212:215], v[60:63], v[28:31], v[212:215]
  v_mfma_f32_16x16x32_bf16 v[216:219], v[64:67], v[28:31], v[216:219]
  v_mfma_f32_16x16x32_bf16 v[220:223], v[68:71], v[28:31], v[220:223]
  s_waitcnt vmcnt(12) lgkmcnt(0)
  s_barrier
  v_mfma_f32_16x16x32_bf16 v[224:227], v[56:59], v[32:35], v[224:227]
  ds_read_b128 v[24:27], v8 offset:32768
  ds_read_b64_tr_b16 v[40:41], v9 offset:32768
  s_mov_b32 m0, s86
  s_add_u32 s86, s86, 16384
  buffer_load_dwordx4 v18, s[40:43], s57 offen nt lds
  v_mfma_f32_16x16x32_bf16 v[228:231], v[60:63], v[32:35], v[228:231]
  ds_read_b64_tr_b16 v[42:43], v9 offset:34816
  ds_read_b64_tr_b16 v[44:45], v10 offset:32768
  buffer_load_dwordx4 v19, s[40:43], s57 offen offset:1024 nt lds
  s_and_b32 s86, s86, 0xffff
  s_add_u32 s57, s57, s58
  v_mfma_f32_16x16x32_bf16 v[232:235], v[64:67], v[32:35], v[232:235]
  ds_read_b64_tr_b16 v[46:47], v10 offset:34816
  v_mfma_f32_16x16x32_bf16 v[236:239], v[68:71], v[32:35], v[236:239]
  ds_read_b128 v[28:31], v8 offset:34816
  ds_read_b64_tr_b16 v[48:49], v11 offset:32768
  s_mov_b32 m0, s60
  s_add_u32 s60, s60, 2048
  buffer_load_dwordx4 v16, s[44:47], s56 offen lds
  v_mfma_f32_16x16x32_bf16 v[240:243], v[56:59], v[36:39], v[240:243]
  ds_read_b64_tr_b16 v[50:51], v11 offset:34816
  ds_read_b64_tr_b16 v[52:53], v12 offset:32768
  buffer_load_dwordx4 v17, s[44:47], s56 offen offset:1024 lds
  s_add_u32 s56, s56, s84
  v_mfma_f32_16x16x32_bf16 v[244:247], v[60:63], v[36:39], v[244:247]
  ds_read_b64_tr_b16 v[54:55], v12 offset:34816
  v_mfma_f32_16x16x32_bf16 v[248:251], v[64:67], v[36:39], v[248:251]
  v_mfma_f32_16x16x32_bf16 v[252:255], v[68:71], v[36:39], v[252:255]
  s_waitcnt lgkmcnt(7)
  v_mfma_f32_16x16x32_bf16 v[128:131], v[40:43], v[24:27], v[128:131]
  ds_read_b128 v[32:35], v8 offset:36864
  s_waitcnt lgkmcnt(6)
  v_mfma_f32_16x16x32_bf16 v[132:135], v[44:47], v[24:27], v[132:135]
  ds_read_b128 v[36:39], v8 offset:38912
  s_waitcnt lgkmcnt(4)
  v_mfma_f32_16x16x32_bf16 v[136:139], v[48:51], v[24:27], v[136:139]
  s_waitcnt lgkmcnt(2)
  v_mfma_f32_16x16x32_bf16 v[140:143], v[52:55], v[24:27], v[140:143]
  v_mfma_f32_16x16x32_bf16 v[144:147], v[40:43], v[28:31], v[144:147]
  ds_read_b128 v[24:27], v8 offset:40960
  v_mfma_f32_16x16x32_bf16 v[148:151], v[44:47], v[28:31], v[148:151]
  v_mfma_f32_16x16x32_bf16 v[152:155], v[48:51], v[28:31], v[152:155]
  s_cmp_lt_u32 s3, 4
  s_cbranch_scc0 K1_LOOPK_e3
  buffer_load_dwordx4 v[80:83], v86, s[76:79], s81 offen
K1_LOOPK_e3:
  v_mfma_f32_16x16x32_bf16 v[156:159], v[52:55], v[28:31], v[156:159]
  s_waitcnt lgkmcnt(2)
  v_mfma_f32_16x16x32_bf16 v[160:163], v[40:43], v[32:35], v[160:163]
  ds_read_b128 v[28:31], v8 offset:43008
  v_mfma_f32_16x16x32_bf16 v[164:167], v[44:47], v[32:35], v[164:167]
  v_mfma_f32_16x16x32_bf16 v[168:171], v[48:51], v[32:35], v[168:171]
  v_mfma_f32_16x16x32_bf16 v[172:175], v[52:55], v[32:35], v[172:175]
  s_waitcnt lgkmcnt(2)
  v_mfma_f32_16x16x32_bf16 v[176:179], v[40:43], v[36:39], v[176:179]
  ds_read_b128 v[32:35], v8 offset:45056
  v_mfma_f32_16x16x32_bf16 v[180:183], v[44:47], v[36:39], v[180:183]
  v_mfma_f32_16x16x32_bf16 v[184:187], v[48:51], v[36:39], v[184:187]
  v_mfma_f32_16x16x32_bf16 v[188:191], v[52:55], v[36:39], v[188:191]
  s_waitcnt lgkmcnt(2)
  v_mfma_f32_16x16x32_bf16 v[192:195], v[40:43], v[24:27], v[192:195]
  ds_read_b128 v[36:39], v8 offset:47104
  v_mfma_f32_16x16x32_bf16 v[196:199], v[44:47], v[24:27], v[196:199]
  v_mfma_f32_16x16x32_bf16 v[200:203], v[48:51], v[24:27], v[200:203]
  v_mfma_f32_16x16x32_bf16 v[204:207], v[52:55], v[24:27], v[204:207]
  s_waitcnt lgkmcnt(2)
  v_mfma_f32_16x16x32_bf16 v[208:211], v[40:43], v[28:31], v[208:211]
  v_mfma_f32_16x16x32_bf16 v[212:215], v[44:47], v[28:31], v[212:215]
  v_mfma_f32_16x16x32_bf16 v[216:219], v[48:51], v[28:31], v[216:219]
  v_mfma_f32_16x16x32_bf16 v[220:223], v[52:55], v[28:31], v[220:223]
  s_waitcnt vmcnt(14) lgkmcnt(0)
  s_barrier
  v_mfma_f32_16x16x32_bf16 v[224:227], v[40:43], v[32:35], v[224:227]
  ds_read_b128 v[24:27], v15 offset:32768
  ds_read_b64_tr_b16 v[56:57], v9 offset:49152
  s_mov_b32 m0, s86
  s_add_u32 s86, s86, 16384
  buffer_load_dwordx4 v18, s[40:43], s57 offen nt lds
  v_mfma_f32_16x16x32_bf16 v[228:231], v[44:47], v[32:35], v[228:231]
  ds_read_b64_tr_b16 v[58:59], v9 offset:51200
  ds_read_b64_tr_b16 v[60:61], v10 offset:49152
  buffer_load_dwordx4 v19, s[40:43], s57 offen offset:1024 nt lds
  s_and_b32 s86, s86, 0xffff
  s_add_u32 s57, s57, s58
  v_mfma_f32_16x16x32_bf16 v[232:235], v[48:51], v[32:35], v[232:235]
  ds_read_b64_tr_b16 v[62:63], v10 offset:51200
  v_mfma_f32_16x16x32_bf16 v[236:239], v[52:55], v[32:35], v[236:239]
  ds_read_b128 v[28:31], v15 offset:34816
  ds_read_b64_tr_b16 v[64:65], v11 offset:49152
  s_mov_b32 m0, s60
  s_add_u32 s60, s60, 30720
  buffer_load_dwordx4 v16, s[44:47], s56 offen lds
  v_mfma_f32_16x16x32_bf16 v[240:243], v[40:43], v[36:39], v[240:243]
  ds_read_b64_tr_b16 v[66:67], v11 offset:51200
  ds_read_b64_tr_b16 v[68:69], v12 offset:49152
  buffer_load_dwordx4 v17, s[44:47], s56 offen offset:1024 lds
  s_add_u32 s56, s56, s87
  s_cmp_ge_u32 s60, 163840
  s_cselect_b32 s60, s88, s60
  v_mfma_f32_16x16x32_bf16 v[244:247], v[44:47], v[36:39], v[244:247]
  ds_read_b64_tr_b16 v[70:71], v12 offset:51200
  v_mfma_f32_16x16x32_bf16 v[248:251], v[48:51], v[36:39], v[248:251]
  buffer_load_dword v4, v6, s[96:99], s100 offen
  s_add_u32 s100, s100, s101
  v_mfma_f32_16x16x32_bf16 v[252:255], v[52:55], v[36:39], v[252:255]
  s_waitcnt lgkmcnt(7)
  v_mfma_f32_16x16x32_bf16 v[128:131], v[56:59], v[24:27], v[128:131]
  ds_read_b128 v[32:35], v15 offset:36864
  s_waitcnt lgkmcnt(6)
  v_mfma_f32_16x16x32_bf16 v[132:135], v[60:63], v[24:27], v[132:135]
  ds_read_b128 v[36:39], v15 offset:38912
  s_waitcnt lgkmcnt(4)
  v_mfma_f32_16x16x32_bf16 v[136:139], v[64:67], v[24:27], v[136:139]
  s_waitcnt lgkmcnt(2)
  v_mfma_f32_16x16x32_bf16 v[140:143], v[68:71], v[24:27], v[140:143]
  v_mfma_f32_16x16x32_bf16 v[144:147], v[56:59], v[28:31], v[144:147]
  ds_read_b128 v[24:27], v15 offset:40960
  v_mfma_f32_16x16x32_bf16 v[148:151], v[60:63], v[28:31], v[148:151]
  v_mfma_f32_16x16x32_bf16 v[152:155], v[64:67], v[28:31], v[152:155]
  v_mfma_f32_16x16x32_bf16 v[156:159], v[68:71], v[28:31], v[156:159]
  s_waitcnt lgkmcnt(2)
  v_mfma_f32_16x16x32_bf16 v[160:163], v[56:59], v[32:35], v[160:163]
  ds_read_b128 v[28:31], v15 offset:43008
  v_mfma_f32_16x16x32_bf16 v[164:167], v[60:63], v[32:35], v[164:167]
  v_mfma_f32_16x16x32_bf16 v[168:171], v[64:67], v[32:35], v[168:171]
  v_mfma_f32_16x16x32_bf16 v[172:175], v[68:71], v[32:35], v[172:175]
  s_waitcnt lgkmcnt(2)
  v_mfma_f32_16x16x32_bf16 v[176:179], v[56:59], v[36:39], v[176:179]
  ds_read_b128 v[32:35], v15 offset:45056
  v_mfma_f32_16x16x32_bf16 v[180:183], v[60:63], v[36:39], v[180:183]
  v_mfma_f32_16x16x32_bf16 v[184:187], v[64:67], v[36:39], v[184:187]
  v_mfma_f32_16x16x32_bf16 v[188:191], v[68:71], v[36:39], v[188:191]
  s_waitcnt lgkmcnt(2)
  v_mfma_f32_16x16x32_bf16 v[192:195], v[56:59], v[24:27], v[192:195]
  ds_read_b128 v[36:39], v15 offset:47104
  v_mfma_f32_16x16x32_bf16 v[196:199], v[60:63], v[24:27], v[196:199]
  v_mfma_f32_16x16x32_bf16 v[200:203], v[64:67], v[24:27], v[200:203]
  v_mfma_f32_16x16x32_bf16 v[204:207], v[68:71], v[24:27], v[204:207]
  s_waitcnt lgkmcnt(2)
  v_mfma_f32_16x16x32_bf16 v[208:211], v[56:59], v[28:31], v[208:211]
  v_mfma_f32_16x16x32_bf16 v[212:215], v[60:63], v[28:31], v[212:215]
  v_mfma_f32_16x16x32_bf16 v[216:219], v[64:67], v[28:31], v[216:219]
  v_mfma_f32_16x16x32_bf16 v[220:223], v[68:71], v[28:31], v[220:223]
  s_waitcnt vmcnt(11) lgkmcnt(0)
  s_barrier
  v_mfma_f32_16x16x32_bf16 v[224:227], v[56:59], v[32:35], v[224:227]
  ds_read_b128 v[24:27], v13 offset:0
  ds_read_b64_tr_b16 v[40:41], v9 offset:0
  s_mov_b32 m0, s86
  s_add_u32 s86, s86, 16384
  buffer_load_dwordx4 v18, s[40:43], s57 offen nt lds
  v_mfma_f32_16x16x32_bf16 v[228:231], v[60:63], v[32:35], v[228:231]
  ds_read_b64_tr_b16 v[42:43], v9 offset:2048
  ds_read_b64_tr_b16 v[44:45], v10 offset:0
  buffer_load_dwordx4 v19, s[40:43], s57 offen offset:1024 nt lds
  s_and_b32 s86, s86, 0xffff
  s_add_u32 s57, s57, s58
  v_mfma_f32_16x16x32_bf16 v[232:235], v[64:67], v[32:35], v[232:235]
  ds_read_b64_tr_b16 v[46:47], v10 offset:2048
  v_mfma_f32_16x16x32_bf16 v[236:239], v[68:71], v[32:35], v[236:239]
  ds_read_b128 v[28:31], v13 offset:2048
  ds_read_b64_tr_b16 v[48:49], v11 offset:0
  s_mov_b32 m0, s60
  s_add_u32 s60, s60, 2048
  buffer_load_dwordx4 v16, s[44:47], s56 offen lds
  v_mfma_f32_16x16x32_bf16 v[240:243], v[56:59], v[36:39], v[240:243]
  ds_read_b64_tr_b16 v[50:51], v11 offset:2048
  ds_read_b64_tr_b16 v[52:53], v12 offset:0
  buffer_load_dwordx4 v17, s[44:47], s56 offen offset:1024 lds
  s_add_u32 s56, s56, s84
  v_mfma_f32_16x16x32_bf16 v[244:247], v[60:63], v[36:39], v[244:247]
  ds_read_b64_tr_b16 v[54:55], v12 offset:2048
  v_mfma_f32_16x16x32_bf16 v[248:251], v[64:67], v[36:39], v[248:251]
  buffer_load_dword v4, v6, s[96:99], s100 offen
  s_add_u32 s100, s100, s101
  v_mfma_f32_16x16x32_bf16 v[252:255], v[68:71], v[36:39], v[252:255]
  s_waitcnt lgkmcnt(7)
  v_mfma_f32_16x16x32_bf16 v[128:131], v[40:43], v[24:27], v[128:131]
  ds_read_b128 v[32:35], v13 offset:4096
  s_waitcnt lgkmcnt(6)
  v_mfma_f32_16x16x32_bf16 v[132:135], v[44:47], v[24:27], v[132:135]
  ds_read_b128 v[36:39], v13 offset:6144
  s_waitcnt lgkmcnt(4)
  v_mfma_f32_16x16x32_bf16 v[136:139], v[48:51], v[24:27], v[136:139]
  s_waitcnt lgkmcnt(2)
  v_mfma_f32_16x16x32_bf16 v[140:143], v[52:55], v[24:27], v[140:143]
  v_mfma_f32_16x16x32_bf16 v[144:147], v[40:43], v[28:31], v[144:147]
  ds_read_b128 v[24:27], v13 offset:8192
  v_mfma_f32_16x16x32_bf16 v[148:151], v[44:47], v[28:31], v[148:151]
  v_mfma_f32_16x16x32_bf16 v[152:155], v[48:51], v[28:31], v[152:155]
  s_cmp_lg_u32 s17, 0
  s_cbranch_scc0 K1_LOOPK_EI
  s_mov_b64 exec, 1
  buffer_store_byte v91, off, s[28:31], s16 sc1
  s_mov_b64 exec, -1
K1_LOOPK_EI:
  v_mfma_f32_16x16x32_bf16 v[156:159], v[52:55], v[28:31], v[156:159]
  s_waitcnt lgkmcnt(2)
  v_mfma_f32_16x16x32_bf16 v[160:163], v[40:43], v[32:35], v[160:163]
  ds_read_b128 v[28:31], v13 offset:10240
  v_mfma_f32_16x16x32_bf16 v[164:167], v[44:47], v[32:35], v[164:167]
  v_mfma_f32_16x16x32_bf16 v[168:171], v[48:51], v[32:35], v[168:171]
  v_mfma_f32_16x16x32_bf16 v[172:175], v[52:55], v[32:35], v[172:175]
  s_waitcnt vmcnt(15)
  buffer_store_dwordx4 v[72:75], v2, s[36:39], s61 offen sc1
  s_waitcnt lgkmcnt(2)
  v_mfma_f32_16x16x32_bf16 v[176:179], v[40:43], v[36:39], v[176:179]
  ds_read_b128 v[32:35], v13 offset:12288
  v_mfma_f32_16x16x32_bf16 v[180:183], v[44:47], v[36:39], v[180:183]
  v_mfma_f32_16x16x32_bf16 v[184:187], v[48:51], v[36:39], v[184:187]
  v_mfma_f32_16x16x32_bf16 v[188:191], v[52:55], v[36:39], v[188:191]
  s_waitcnt lgkmcnt(2)
  v_mfma_f32_16x16x32_bf16 v[192:195], v[40:43], v[24:27], v[192:195]
  ds_read_b128 v[36:39], v13 offset:14336
  s_waitcnt vmcnt(15)
  buffer_store_dwordx4 v[76:79], v87, s[36:39], s63 offen sc1
  v_mfma_f32_16x16x32_bf16 v[196:199], v[44:47], v[24:27], v[196:199]
  v_mfma_f32_16x16x32_bf16 v[200:203], v[48:51], v[24:27], v[200:203]
  v_mfma_f32_16x16x32_bf16 v[204:207], v[52:55], v[24:27], v[204:207]
  s_waitcnt lgkmcnt(2)
  v_mfma_f32_16x16x32_bf16 v[208:211], v[40:43], v[28:31], v[208:211]
  v_mfma_f32_16x16x32_bf16 v[212:215], v[44:47], v[28:31], v[212:215]
  v_mfma_f32_16x16x32_bf16 v[216:219], v[48:51], v[28:31], v[216:219]
  v_mfma_f32_16x16x32_bf16 v[220:223], v[52:55], v[28:31], v[220:223]
  s_waitcnt vmcnt(14) lgkmcnt(0)
  s_barrier
  v_mfma_f32_16x16x32_bf16 v[224:227], v[40:43], v[32:35], v[224:227]
  ds_read_b128 v[24:27], v14 offset:0
  ds_read_b64_tr_b16 v[56:57], v9 offset:16384
  s_mov_b32 m0, s86
  s_add_u32 s86, s86, 16384
  buffer_load_dwordx4 v18, s[40:43], s57 offen nt lds
  v_mfma_f32_16x16x32_bf16 v[228:231], v[44:47], v[32:35], v[228:231]
  ds_read_b64_tr_b16 v[58:59], v9 offset:18432
  ds_read_b64_tr_b16 v[60:61], v10 offset:16384
  buffer_load_dwordx4 v19, s[40:43], s57 offen offset:1024 nt lds
  s_and_b32 s86, s86, 0xffff
  s_add_u32 s57, s57, s58
  v_mfma_f32_16x16x32_bf16 v[232:235], v[48:51], v[32:35], v[232:235]
  ds_read_b64_tr_b16 v[62:63], v10 offset:18432
  v_mfma_f32_16x16x32_bf16 v[236:239], v[52:55], v[32:35], v[236:239]
  ds_read_b128 v[28:31], v14 offset:2048
  ds_read_b64_tr_b16 v[64:65], v11 offset:16384
  s_mov_b32 m0, s60
  s_add_u32 s60, s60, 30720
  buffer_load_dwordx4 v16, s[44:47], s56 offen lds
  v_mfma_f32_16x16x32_bf16 v[240:243], v[40:43], v[36:39], v[240:243]
  ds_read_b64_tr_b16 v[66:67], v11 offset:18432
  ds_read_b64_tr_b16 v[68:69], v12 offset:16384
  buffer_load_dwordx4 v17, s[44:47], s56 offen offset:1024 lds
  s_add_u32 s56, s56, s87
  s_cmp_ge_u32 s60, 163840
  s_cselect_b32 s60, s88, s60
  v_mfma_f32_16x16x32_bf16 v[244:247], v[44:47], v[36:39], v[244:247]
  ds_read_b64_tr_b16 v[70:71], v12 offset:18432
  v_mfma_f32_16x16x32_bf16 v[248:251], v[48:51], v[36:39], v[248:251]
  buffer_load_dword v4, v6, s[96:99], s100 offen
  s_add_u32 s100, s100, s101
  v_mfma_f32_16x16x32_bf16 v[252:255], v[52:55], v[36:39], v[252:255]
  s_waitcnt lgkmcnt(7)
  v_mfma_f32_16x16x32_bf16 v[128:131], v[56:59], v[24:27], v[128:131]
  ds_read_b128 v[32:35], v14 offset:4096
  s_waitcnt lgkmcnt(6)
  v_mfma_f32_16x16x32_bf16 v[132:135], v[60:63], v[24:27], v[132:135]
  ds_read_b128 v[36:39], v14 offset:6144
  s_waitcnt lgkmcnt(4)
  v_mfma_f32_16x16x32_bf16 v[136:139], v[64:67], v[24:27], v[136:139]
  s_waitcnt lgkmcnt(2)
  v_mfma_f32_16x16x32_bf16 v[140:143], v[68:71], v[24:27], v[140:143]
  v_mfma_f32_16x16x32_bf16 v[144:147], v[56:59], v[28:31], v[144:147]
  ds_read_b128 v[24:27], v14 offset:8192
  v_mfma_f32_16x16x32_bf16 v[148:151], v[60:63], v[28:31], v[148:151]
  v_mfma_f32_16x16x32_bf16 v[152:155], v[64:67], v[28:31], v[152:155]
  s_cmp_lt_u32 s3, 4
  s_cbranch_scc0 K1_LOOPK_E3
  s_waitcnt vmcnt(17)
  buffer_store_dwordx4 v[80:83], v88, s[36:39], s82 offen sc1
K1_LOOPK_E3:
  v_mfma_f32_16x16x32_bf16 v[156:159], v[68:71], v[28:31], v[156:159]
  s_waitcnt lgkmcnt(2)
  v_mfma_f32_16x16x32_bf16 v[160:163], v[56:59], v[32:35], v[160:163]
  ds_read_b128 v[28:31], v14 offset:10240
  v_mfma_f32_16x16x32_bf16 v[164:167], v[60:63], v[32:35], v[164:167]
  v_mfma_f32_16x16x32_bf16 v[168:171], v[64:67], v[32:35], v[168:171]
  v_mfma_f32_16x16x32_bf16 v[172:175], v[68:71], v[32:35], v[172:175]
  s_waitcnt lgkmcnt(2)
  v_mfma_f32_16x16x32_bf16 v[176:179], v[56:59], v[36:39], v[176:179]
  ds_read_b128 v[32:35], v14 offset:12288
  v_mfma_f32_16x16x32_bf16 v[180:183], v[60:63], v[36:39], v[180:183]
  v_mfma_f32_16x16x32_bf16 v[184:187], v[64:67], v[36:39], v[184:187]
  v_mfma_f32_16x16x32_bf16 v[188:191], v[68:71], v[36:39], v[188:191]
  s_waitcnt lgkmcnt(2)
  v_mfma_f32_16x16x32_bf16 v[192:195], v[56:59], v[24:27], v[192:195]
  ds_read_b128 v[36:39], v14 offset:14336
  v_mfma_f32_16x16x32_bf16 v[196:199], v[60:63], v[24:27], v[196:199]
  v_mfma_f32_16x16x32_bf16 v[200:203], v[64:67], v[24:27], v[200:203]
  v_mfma_f32_16x16x32_bf16 v[204:207], v[68:71], v[24:27], v[204:207]
  s_waitcnt lgkmcnt(2)
  v_mfma_f32_16x16x32_bf16 v[208:211], v[56:59], v[28:31], v[208:211]
  v_mfma_f32_16x16x32_bf16 v[212:215], v[60:63], v[28:31], v[212:215]
  v_mfma_f32_16x16x32_bf16 v[216:219], v[64:67], v[28:31], v[216:219]
  v_mfma_f32_16x16x32_bf16 v[220:223], v[68:71], v[28:31], v[220:223]
  s_waitcnt vmcnt(13) lgkmcnt(0)
  s_barrier
  v_mfma_f32_16x16x32_bf16 v[224:227], v[56:59], v[32:35], v[224:227]
  ds_read_b128 v[24:27], v8 offset:0
  ds_read_b64_tr_b16 v[40:41], v9 offset:32768
  s_mov_b32 m0, s86
  s_add_u32 s86, s86, 16384
  buffer_load_dwordx4 v18, s[40:43], s57 offen nt lds
  v_mfma_f32_16x16x32_bf16 v[228:231], v[60:63], v[32:35], v[228:231]
  ds_read_b64_tr_b16 v[42:43], v9 offset:34816
  ds_read_b64_tr_b16 v[44:45], v10 offset:32768
  buffer_load_dwordx4 v19, s[40:43], s57 offen offset:1024 nt lds
  s_and_b32 s86, s86, 0xffff
  s_add_u32 s57, s57, s58
  v_mfma_f32_16x16x32_bf16 v[232:235], v[64:67], v[32:35], v[232:235]
  ds_read_b64_tr_b16 v[46:47], v10 offset:34816
  v_mfma_f32_16x16x32_bf16 v[236:239], v[68:71], v[32:35], v[236:239]
  ds_read_b128 v[28:31], v8 offset:2048
  ds_read_b64_tr_b16 v[48:49], v11 offset:32768
  s_mov_b32 m0, s60
  s_add_u32 s60, s60, 2048
  buffer_load_dwordx4 v16, s[44:47], s56 offen lds
  v_mfma_f32_16x16x32_bf16 v[240:243], v[56:59], v[36:39], v[240:243]
  ds_read_b64_tr_b16 v[50:51], v11 offset:34816
  ds_read_b64_tr_b16 v[52:53], v12 offset:32768
  buffer_load_dwordx4 v17, s[44:47], s56 offen offset:1024 lds
  s_add_u32 s56, s56, s84
  v_mfma_f32_16x16x32_bf16 v[244:247], v[60:63], v[36:39], v[244:247]
  ds_read_b64_tr_b16 v[54:55], v12 offset:34816
  v_mfma_f32_16x16x32_bf16 v[248:251], v[64:67], v[36:39], v[248:251]
  buffer_load_dword v4, v6, s[96:99], s100 offen
  s_add_u32 s100, s100, s101
  v_mfma_f32_16x16x32_bf16 v[252:255], v[68:71], v[36:39], v[252:255]
  s_waitcnt lgkmcnt(7)
  v_mfma_f32_16x16x32_bf16 v[128:131], v[40:43], v[24:27], v[128:131]
  ds_read_b128 v[32:35], v8 offset:4096
  s_waitcnt lgkmcnt(6)
  v_mfma_f32_16x16x32_bf16 v[132:135], v[44:47], v[24:27], v[132:135]
  ds_read_b128 v[36:39], v8 offset:6144
  s_waitcnt lgkmcnt(4)
  v_mfma_f32_16x16x32_bf16 v[136:139], v[48:51], v[24:27], v[136:139]
  s_waitcnt lgkmcnt(2)
  v_mfma_f32_16x16x32_bf16 v[140:143], v[52:55], v[24:27], v[140:143]
  v_mfma_f32_16x16x32_bf16 v[144:147], v[40:43], v[28:31], v[144:147]
  ds_read_b128 v[24:27], v8 offset:8192
  v_mfma_f32_16x16x32_bf16 v[148:151], v[44:47], v[28:31], v[148:151]
  v_mfma_f32_16x16x32_bf16 v[152:155], v[48:51], v[28:31], v[152:155]
  v_mfma_f32_16x16x32_bf16 v[156:159], v[52:55], v[28:31], v[156:159]
  s_waitcnt lgkmcnt(2)
  v_mfma_f32_16x16x32_bf16 v[160:163], v[40:43], v[32:35], v[160:163]
  ds_read_b128 v[28:31], v8 offset:10240
  v_mfma_f32_16x16x32_bf16 v[164:167], v[44:47], v[32:35], v[164:167]
  v_mfma_f32_16x16x32_bf16 v[168:171], v[48:51], v[32:35], v[168:171]
  v_mfma_f32_16x16x32_bf16 v[172:175], v[52:55], v[32:35], v[172:175]
  s_waitcnt lgkmcnt(2)
  v_mfma_f32_16x16x32_bf16 v[176:179], v[40:43], v[36:39], v[176:179]
  ds_read_b128 v[32:35], v8 offset:12288
  v_mfma_f32_16x16x32_bf16 v[180:183], v[44:47], v[36:39], v[180:183]
  v_mfma_f32_16x16x32_bf16 v[184:187], v[48:51], v[36:39], v[184:187]
  v_mfma_f32_16x16x32_bf16 v[188:191], v[52:55], v[36:39], v[188:191]
  s_waitcnt lgkmcnt(2)
  v_mfma_f32_16x16x32_bf16 v[192:195], v[40:43], v[24:27], v[192:195]
  ds_read_b128 v[36:39], v8 offset:14336
  v_mfma_f32_16x16x32_bf16 v[196:199], v[44:47], v[24:27], v[196:199]
  v_mfma_f32_16x16x32_bf16 v[200:203], v[48:51], v[24:27], v[200:203]
  v_mfma_f32_16x16x32_bf16 v[204:207], v[52:55], v[24:27], v[204:207]
  s_waitcnt lgkmcnt(2)
  v_mfma_f32_16x16x32_bf16 v[208:211], v[40:43], v[28:31], v[208:211]
  v_mfma_f32_16x16x32_bf16 v[212:215], v[44:47], v[28:31], v[212:215]
  v_mfma_f32_16x16x32_bf16 v[216:219], v[48:51], v[28:31], v[216:219]
  v_mfma_f32_16x16x32_bf16 v[220:223], v[52:55], v[28:31], v[220:223]
  s_waitcnt vmcnt(15) lgkmcnt(0)
  s_barrier
  v_mfma_f32_16x16x32_bf16 v[224:227], v[40:43], v[32:35], v[224:227]
  ds_read_b128 v[24:27], v15 offset:0
  ds_read_b64_tr_b16 v[56:57], v9 offset:49152
  s_mov_b32 m0, s86
  s_add_u32 s86, s86, 16384
  buffer_load_dwordx4 v18, s[40:43], s57 offen nt lds
  v_mfma_f32_16x16x32_bf16 v[228:231], v[44:47], v[32:35], v[228:231]
  ds_read_b64_tr_b16 v[58:59], v9 offset:51200
  ds_read_b64_tr_b16 v[60:61], v10 offset:49152
  buffer_load_dwordx4 v19, s[40:43], s57 offen offset:1024 nt lds
  s_and_b32 s86, s86, 0xffff
  s_add_u32 s57, s57, s58
  v_mfma_f32_16x16x32_bf16 v[232:235], v[48:51], v[32:35], v[232:235]
  ds_read_b64_tr_b16 v[62:63], v10 offset:51200
  v_mfma_f32_16x16x32_bf16 v[236:239], v[52:55], v[32:35], v[236:239]
  ds_read_b128 v[28:31], v15 offset:2048
  ds_read_b64_tr_b16 v[64:65], v11 offset:49152
  s_mov_b32 m0, s60
  s_add_u32 s60, s60, 30720
  buffer_load_dwordx4 v16, s[44:47], s56 offen lds
  v_mfma_f32_16x16x32_bf16 v[240:243], v[40:43], v[36:39], v[240:243]
  ds_read_b64_tr_b16 v[66:67], v11 offset:51200
  ds_read_b64_tr_b16 v[68:69], v12 offset:49152
  buffer_load_dwordx4 v17, s[44:47], s56 offen offset:1024 lds
  s_add_u32 s56, s56, s87
  s_cmp_ge_u32 s60, 163840
  s_cselect_b32 s60, s88, s60
  v_mfma_f32_16x16x32_bf16 v[244:247], v[44:47], v[36:39], v[244:247]
  ds_read_b64_tr_b16 v[70:71], v12 offset:51200
  v_mfma_f32_16x16x32_bf16 v[248:251], v[48:51], v[36:39], v[248:251]
  buffer_load_dword v4, v6, s[96:99], s100 offen
  s_add_u32 s100, s100, s101
  v_mfma_f32_16x16x32_bf16 v[252:255], v[52:55], v[36:39], v[252:255]
  s_waitcnt lgkmcnt(7)
  v_mfma_f32_16x16x32_bf16 v[128:131], v[56:59], v[24:27], v[128:131]
  ds_read_b128 v[32:35], v15 offset:4096
  s_waitcnt lgkmcnt(6)
  v_mfma_f32_16x16x32_bf16 v[132:135], v[60:63], v[24:27], v[132:135]
  ds_read_b128 v[36:39], v15 offset:6144
  s_waitcnt lgkmcnt(4)
  v_mfma_f32_16x16x32_bf16 v[136:139], v[64:67], v[24:27], v[136:139]
  s_waitcnt lgkmcnt(2)
  v_mfma_f32_16x16x32_bf16 v[140:143], v[68:71], v[24:27], v[140:143]
  v_mfma_f32_16x16x32_bf16 v[144:147], v[56:59], v[28:31], v[144:147]
  ds_read_b128 v[24:27], v15 offset:8192
  v_mfma_f32_16x16x32_bf16 v[148:151], v[60:63], v[28:31], v[148:151]
  v_mfma_f32_16x16x32_bf16 v[152:155], v[64:67], v[28:31], v[152:155]
  v_mfma_f32_16x16x32_bf16 v[156:159], v[68:71], v[28:31], v[156:159]
  s_waitcnt lgkmcnt(2)
  v_mfma_f32_16x16x32_bf16 v[160:163], v[56:59], v[32:35], v[160:163]
  ds_read_b128 v[28:31], v15 offset:10240
  v_mfma_f32_16x16x32_bf16 v[164:167], v[60:63], v[32:35], v[164:167]
  v_mfma_f32_16x16x32_bf16 v[168:171], v[64:67], v[32:35], v[168:171]
  v_mfma_f32_16x16x32_bf16 v[172:175], v[68:71], v[32:35], v[172:175]
  s_waitcnt lgkmcnt(2)
  v_mfma_f32_16x16x32_bf16 v[176:179], v[56:59], v[36:39], v[176:179]
  ds_read_b128 v[32:35], v15 offset:12288
  v_mfma_f32_16x16x32_bf16 v[180:183], v[60:63], v[36:39], v[180:183]
  v_mfma_f32_16x16x32_bf16 v[184:187], v[64:67], v[36:39], v[184:187]
  v_mfma_f32_16x16x32_bf16 v[188:191], v[68:71], v[36:39], v[188:191]
  s_waitcnt lgkmcnt(2)
  v_mfma_f32_16x16x32_bf16 v[192:195], v[56:59], v[24:27], v[192:195]
  ds_read_b128 v[36:39], v15 offset:14336
  v_mfma_f32_16x16x32_bf16 v[196:199], v[60:63], v[24:27], v[196:199]
  v_mfma_f32_16x16x32_bf16 v[200:203], v[64:67], v[24:27], v[200:203]
  v_mfma_f32_16x16x32_bf16 v[204:207], v[68:71], v[24:27], v[204:207]
  s_waitcnt lgkmcnt(2)
  v_mfma_f32_16x16x32_bf16 v[208:211], v[56:59], v[28:31], v[208:211]
  v_mfma_f32_16x16x32_bf16 v[212:215], v[60:63], v[28:31], v[212:215]
  v_mfma_f32_16x16x32_bf16 v[216:219], v[64:67], v[28:31], v[216:219]
  v_mfma_f32_16x16x32_bf16 v[220:223], v[68:71], v[28:31], v[220:223]
  s_waitcnt vmcnt(8) lgkmcnt(0)
  s_barrier
  v_mfma_f32_16x16x32_bf16 v[224:227], v[56:59], v[32:35], v[224:227]
  ds_read_b128 v[24:27], v8 offset:32768
  ds_read_b64_tr_b16 v[40:41], v9 offset:0
  s_mov_b32 m0, s86
  s_add_u32 s86, s86, 16384
  buffer_load_dwordx4 v18, s[40:43], s57 offen nt lds
  v_mfma_f32_16x16x32_bf16 v[228:231], v[60:63], v[32:35], v[228:231]
  ds_read_b64_tr_b16 v[42:43], v9 offset:2048
  ds_read_b64_tr_b16 v[44:45], v10 offset:0
  buffer_load_dwordx4 v19, s[40:43], s57 offen offset:1024 nt lds
  s_and_b32 s86, s86, 0xffff
  s_add_u32 s57, s57, s58
  v_mfma_f32_16x16x32_bf16 v[232:235], v[64:67], v[32:35], v[232:235]
  ds_read_b64_tr_b16 v[46:47], v10 offset:2048
  v_mfma_f32_16x16x32_bf16 v[236:239], v[68:71], v[32:35], v[236:239]
  ds_read_b128 v[28:31], v8 offset:34816
  ds_read_b64_tr_b16 v[48:49], v11 offset:0
  s_mov_b32 m0, s60
  s_add_u32 s60, s60, 2048
  buffer_load_dwordx4 v16, s[44:47], s56 offen lds
  v_mfma_f32_16x16x32_bf16 v[240:243], v[56:59], v[36:39], v[240:243]
  ds_read_b64_tr_b16 v[50:51], v11 offset:2048
  ds_read_b64_tr_b16 v[52:53], v12 offset:0
  buffer_load_dwordx4 v17, s[44:47], s56 offen offset:1024 lds
  s_add_u32 s56, s56, s84
  v_mfma_f32_16x16x32_bf16 v[244:247], v[60:63], v[36:39], v[244:247]
  ds_read_b64_tr_b16 v[54:55], v12 offset:2048
  v_mfma_f32_16x16x32_bf16 v[248:251], v[64:67], v[36:39], v[248:251]
  buffer_load_dword v4, v6, s[96:99], s100 offen
  s_add_u32 s100, s100, s101
  v_mfma_f32_16x16x32_bf16 v[252:255], v[68:71], v[36:39], v[252:255]
  s_waitcnt lgkmcnt(7)
  v_mfma_f32_16x16x32_bf16 v[128:131], v[40:43], v[24:27], v[128:131]
  ds_read_b128 v[32:35], v8 offset:36864
  s_waitcnt lgkmcnt(6)
  v_mfma_f32_16x16x32_bf16 v[132:135], v[44:47], v[24:27], v[132:135]
  ds_read_b128 v[36:39], v8 offset:38912
  s_waitcnt lgkmcnt(4)
  v_mfma_f32_16x16x32_bf16 v[136:139], v[48:51], v[24:27], v[136:139]
  s_waitcnt lgkmcnt(2)
  v_mfma_f32_16x16x32_bf16 v[140:143], v[52:55], v[24:27], v[140:143]
  v_mfma_f32_16x16x32_bf16 v[144:147], v[40:43], v[28:31], v[144:147]
  ds_read_b128 v[24:27], v8 offset:40960
  v_mfma_f32_16x16x32_bf16 v[148:151], v[44:47], v[28:31], v[148:151]
  v_mfma_f32_16x16x32_bf16 v[152:155], v[48:51], v[28:31], v[152:155]
  s_cmp_lg_u32 s17, 0
  s_cbranch_scc0 K1_LOOPK_EF
  s_mov_b64 exec, 1
  buffer_store_dword v91, off, s[36:39], s17 sc1
  s_mov_b64 exec, -1
K1_LOOPK_EF:
  v_mfma_f32_16x16x32_bf16 v[156:159], v[52:55], v[28:31], v[156:159]
  s_waitcnt lgkmcnt(2)
  v_mfma_f32_16x16x32_bf16 v[160:163], v[40:43], v[32:35], v[160:163]
  ds_read_b128 v[28:31], v8 offset:43008
  v_mfma_f32_16x16x32_bf16 v[164:167], v[44:47], v[32:35], v[164:167]
  v_mfma_f32_16x16x32_bf16 v[168:171], v[48:51], v[32:35], v[168:171]
  v_mfma_f32_16x16x32_bf16 v[172:175], v[52:55], v[32:35], v[172:175]
  s_cmp_eq_u32 s3, 0
  s_cbranch_scc0 K1_LOOPK_EQ
  buffer_load_ubyte v92, v89, s[28:31], 0 offen sc1
K1_LOOPK_EQ:
  s_waitcnt lgkmcnt(2)
  v_mfma_f32_16x16x32_bf16 v[176:179], v[40:43], v[36:39], v[176:179]
  ds_read_b128 v[32:35], v8 offset:45056
  v_mfma_f32_16x16x32_bf16 v[180:183], v[44:47], v[36:39], v[180:183]
  v_mfma_f32_16x16x32_bf16 v[184:187], v[48:51], v[36:39], v[184:187]
  v_mfma_f32_16x16x32_bf16 v[188:191], v[52:55], v[36:39], v[188:191]
  s_waitcnt lgkmcnt(2)
  v_mfma_f32_16x16x32_bf16 v[192:195], v[40:43], v[24:27], v[192:195]
  ds_read_b128 v[36:39], v8 offset:47104
  v_mfma_f32_16x16x32_bf16 v[196:199], v[44:47], v[24:27], v[196:199]
  v_mfma_f32_16x16x32_bf16 v[200:203], v[48:51], v[24:27], v[200:203]
  v_mfma_f32_16x16x32_bf16 v[204:207], v[52:55], v[24:27], v[204:207]
  s_waitcnt lgkmcnt(2)
  v_mfma_f32_16x16x32_bf16 v[208:211], v[40:43], v[28:31], v[208:211]
  v_mfma_f32_16x16x32_bf16 v[212:215], v[44:47], v[28:31], v[212:215]
  v_mfma_f32_16x16x32_bf16 v[216:219], v[48:51], v[28:31], v[216:219]
  v_mfma_f32_16x16x32_bf16 v[220:223], v[52:55], v[28:31], v[220:223]
  s_waitcnt vmcnt(13) lgkmcnt(0)
  s_barrier
  v_mfma_f32_16x16x32_bf16 v[224:227], v[40:43], v[32:35], v[224:227]
  ds_read_b128 v[24:27], v15 offset:32768
  ds_read_b64_tr_b16 v[56:57], v9 offset:16384
  s_mov_b32 m0, s86
  s_add_u32 s86, s86, 16384
  buffer_load_dwordx4 v18, s[40:43], s57 offen nt lds
  v_mfma_f32_16x16x32_bf16 v[228:231], v[44:47], v[32:35], v[228:231]
  ds_read_b64_tr_b16 v[58:59], v9 offset:18432
  ds_read_b64_tr_b16 v[60:61], v10 offset:16384
  buffer_load_dwordx4 v19, s[40:43], s57 offen offset:1024 nt lds
  s_and_b32 s86, s86, 0xffff
  s_add_u32 s57, s57, s58
  v_mfma_f32_16x16x32_bf16 v[232:235], v[48:51], v[32:35], v[232:235]
  ds_read_b64_tr_b16 v[62:63], v10 offset:18432
  v_mfma_f32_16x16x32_bf16 v[236:239], v[52:55], v[32:35], v[236:239]
  ds_read_b128 v[28:31], v15 offset:34816
  ds_read_b64_tr_b16 v[64:65], v11 offset:16384
  s_mov_b32 m0, s60
  s_add_u32 s60, s60, 30720
  buffer_load_dwordx4 v16, s[44:47], s56 offen lds
  v_mfma_f32_16x16x32_bf16 v[240:243], v[40:43], v[36:39], v[240:243]
  ds_read_b64_tr_b16 v[66:67], v11 offset:18432
  ds_read_b64_tr_b16 v[68:69], v12 offset:16384
  buffer_load_dwordx4 v17, s[44:47], s56 offen offset:1024 lds
  s_add_u32 s56, s56, s87
  s_cmp_ge_u32 s60, 163840
  s_cselect_b32 s60, s88, s60
  v_mfma_f32_16x16x32_bf16 v[244:247], v[44:47], v[36:39], v[244:247]
  ds_read_b64_tr_b16 v[70:71], v12 offset:18432
  v_mfma_f32_16x16x32_bf16 v[248:251], v[48:51], v[36:39], v[248:251]
  buffer_load_dword v4, v6, s[96:99], s100 offen
  s_add_u32 s100, s100, s101
  v_mfma_f32_16x16x32_bf16 v[252:255], v[52:55], v[36:39], v[252:255]
  s_waitcnt lgkmcnt(7)
  v_mfma_f32_16x16x32_bf16 v[128:131], v[56:59], v[24:27], v[128:131]
  ds_read_b128 v[32:35], v15 offset:36864
  s_waitcnt lgkmcnt(6)
  v_mfma_f32_16x16x32_bf16 v[132:135], v[60:63], v[24:27], v[132:135]
  ds_read_b128 v[36:39], v15 offset:38912
  s_waitcnt lgkmcnt(4)
  v_mfma_f32_16x16x32_bf16 v[136:139], v[64:67], v[24:27], v[136:139]
  s_waitcnt lgkmcnt(2)
  v_mfma_f32_16x16x32_bf16 v[140:143], v[68:71], v[24:27], v[140:143]
  v_mfma_f32_16x16x32_bf16 v[144:147], v[56:59], v[28:31], v[144:147]
  ds_read_b128 v[24:27], v15 offset:40960
  v_mfma_f32_16x16x32_bf16 v[148:151], v[60:63], v[28:31], v[148:151]
  v_mfma_f32_16x16x32_bf16 v[152:155], v[64:67], v[28:31], v[152:155]
  v_mfma_f32_16x16x32_bf16 v[156:159], v[68:71], v[28:31], v[156:159]
  s_waitcnt lgkmcnt(2)
  v_mfma_f32_16x16x32_bf16 v[160:163], v[56:59], v[32:35], v[160:163]
  ds_read_b128 v[28:31], v15 offset:43008
  v_mfma_f32_16x16x32_bf16 v[164:167], v[60:63], v[32:35], v[164:167]
  v_mfma_f32_16x16x32_bf16 v[168:171], v[64:67], v[32:35], v[168:171]
  v_mfma_f32_16x16x32_bf16 v[172:175], v[68:71], v[32:35], v[172:175]
  s_waitcnt lgkmcnt(2)
  v_mfma_f32_16x16x32_bf16 v[176:179], v[56:59], v[36:39], v[176:179]
  ds_read_b128 v[32:35], v15 offset:45056
  v_mfma_f32_16x16x32_bf16 v[180:183], v[60:63], v[36:39], v[180:183]
  v_mfma_f32_16x16x32_bf16 v[184:187], v[64:67], v[36:39], v[184:187]
  v_mfma_f32_16x16x32_bf16 v[188:191], v[68:71], v[36:39], v[188:191]
  s_waitcnt lgkmcnt(2)
  v_mfma_f32_16x16x32_bf16 v[192:195], v[56:59], v[24:27], v[192:195]
  ds_read_b128 v[36:39], v15 offset:47104
  v_mfma_f32_16x16x32_bf16 v[196:199], v[60:63], v[24:27], v[196:199]
  v_mfma_f32_16x16x32_bf16 v[200:203], v[64:67], v[24:27], v[200:203]
  v_mfma_f32_16x16x32_bf16 v[204:207], v[68:71], v[24:27], v[204:207]
  s_waitcnt lgkmcnt(2)
  v_mfma_f32_16x16x32_bf16 v[208:211], v[56:59], v[28:31], v[208:211]
  v_mfma_f32_16x16x32_bf16 v[212:215], v[60:63], v[28:31], v[212:215]
  v_mfma_f32_16x16x32_bf16 v[216:219], v[64:67], v[28:31], v[216:219]
  v_mfma_f32_16x16x32_bf16 v[220:223], v[68:71], v[28:31], v[220:223]
  s_waitcnt vmcnt(11) lgkmcnt(0)
  s_barrier
  v_mfma_f32_16x16x32_bf16 v[224:227], v[56:59], v[32:35], v[224:227]
  ds_read_b128 v[24:27], v13 offset:0
  ds_read_b64_tr_b16 v[40:41], v9 offset:32768
  s_mov_b32 m0, s86
  s_add_u32 s86, s86, 16384
  buffer_load_dwordx4 v18, s[40:43], s57 offen nt lds
  v_mfma_f32_16x16x32_bf16 v[228:231], v[60:63], v[32:35], v[228:231]
  ds_read_b64_tr_b16 v[42:43], v9 offset:34816
  ds_read_b64_tr_b16 v[44:45], v10 offset:32768
  buffer_load_dwordx4 v19, s[40:43], s57 offen offset:1024 nt lds
  s_and_b32 s86, s86, 0xffff
  s_add_u32 s57, s57, s58
  v_mfma_f32_16x16x32_bf16 v[232:235], v[64:67], v[32:35], v[232:235]
  ds_read_b64_tr_b16 v[46:47], v10 offset:34816
  v_mfma_f32_16x16x32_bf16 v[236:239], v[68:71], v[32:35], v[236:239]
  ds_read_b128 v[28:31], v13 offset:2048
  ds_read_b64_tr_b16 v[48:49], v11 offset:32768
  s_mov_b32 m0, s60
  s_add_u32 s60, s60, 2048
  buffer_load_dwordx4 v16, s[44:47], s56 offen lds
  v_mfma_f32_16x16x32_bf16 v[240:243], v[56:59], v[36:39], v[240:243]
  ds_read_b64_tr_b16 v[50:51], v11 offset:34816
  ds_read_b64_tr_b16 v[52:53], v12 offset:32768
  buffer_load_dwordx4 v17, s[44:47], s56 offen offset:1024 lds
  s_add_u32 s56, s56, s84
  v_mfma_f32_16x16x32_bf16 v[244:247], v[60:63], v[36:39], v[244:247]
  ds_read_b64_tr_b16 v[54:55], v12 offset:34816
  v_mfma_f32_16x16x32_bf16 v[248:251], v[64:67], v[36:39], v[248:251]
  buffer_load_dword v4, v6, s[96:99], s100 offen
  s_add_u32 s100, s100, s101
  v_mfma_f32_16x16x32_bf16 v[252:255], v[68:71], v[36:39], v[252:255]
  s_waitcnt lgkmcnt(7)
  v_mfma_f32_16x16x32_bf16 v[128:131], v[40:43], v[24:27], v[128:131]
  ds_read_b128 v[32:35], v13 offset:4096
  s_waitcnt lgkmcnt(6)
  v_mfma_f32_16x16x32_bf16 v[132:135], v[44:47], v[24:27], v[132:135]
  ds_read_b128 v[36:39], v13 offset:6144
  s_waitcnt lgkmcnt(4)
  v_mfma_f32_16x16x32_bf16 v[136:139], v[48:51], v[24:27], v[136:139]
  s_waitcnt lgkmcnt(2)
  v_mfma_f32_16x16x32_bf16 v[140:143], v[52:55], v[24:27], v[140:143]
  v_mfma_f32_16x16x32_bf16 v[144:147], v[40:43], v[28:31], v[144:147]
  ds_read_b128 v[24:27], v13 offset:8192
  v_mfma_f32_16x16x32_bf16 v[148:151], v[44:47], v[28:31], v[148:151]
  v_mfma_f32_16x16x32_bf16 v[152:155], v[48:51], v[28:31], v[152:155]
  s_cmp_eq_u32 s3, 0
  s_cbranch_scc0 K1_LOOPK_EP
  s_waitcnt vmcnt(10)
  v_cmp_ne_u32 s[18:19], 1, v92
  buffer_load_dword v90, v93, s[36:39], 0 offen sc1
K1_LOOPK_EP:
  v_mfma_f32_16x16x32_bf16 v[156:159], v[52:55], v[28:31], v[156:159]
  s_waitcnt lgkmcnt(2)
  v_mfma_f32_16x16x32_bf16 v[160:163], v[40:43], v[32:35], v[160:163]
  ds_read_b128 v[28:31], v13 offset:10240
  v_mfma_f32_16x16x32_bf16 v[164:167], v[44:47], v[32:35], v[164:167]
  v_mfma_f32_16x16x32_bf16 v[168:171], v[48:51], v[32:35], v[168:171]
  v_mfma_f32_16x16x32_bf16 v[172:175], v[52:55], v[32:35], v[172:175]
  s_waitcnt lgkmcnt(2)
  v_mfma_f32_16x16x32_bf16 v[176:179], v[40:43], v[36:39], v[176:179]
  ds_read_b128 v[32:35], v13 offset:12288
  v_mfma_f32_16x16x32_bf16 v[180:183], v[44:47], v[36:39], v[180:183]
  v_mfma_f32_16x16x32_bf16 v[184:187], v[48:51], v[36:39], v[184:187]
  v_mfma_f32_16x16x32_bf16 v[188:191], v[52:55], v[36:39], v[188:191]
  s_waitcnt lgkmcnt(2)
  v_mfma_f32_16x16x32_bf16 v[192:195], v[40:43], v[24:27], v[192:195]
  ds_read_b128 v[36:39], v13 offset:14336
  v_mfma_f32_16x16x32_bf16 v[196:199], v[44:47], v[24:27], v[196:199]
  v_mfma_f32_16x16x32_bf16 v[200:203], v[48:51], v[24:27], v[200:203]
  v_mfma_f32_16x16x32_bf16 v[204:207], v[52:55], v[24:27], v[204:207]
  s_waitcnt lgkmcnt(2)
  v_mfma_f32_16x16x32_bf16 v[208:211], v[40:43], v[28:31], v[208:211]
  v_mfma_f32_16x16x32_bf16 v[212:215], v[44:47], v[28:31], v[212:215]
  v_mfma_f32_16x16x32_bf16 v[216:219], v[48:51], v[28:31], v[216:219]
  v_mfma_f32_16x16x32_bf16 v[220:223], v[52:55], v[28:31], v[220:223]
  s_waitcnt vmcnt(13) lgkmcnt(0)
  s_barrier
  v_mfma_f32_16x16x32_bf16 v[224:227], v[40:43], v[32:35], v[224:227]
  ds_read_b128 v[24:27], v14 offset:0
  ds_read_b64_tr_b16 v[56:57], v9 offset:49152
  s_mov_b32 m0, s86
  s_add_u32 s86, s86, 16384
  buffer_load_dwordx4 v18, s[40:43], s57 offen nt lds
  v_mfma_f32_16x16x32_bf16 v[228:231], v[44:47], v[32:35], v[228:231]
  ds_read_b64_tr_b16 v[58:59], v9 offset:51200
  ds_read_b64_tr_b16 v[60:61], v10 offset:49152
  buffer_load_dwordx4 v19, s[40:43], s57 offen offset:1024 nt lds
  s_and_b32 s86, s86, 0xffff
  s_add_u32 s57, s57, s58
  v_mfma_f32_16x16x32_bf16 v[232:235], v[48:51], v[32:35], v[232:235]
  ds_read_b64_tr_b16 v[62:63], v10 offset:51200
  v_mfma_f32_16x16x32_bf16 v[236:239], v[52:55], v[32:35], v[236:239]
  ds_read_b128 v[28:31], v14 offset:2048
  ds_read_b64_tr_b16 v[64:65], v11 offset:49152
  s_mov_b32 m0, s60
  s_add_u32 s60, s60, 30720
  buffer_load_dwordx4 v16, s[44:47], s56 offen lds
  v_mfma_f32_16x16x32_bf16 v[240:243], v[40:43], v[36:39], v[240:243]
  ds_read_b64_tr_b16 v[66:67], v11 offset:51200
  ds_read_b64_tr_b16 v[68:69], v12 offset:49152
  buffer_load_dwordx4 v17, s[44:47], s56 offen offset:1024 lds
  s_add_u32 s56, s56, s87
  s_cmp_ge_u32 s60, 163840
  s_cselect_b32 s60, s88, s60
  v_mfma_f32_16x16x32_bf16 v[244:247], v[44:47], v[36:39], v[244:247]
  ds_read_b64_tr_b16 v[70:71], v12 offset:51200
  v_mfma_f32_16x16x32_bf16 v[248:251], v[48:51], v[36:39], v[248:251]
  buffer_load_dword v4, v6, s[96:99], s100 offen
  s_add_u32 s100, s100, s101
  v_mfma_f32_16x16x32_bf16 v[252:255], v[52:55], v[36:39], v[252:255]
  s_waitcnt lgkmcnt(7)
  v_mfma_f32_16x16x32_bf16 v[128:131], v[56:59], v[24:27], v[128:131]
  ds_read_b128 v[32:35], v14 offset:4096
  s_waitcnt lgkmcnt(6)
  v_mfma_f32_16x16x32_bf16 v[132:135], v[60:63], v[24:27], v[132:135]
  ds_read_b128 v[36:39], v14 offset:6144
  s_waitcnt lgkmcnt(4)
  v_mfma_f32_16x16x32_bf16 v[136:139], v[64:67], v[24:27], v[136:139]
  s_mov_b32 s44, s8
  s_waitcnt lgkmcnt(2)
  v_mfma_f32_16x16x32_bf16 v[140:143], v[68:71], v[24:27], v[140:143]
  v_mfma_f32_16x16x32_bf16 v[144:147], v[56:59], v[28:31], v[144:147]
  ds_read_b128 v[24:27], v14 offset:8192
  s_mov_b32 s45, s9
  v_mfma_f32_16x16x32_bf16 v[148:151], v[60:63], v[28:31], v[148:151]
  v_mfma_f32_16x16x32_bf16 v[152:155], v[64:67], v[28:31], v[152:155]
  v_mfma_f32_16x16x32_bf16 v[156:159], v[68:71], v[28:31], v[156:159]
  s_mov_b32 s46, 2621440
  s_waitcnt lgkmcnt(2)
  v_mfma_f32_16x16x32_bf16 v[160:163], v[56:59], v[32:35], v[160:163]
  ds_read_b128 v[28:31], v14 offset:10240
  v_mfma_f32_16x16x32_bf16 v[164:167], v[60:63], v[32:35], v[164:167]
  s_mov_b32 s56, 0
  v_mfma_f32_16x16x32_bf16 v[168:171], v[64:67], v[32:35], v[168:171]
  v_mfma_f32_16x16x32_bf16 v[172:175], v[68:71], v[32:35], v[172:175]
  s_waitcnt lgkmcnt(2)
  v_mfma_f32_16x16x32_bf16 v[176:179], v[56:59], v[36:39], v[176:179]
  ds_read_b128 v[32:35], v14 offset:12288
  s_movk_i32 s84, 128
  v_mfma_f32_16x16x32_bf16 v[180:183], v[60:63], v[36:39], v[180:183]
  v_mfma_f32_16x16x32_bf16 v[184:187], v[64:67], v[36:39], v[184:187]
  s_movk_i32 s87, 128
  v_mfma_f32_16x16x32_bf16 v[188:191], v[68:71], v[36:39], v[188:191]
  s_waitcnt lgkmcnt(2)
  v_mfma_f32_16x16x32_bf16 v[192:195], v[56:59], v[24:27], v[192:195]
  ds_read_b128 v[36:39], v14 offset:14336
  v_mfma_f32_16x16x32_bf16 v[196:199], v[60:63], v[24:27], v[196:199]
  v_mov_b32 v16, v20
  v_mfma_f32_16x16x32_bf16 v[200:203], v[64:67], v[24:27], v[200:203]
  v_mfma_f32_16x16x32_bf16 v[204:207], v[68:71], v[24:27], v[204:207]
  v_mov_b32 v17, v21
  s_waitcnt lgkmcnt(2)
  v_mfma_f32_16x16x32_bf16 v[208:211], v[56:59], v[28:31], v[208:211]
  v_mfma_f32_16x16x32_bf16 v[212:215], v[60:63], v[28:31], v[212:215]
  v_mfma_f32_16x16x32_bf16 v[216:219], v[64:67], v[28:31], v[216:219]
  s_cmp_eq_u32 s3, 0
  s_cbranch_scc0 K1_LOOPK_EC
  s_waitcnt vmcnt(5)
  v_cmp_eq_u32 vcc, 0, v90
  s_nop 0
  s_or_b64 vcc, vcc, s[18:19]
  s_cbranch_scc1 K1_ESLOW
K1_LOOPK_EC:
  v_mfma_f32_16x16x32_bf16 v[220:223], v[68:71], v[28:31], v[220:223]
  s_waitcnt vmcnt(11) lgkmcnt(0)
  s_barrier
  v_mfma_f32_16x16x32_bf16 v[224:227], v[56:59], v[32:35], v[224:227]
  ds_read_b128 v[24:27], v8 offset:0
  ds_read_b64_tr_b16 v[40:41], v9 offset:0
  s_mov_b32 m0, s86
  s_add_u32 s86, s86, 16384
  buffer_load_dwordx4 v18, s[40:43], s57 offen nt lds
  v_mfma_f32_16x16x32_bf16 v[228:231], v[60:63], v[32:35], v[228:231]
  ds_read_b64_tr_b16 v[42:43], v9 offset:2048
  ds_read_b64_tr_b16 v[44:45], v10 offset:0
  buffer_load_dwordx4 v19, s[40:43], s57 offen offset:1024 nt lds
  s_and_b32 s86, s86, 0xffff
  s_add_u32 s57, s57, s58
  v_mfma_f32_16x16x32_bf16 v[232:235], v[64:67], v[32:35], v[232:235]
  ds_read_b64_tr_b16 v[46:47], v10 offset:2048
  v_mfma_f32_16x16x32_bf16 v[236:239], v[68:71], v[32:35], v[236:239]
  ds_read_b128 v[28:31], v8 offset:2048
  ds_read_b64_tr_b16 v[48:49], v11 offset:0
  s_mov_b32 m0, s60
  s_add_u32 s60, s60, 2048
  buffer_load_dwordx4 v16, s[44:47], s56 offen lds
  v_mfma_f32_16x16x32_bf16 v[240:243], v[56:59], v[36:39], v[240:243]
  ds_read_b64_tr_b16 v[50:51], v11 offset:2048
  ds_read_b64_tr_b16 v[52:53], v12 offset:0
  buffer_load_dwordx4 v17, s[44:47], s56 offen offset:1024 lds
  s_add_u32 s56, s56, s84
  v_mfma_f32_16x16x32_bf16 v[244:247], v[60:63], v[36:39], v[244:247]
  ds_read_b64_tr_b16 v[54:55], v12 offset:2048
  v_mfma_f32_16x16x32_bf16 v[248:251], v[64:67], v[36:39], v[248:251]
  buffer_load_dword v4, v6, s[96:99], s100 offen
  s_add_u32 s100, s100, s101
  v_mfma_f32_16x16x32_bf16 v[252:255], v[68:71], v[36:39], v[252:255]
  s_waitcnt lgkmcnt(7)
  v_mfma_f32_16x16x32_bf16 v[128:131], v[40:43], v[24:27], v[128:131]
  ds_read_b128 v[32:35], v8 offset:4096
  s_waitcnt lgkmcnt(6)
  v_mfma_f32_16x16x32_bf16 v[132:135], v[44:47], v[24:27], v[132:135]
  ds_read_b128 v[36:39], v8 offset:6144
  s_waitcnt lgkmcnt(4)
  v_mfma_f32_16x16x32_bf16 v[136:139], v[48:51], v[24:27], v[136:139]
  s_mov_b32 s40, s36
  s_waitcnt lgkmcnt(2)
  v_mfma_f32_16x16x32_bf16 v[140:143], v[52:55], v[24:27], v[140:143]
  v_mfma_f32_16x16x32_bf16 v[144:147], v[40:43], v[28:31], v[144:147]
  ds_read_b128 v[24:27], v8 offset:8192
  s_mov_b32 s41, s37
  v_mfma_f32_16x16x32_bf16 v[148:151], v[44:47], v[28:31], v[148:151]
  v_mfma_f32_16x16x32_bf16 v[152:155], v[48:51], v[28:31], v[152:155]
  v_mfma_f32_16x16x32_bf16 v[156:159], v[52:55], v[28:31], v[156:159]
  s_mov_b32 s42, s38
  s_waitcnt lgkmcnt(2)
  v_mfma_f32_16x16x32_bf16 v[160:163], v[40:43], v[32:35], v[160:163]
  ds_read_b128 v[28:31], v8 offset:10240
  v_mfma_f32_16x16x32_bf16 v[164:167], v[44:47], v[32:35], v[164:167]
  s_mul_i32 s57, s80, 163840
  v_mfma_f32_16x16x32_bf16 v[168:171], v[48:51], v[32:35], v[168:171]
  v_mfma_f32_16x16x32_bf16 v[172:175], v[52:55], v[32:35], v[172:175]
  s_waitcnt lgkmcnt(2)
  v_mfma_f32_16x16x32_bf16 v[176:179], v[40:43], v[36:39], v[176:179]
  ds_read_b128 v[32:35], v8 offset:12288
  s_add_u32 s57, s57, 88080384
  v_mfma_f32_16x16x32_bf16 v[180:183], v[44:47], v[36:39], v[180:183]
  v_mfma_f32_16x16x32_bf16 v[184:187], v[48:51], v[36:39], v[184:187]
  s_movk_i32 s58, 16384
  v_mfma_f32_16x16x32_bf16 v[188:191], v[52:55], v[36:39], v[188:191]
  s_waitcnt lgkmcnt(2)
  v_mfma_f32_16x16x32_bf16 v[192:195], v[40:43], v[24:27], v[192:195]
  ds_read_b128 v[36:39], v8 offset:14336
  v_mfma_f32_16x16x32_bf16 v[196:199], v[44:47], v[24:27], v[196:199]
  v_add_u32 v18, s86, v2
  v_mfma_f32_16x16x32_bf16 v[200:203], v[48:51], v[24:27], v[200:203]
  v_mfma_f32_16x16x32_bf16 v[204:207], v[52:55], v[24:27], v[204:207]
  v_add_u32 v19, s86, v2
  s_waitcnt lgkmcnt(2)
  v_mfma_f32_16x16x32_bf16 v[208:211], v[40:43], v[28:31], v[208:211]
  v_mfma_f32_16x16x32_bf16 v[212:215], v[44:47], v[28:31], v[212:215]
  v_mfma_f32_16x16x32_bf16 v[216:219], v[48:51], v[28:31], v[216:219]
  v_mfma_f32_16x16x32_bf16 v[220:223], v[52:55], v[28:31], v[220:223]
  s_waitcnt vmcnt(13) lgkmcnt(0)
  s_barrier
  v_mfma_f32_16x16x32_bf16 v[224:227], v[40:43], v[32:35], v[224:227]
  ds_read_b128 v[24:27], v15 offset:0
  ds_read_b64_tr_b16 v[56:57], v9 offset:16384
  s_mov_b32 m0, s86
  s_add_u32 s86, s86, 16384
  buffer_load_dwordx4 v18, s[40:43], s57 offen sc1 lds
  v_mfma_f32_16x16x32_bf16 v[228:231], v[44:47], v[32:35], v[228:231]
  ds_read_b64_tr_b16 v[58:59], v9 offset:18432
  ds_read_b64_tr_b16 v[60:61], v10 offset:16384
  buffer_load_dwordx4 v19, s[40:43], s57 offen offset:1024 sc1 lds
  s_and_b32 s86, s86, 0xffff
  s_add_u32 s57, s57, s58
  v_mfma_f32_16x16x32_bf16 v[232:235], v[48:51], v[32:35], v[232:235]
  ds_read_b64_tr_b16 v[62:63], v10 offset:18432
  v_mfma_f32_16x16x32_bf16 v[236:239], v[52:55], v[32:35], v[236:239]
  ds_read_b128 v[28:31], v15 offset:2048
  ds_read_b64_tr_b16 v[64:65], v11 offset:16384
  s_mov_b32 m0, s60
  s_add_u32 s60, s60, 30720
  buffer_load_dwordx4 v16, s[44:47], s56 offen lds
  v_mfma_f32_16x16x32_bf16 v[240:243], v[40:43], v[36:39], v[240:243]
  ds_read_b64_tr_b16 v[66:67], v11 offset:18432
  ds_read_b64_tr_b16 v[68:69], v12 offset:16384
  buffer_load_dwordx4 v17, s[44:47], s56 offen offset:1024 lds
  s_add_u32 s56, s56, s87
  s_cmp_ge_u32 s60, 163840
  s_cselect_b32 s60, s88, s60
  v_mfma_f32_16x16x32_bf16 v[244:247], v[44:47], v[36:39], v[244:247]
  ds_read_b64_tr_b16 v[70:71], v12 offset:18432
  v_mfma_f32_16x16x32_bf16 v[248:251], v[48:51], v[36:39], v[248:251]
  buffer_load_dword v4, v6, s[96:99], s100 offen
  s_add_u32 s100, s100, s101
  v_mfma_f32_16x16x32_bf16 v[252:255], v[52:55], v[36:39], v[252:255]
  s_waitcnt lgkmcnt(7)
  v_mfma_f32_16x16x32_bf16 v[128:131], v[56:59], v[24:27], v[128:131]
  ds_read_b128 v[32:35], v15 offset:4096
  s_waitcnt lgkmcnt(6)
  v_mfma_f32_16x16x32_bf16 v[132:135], v[60:63], v[24:27], v[132:135]
  ds_read_b128 v[36:39], v15 offset:6144
  s_waitcnt lgkmcnt(4)
  v_mfma_f32_16x16x32_bf16 v[136:139], v[64:67], v[24:27], v[136:139]
  s_waitcnt lgkmcnt(2)
  v_mfma_f32_16x16x32_bf16 v[140:143], v[68:71], v[24:27], v[140:143]
  v_mfma_f32_16x16x32_bf16 v[144:147], v[56:59], v[28:31], v[144:147]
  ds_read_b128 v[24:27], v15 offset:8192
  v_mfma_f32_16x16x32_bf16 v[148:151], v[60:63], v[28:31], v[148:151]
  v_mfma_f32_16x16x32_bf16 v[152:155], v[64:67], v[28:31], v[152:155]
  v_mfma_f32_16x16x32_bf16 v[156:159], v[68:71], v[28:31], v[156:159]
  s_waitcnt lgkmcnt(2)
  v_mfma_f32_16x16x32_bf16 v[160:163], v[56:59], v[32:35], v[160:163]
  ds_read_b128 v[28:31], v15 offset:10240
  v_mfma_f32_16x16x32_bf16 v[164:167], v[60:63], v[32:35], v[164:167]
  v_mfma_f32_16x16x32_bf16 v[168:171], v[64:67], v[32:35], v[168:171]
  v_mfma_f32_16x16x32_bf16 v[172:175], v[68:71], v[32:35], v[172:175]
  s_waitcnt lgkmcnt(2)
  v_mfma_f32_16x16x32_bf16 v[176:179], v[56:59], v[36:39], v[176:179]
  ds_read_b128 v[32:35], v15 offset:12288
  v_mfma_f32_16x16x32_bf16 v[180:183], v[60:63], v[36:39], v[180:183]
  v_mfma_f32_16x16x32_bf16 v[184:187], v[64:67], v[36:39], v[184:187]
  v_mfma_f32_16x16x32_bf16 v[188:191], v[68:71], v[36:39], v[188:191]
  s_waitcnt lgkmcnt(2)
  v_mfma_f32_16x16x32_bf16 v[192:195], v[56:59], v[24:27], v[192:195]
  ds_read_b128 v[36:39], v15 offset:14336
  v_mfma_f32_16x16x32_bf16 v[196:199], v[60:63], v[24:27], v[196:199]
  v_mfma_f32_16x16x32_bf16 v[200:203], v[64:67], v[24:27], v[200:203]
  v_mfma_f32_16x16x32_bf16 v[204:207], v[68:71], v[24:27], v[204:207]
  s_waitcnt lgkmcnt(2)
  v_mfma_f32_16x16x32_bf16 v[208:211], v[56:59], v[28:31], v[208:211]
  v_mfma_f32_16x16x32_bf16 v[212:215], v[60:63], v[28:31], v[212:215]
  v_mfma_f32_16x16x32_bf16 v[216:219], v[64:67], v[28:31], v[216:219]
  v_mfma_f32_16x16x32_bf16 v[220:223], v[68:71], v[28:31], v[220:223]
  s_waitcnt vmcnt(11) lgkmcnt(0)
  s_barrier
  v_mfma_f32_16x16x32_bf16 v[224:227], v[56:59], v[32:35], v[224:227]
  ds_read_b128 v[24:27], v8 offset:32768
  ds_read_b64_tr_b16 v[40:41], v9 offset:32768
  s_mov_b32 m0, s86
  s_add_u32 s86, s86, 16384
  buffer_load_dwordx4 v18, s[40:43], s57 offen sc1 lds
  v_mfma_f32_16x16x32_bf16 v[228:231], v[60:63], v[32:35], v[228:231]
  ds_read_b64_tr_b16 v[42:43], v9 offset:34816
  ds_read_b64_tr_b16 v[44:45], v10 offset:32768
  buffer_load_dwordx4 v19, s[40:43], s57 offen offset:1024 sc1 lds
  s_and_b32 s86, s86, 0xffff
  s_add_u32 s57, s57, s58
  v_mfma_f32_16x16x32_bf16 v[232:235], v[64:67], v[32:35], v[232:235]
  ds_read_b64_tr_b16 v[46:47], v10 offset:34816
  v_mfma_f32_16x16x32_bf16 v[236:239], v[68:71], v[32:35], v[236:239]
  ds_read_b128 v[28:31], v8 offset:34816
  ds_read_b64_tr_b16 v[48:49], v11 offset:32768
  s_mov_b32 m0, s60
  s_add_u32 s60, s60, 2048
  buffer_load_dwordx4 v16, s[44:47], s56 offen lds
  v_mfma_f32_16x16x32_bf16 v[240:243], v[56:59], v[36:39], v[240:243]
  ds_read_b64_tr_b16 v[50:51], v11 offset:34816
  ds_read_b64_tr_b16 v[52:53], v12 offset:32768
  buffer_load_dwordx4 v17, s[44:47], s56 offen offset:1024 lds
  s_add_u32 s56, s56, s84
  v_mfma_f32_16x16x32_bf16 v[244:247], v[60:63], v[36:39], v[244:247]
  ds_read_b64_tr_b16 v[54:55], v12 offset:34816
  v_mfma_f32_16x16x32_bf16 v[248:251], v[64:67], v[36:39], v[248:251]
  buffer_load_dword v4, v6, s[96:99], s100 offen
  s_add_u32 s100, s100, s101
  v_mfma_f32_16x16x32_bf16 v[252:255], v[68:71], v[36:39], v[252:255]
  s_waitcnt lgkmcnt(7)
  v_mfma_f32_16x16x32_bf16 v[128:131], v[40:43], v[24:27], v[128:131]
  ds_read_b128 v[32:35], v8 offset:36864
  s_waitcnt lgkmcnt(6)
  v_mfma_f32_16x16x32_bf16 v[132:135], v[44:47], v[24:27], v[132:135]
  ds_read_b128 v[36:39], v8 offset:38912
  s_waitcnt lgkmcnt(4)
  v_mfma_f32_16x16x32_bf16 v[136:139], v[48:51], v[24:27], v[136:139]
  s_waitcnt lgkmcnt(2)
  v_mfma_f32_16x16x32_bf16 v[140:143], v[52:55], v[24:27], v[140:143]
  v_mfma_f32_16x16x32_bf16 v[144:147], v[40:43], v[28:31], v[144:147]
  ds_read_b128 v[24:27], v8 offset:40960
  v_mfma_f32_16x16x32_bf16 v[148:151], v[44:47], v[28:31], v[148:151]
  v_mfma_f32_16x16x32_bf16 v[152:155], v[48:51], v[28:31], v[152:155]
  v_mfma_f32_16x16x32_bf16 v[156:159], v[52:55], v[28:31], v[156:159]
  s_waitcnt lgkmcnt(2)
  v_mfma_f32_16x16x32_bf16 v[160:163], v[40:43], v[32:35], v[160:163]
  ds_read_b128 v[28:31], v8 offset:43008
  v_mfma_f32_16x16x32_bf16 v[164:167], v[44:47], v[32:35], v[164:167]
  v_mfma_f32_16x16x32_bf16 v[168:171], v[48:51], v[32:35], v[168:171]
  v_mfma_f32_16x16x32_bf16 v[172:175], v[52:55], v[32:35], v[172:175]
  s_waitcnt lgkmcnt(2)
  v_mfma_f32_16x16x32_bf16 v[176:179], v[40:43], v[36:39], v[176:179]
  ds_read_b128 v[32:35], v8 offset:45056
  v_mfma_f32_16x16x32_bf16 v[180:183], v[44:47], v[36:39], v[180:183]
  v_mfma_f32_16x16x32_bf16 v[184:187], v[48:51], v[36:39], v[184:187]
  v_mfma_f32_16x16x32_bf16 v[188:191], v[52:55], v[36:39], v[188:191]
  s_waitcnt lgkmcnt(2)
  v_mfma_f32_16x16x32_bf16 v[192:195], v[40:43], v[24:27], v[192:195]
  ds_read_b128 v[36:39], v8 offset:47104
  v_mfma_f32_16x16x32_bf16 v[196:199], v[44:47], v[24:27], v[196:199]
  v_mfma_f32_16x16x32_bf16 v[200:203], v[48:51], v[24:27], v[200:203]
  v_mfma_f32_16x16x32_bf16 v[204:207], v[52:55], v[24:27], v[204:207]
  s_waitcnt lgkmcnt(2)
  v_mfma_f32_16x16x32_bf16 v[208:211], v[40:43], v[28:31], v[208:211]
  v_mfma_f32_16x16x32_bf16 v[212:215], v[44:47], v[28:31], v[212:215]
  v_mfma_f32_16x16x32_bf16 v[216:219], v[48:51], v[28:31], v[216:219]
  v_mfma_f32_16x16x32_bf16 v[220:223], v[52:55], v[28:31], v[220:223]
  s_waitcnt vmcnt(13) lgkmcnt(0)
  s_barrier
  v_mfma_f32_16x16x32_bf16 v[224:227], v[40:43], v[32:35], v[224:227]
  ds_read_b128 v[24:27], v15 offset:32768
  ds_read_b64_tr_b16 v[56:57], v9 offset:49152
  s_mov_b32 m0, s86
  s_add_u32 s86, s86, 16384
  buffer_load_dwordx4 v18, s[40:43], s57 offen sc1 lds
  v_mfma_f32_16x16x32_bf16 v[228:231], v[44:47], v[32:35], v[228:231]
  ds_read_b64_tr_b16 v[58:59], v9 offset:51200
  ds_read_b64_tr_b16 v[60:61], v10 offset:49152
  buffer_load_dwordx4 v19, s[40:43], s57 offen offset:1024 sc1 lds
  s_and_b32 s86, s86, 0xffff
  s_add_u32 s57, s57, s58
  v_mfma_f32_16x16x32_bf16 v[232:235], v[48:51], v[32:35], v[232:235]
  ds_read_b64_tr_b16 v[62:63], v10 offset:51200
  v_mfma_f32_16x16x32_bf16 v[236:239], v[52:55], v[32:35], v[236:239]
  ds_read_b128 v[28:31], v15 offset:34816
  ds_read_b64_tr_b16 v[64:65], v11 offset:49152
  s_mov_b32 m0, s60
  s_add_u32 s60, s60, 30720
  buffer_load_dwordx4 v16, s[44:47], s56 offen lds
  v_mfma_f32_16x16x32_bf16 v[240:243], v[40:43], v[36:39], v[240:243]
  ds_read_b64_tr_b16 v[66:67], v11 offset:51200
  ds_read_b64_tr_b16 v[68:69], v12 offset:49152
  buffer_load_dwordx4 v17, s[44:47], s56 offen offset:1024 lds
  s_add_u32 s56, s56, s87
  s_cmp_ge_u32 s60, 163840
  s_cselect_b32 s60, s88, s60
  v_mfma_f32_16x16x32_bf16 v[244:247], v[44:47], v[36:39], v[244:247]
  ds_read_b64_tr_b16 v[70:71], v12 offset:51200
  v_mfma_f32_16x16x32_bf16 v[248:251], v[48:51], v[36:39], v[248:251]
  buffer_load_dword v4, v6, s[96:99], s100 offen
  s_add_u32 s100, s100, s101
  v_mfma_f32_16x16x32_bf16 v[252:255], v[52:55], v[36:39], v[252:255]
  s_waitcnt lgkmcnt(7)
  v_mfma_f32_16x16x32_bf16 v[128:131], v[56:59], v[24:27], v[128:131]
  ds_read_b128 v[32:35], v15 offset:36864
  s_waitcnt lgkmcnt(6)
  v_mfma_f32_16x16x32_bf16 v[132:135], v[60:63], v[24:27], v[132:135]
  ds_read_b128 v[36:39], v15 offset:38912
  s_waitcnt lgkmcnt(4)
  v_mfma_f32_16x16x32_bf16 v[136:139], v[64:67], v[24:27], v[136:139]
  s_waitcnt lgkmcnt(2)
  v_mfma_f32_16x16x32_bf16 v[140:143], v[68:71], v[24:27], v[140:143]
  v_mfma_f32_16x16x32_bf16 v[144:147], v[56:59], v[28:31], v[144:147]
  ds_read_b128 v[24:27], v15 offset:40960
  v_mfma_f32_16x16x32_bf16 v[148:151], v[60:63], v[28:31], v[148:151]
  v_mfma_f32_16x16x32_bf16 v[152:155], v[64:67], v[28:31], v[152:155]
  v_mfma_f32_16x16x32_bf16 v[156:159], v[68:71], v[28:31], v[156:159]
  s_waitcnt lgkmcnt(2)
  v_mfma_f32_16x16x32_bf16 v[160:163], v[56:59], v[32:35], v[160:163]
  ds_read_b128 v[28:31], v15 offset:43008
  v_mfma_f32_16x16x32_bf16 v[164:167], v[60:63], v[32:35], v[164:167]
  v_mfma_f32_16x16x32_bf16 v[168:171], v[64:67], v[32:35], v[168:171]
  v_mfma_f32_16x16x32_bf16 v[172:175], v[68:71], v[32:35], v[172:175]
  s_waitcnt lgkmcnt(2)
  v_mfma_f32_16x16x32_bf16 v[176:179], v[56:59], v[36:39], v[176:179]
  ds_read_b128 v[32:35], v15 offset:45056
  v_mfma_f32_16x16x32_bf16 v[180:183], v[60:63], v[36:39], v[180:183]
  v_mfma_f32_16x16x32_bf16 v[184:187], v[64:67], v[36:39], v[184:187]
  v_mfma_f32_16x16x32_bf16 v[188:191], v[68:71], v[36:39], v[188:191]
  s_waitcnt lgkmcnt(2)
  v_mfma_f32_16x16x32_bf16 v[192:195], v[56:59], v[24:27], v[192:195]
  ds_read_b128 v[36:39], v15 offset:47104
  v_mfma_f32_16x16x32_bf16 v[196:199], v[60:63], v[24:27], v[196:199]
  v_mfma_f32_16x16x32_bf16 v[200:203], v[64:67], v[24:27], v[200:203]
  v_mfma_f32_16x16x32_bf16 v[204:207], v[68:71], v[24:27], v[204:207]
  s_waitcnt lgkmcnt(2)
  v_mfma_f32_16x16x32_bf16 v[208:211], v[56:59], v[28:31], v[208:211]
  v_mfma_f32_16x16x32_bf16 v[212:215], v[60:63], v[28:31], v[212:215]
  v_mfma_f32_16x16x32_bf16 v[216:219], v[64:67], v[28:31], v[216:219]
  v_mfma_f32_16x16x32_bf16 v[220:223], v[68:71], v[28:31], v[220:223]
  s_waitcnt vmcnt(13) lgkmcnt(0)
  s_barrier
  v_mfma_f32_16x16x32_bf16 v[224:227], v[56:59], v[32:35], v[224:227]
  ds_read_b128 v[24:27], v122 offset:0
  ds_read_b64_tr_b16 v[40:41], v124 offset:0
  s_mov_b32 m0, s86
  s_add_u32 s86, s86, 16384
  buffer_load_dwordx4 v18, s[40:43], s57 offen sc1 lds
  v_mfma_f32_16x16x32_bf16 v[228:231], v[60:63], v[32:35], v[228:231]
  ds_read_b64_tr_b16 v[42:43], v124 offset:1024
  ds_read_b64_tr_b16 v[44:45], v125 offset:0
  buffer_load_dwordx4 v19, s[40:43], s57 offen offset:1024 sc1 lds
  s_and_b32 s86, s86, 0xffff
  s_add_u32 s57, s57, s58
  v_mfma_f32_16x16x32_bf16 v[232:235], v[64:67], v[32:35], v[232:235]
  ds_read_b64_tr_b16 v[46:47], v125 offset:1024
  v_mfma_f32_16x16x32_bf16 v[236:239], v[68:71], v[32:35], v[236:239]
  ds_read_b64_tr_b16 v[48:49], v126 offset:0
  ds_read_b64_tr_b16 v[50:51], v126 offset:1024
  s_mov_b32 m0, s60
  s_add_u32 s60, s60, 2048
  buffer_load_dwordx4 v16, s[44:47], s56 offen lds
  v_mfma_f32_16x16x32_bf16 v[240:243], v[56:59], v[36:39], v[240:243]
  ds_read_b64_tr_b16 v[52:53], v127 offset:0
  ds_read_b64_tr_b16 v[54:55], v127 offset:1024
  buffer_load_dwordx4 v17, s[44:47], s56 offen offset:1024 lds
  s_add_u32 s56, s56, s84
  v_mfma_f32_16x16x32_bf16 v[244:247], v[60:63], v[36:39], v[244:247]
  ds_read_b128 v[28:31], v122 offset:4096
  v_mfma_f32_16x16x32_bf16 v[248:251], v[64:67], v[36:39], v[248:251]
  buffer_load_dword v4, v6, s[96:99], s100 offen
  s_add_u32 s100, s100, s101
  v_mfma_f32_16x16x32_bf16 v[252:255], v[68:71], v[36:39], v[252:255]
  s_branch K1_EPI1
K1_LOOPV:
  s_waitcnt lgkmcnt(7)
  v_mfma_f32_16x16x32_bf16 v[128:131], v[24:27], v[40:43], 0
  ds_read_b128 v[32:35], v8 offset:4096
  s_waitcnt lgkmcnt(6)
  v_mfma_f32_16x16x32_bf16 v[136:139], v[24:27], v[44:47], 0
  ds_read_b128 v[36:39], v8 offset:6144
  s_waitcnt lgkmcnt(5)
  v_mfma_f32_16x16x32_bf16 v[144:147], v[24:27], v[48:51], 0
  s_waitcnt lgkmcnt(3)
  v_mfma_f32_16x16x32_bf16 v[152:155], v[24:27], v[52:55], 0
  s_waitcnt lgkmcnt(2)
  v_mfma_f32_16x16x32_bf16 v[132:135], v[28:31], v[40:43], 0
  ds_read_b128 v[24:27], v8 offset:8192
  v_mfma_f32_16x16x32_bf16 v[140:143], v[28:31], v[44:47], 0
  v_mfma_f32_16x16x32_bf16 v[148:151], v[28:31], v[48:51], 0
  v_mfma_f32_16x16x32_bf16 v[156:159], v[28:31], v[52:55], 0
  s_waitcnt lgkmcnt(2)
  v_mfma_f32_16x16x32_bf16 v[160:163], v[32:35], v[40:43], 0
  ds_read_b128 v[28:31], v8 offset:10240
  v_mfma_f32_16x16x32_bf16 v[168:171], v[32:35], v[44:47], 0
  v_mfma_f32_16x16x32_bf16 v[176:179], v[32:35], v[48:51], 0
  v_mfma_f32_16x16x32_bf16 v[184:187], v[32:35], v[52:55], 0
  s_waitcnt lgkmcnt(2)
  v_mfma_f32_16x16x32_bf16 v[164:167], v[36:39], v[40:43], 0
  ds_read_b128 v[32:35], v8 offset:12288
  v_mfma_f32_16x16x32_bf16 v[172:175], v[36:39], v[44:47], 0
  v_mfma_f32_16x16x32_bf16 v[180:183], v[36:39], v[48:51], 0
  v_mfma_f32_16x16x32_bf16 v[188:191], v[36:39], v[52:55], 0
  s_waitcnt lgkmcnt(2)
  v_mfma_f32_16x16x32_bf16 v[192:195], v[24:27], v[40:43], 0
  ds_read_b128 v[36:39], v8 offset:14336
  v_mfma_f32_16x16x32_bf16 v[200:203], v[24:27], v[44:47], 0
  v_mfma_f32_16x16x32_bf16 v[208:211], v[24:27], v[48:51], 0
  v_mfma_f32_16x16x32_bf16 v[216:219], v[24:27], v[52:55], 0
  s_waitcnt lgkmcnt(2)
  v_mfma_f32_16x16x32_bf16 v[196:199], v[28:31], v[40:43], 0
  v_mfma_f32_16x16x32_bf16 v[204:207], v[28:31], v[44:47], 0
  v_mfma_f32_16x16x32_bf16 v[212:215], v[28:31], v[48:51], 0
  v_mfma_f32_16x16x32_bf16 v[220:223], v[28:31], v[52:55], 0
  s_waitcnt vmcnt(12) lgkmcnt(0)
  s_barrier
  v_mfma_f32_16x16x32_bf16 v[224:227], v[32:35], v[40:43], 0
  ds_read_b128 v[24:27], v15 offset:0
  ds_read_b64_tr_b16 v[56:57], v9 offset:16384
  s_mov_b32 m0, s86
  s_add_u32 s86, s86, 16384
  buffer_load_dwordx4 v18, s[40:43], s57 offen nt lds
  v_mfma_f32_16x16x32_bf16 v[232:235], v[32:35], v[44:47], 0
  ds_read_b64_tr_b16 v[58:59], v9 offset:18432
  ds_read_b64_tr_b16 v[60:61], v10 offset:16384
  buffer_load_dwordx4 v19, s[40:43], s57 offen offset:1024 nt lds
  s_and_b32 s86, s86, 0xffff
  s_add_u32 s57, s57, s58
  v_mfma_f32_16x16x32_bf16 v[240:243], v[32:35], v[48:51], 0
  ds_read_b64_tr_b16 v[62:63], v10 offset:18432
  v_mfma_f32_16x16x32_bf16 v[248:251], v[32:35], v[52:55], 0
  ds_read_b128 v[28:31], v15 offset:2048
  ds_read_b64_tr_b16 v[64:65], v11 offset:16384
  s_mov_b32 m0, s60
  s_add_u32 s60, s60, 30720
  buffer_load_dwordx4 v16, s[44:47], s56 offen lds
  v_mfma_f32_16x16x32_bf16 v[228:231], v[36:39], v[40:43], 0
  ds_read_b64_tr_b16 v[66:67], v11 offset:18432
  ds_read_b64_tr_b16 v[68:69], v12 offset:16384
  buffer_load_dwordx4 v17, s[44:47], s56 offen offset:1024 lds
  s_add_u32 s56, s56, s87
  s_cmp_ge_u32 s60, 163840
  s_cselect_b32 s60, s88, s60
  v_mfma_f32_16x16x32_bf16 v[236:239], v[36:39], v[44:47], 0
  ds_read_b64_tr_b16 v[70:71], v12 offset:18432
  v_mfma_f32_16x16x32_bf16 v[244:247], v[36:39], v[48:51], 0
  v_mfma_f32_16x16x32_bf16 v[252:255], v[36:39], v[52:55], 0
  s_waitcnt lgkmcnt(7)
  v_mfma_f32_16x16x32_bf16 v[128:131], v[24:27], v[56:59], v[128:131]
  ds_read_b128 v[32:35], v15 offset:4096
  s_waitcnt lgkmcnt(6)
  v_mfma_f32_16x16x32_bf16 v[136:139], v[24:27], v[60:63], v[136:139]
  ds_read_b128 v[36:39], v15 offset:6144
  s_waitcnt lgkmcnt(4)
  v_mfma_f32_16x16x32_bf16 v[144:147], v[24:27], v[64:67], v[144:147]
  s_waitcnt lgkmcnt(2)
  v_mfma_f32_16x16x32_bf16 v[152:155], v[24:27], v[68:71], v[152:155]
  v_mfma_f32_16x16x32_bf16 v[132:135], v[28:31], v[56:59], v[132:135]
  ds_read_b128 v[24:27], v15 offset:8192
  v_mfma_f32_16x16x32_bf16 v[140:143], v[28:31], v[60:63], v[140:143]
  v_mfma_f32_16x16x32_bf16 v[148:151], v[28:31], v[64:67], v[148:151]
  buffer_load_dwordx4 v[72:75], v84, s[68:71], s59 offen
  v_mfma_f32_16x16x32_bf16 v[156:159], v[28:31], v[68:71], v[156:159]
  s_waitcnt lgkmcnt(2)
  v_mfma_f32_16x16x32_bf16 v[160:163], v[32:35], v[56:59], v[160:163]
  ds_read_b128 v[28:31], v15 offset:10240
  v_mfma_f32_16x16x32_bf16 v[168:171], v[32:35], v[60:63], v[168:171]
  v_mfma_f32_16x16x32_bf16 v[176:179], v[32:35], v[64:67], v[176:179]
  v_mfma_f32_16x16x32_bf16 v[184:187], v[32:35], v[68:71], v[184:187]
  buffer_load_dwordx4 v[76:79], v85, s[72:75], s62 offen
  s_waitcnt lgkmcnt(2)
  v_mfma_f32_16x16x32_bf16 v[164:167], v[36:39], v[56:59], v[164:167]
  ds_read_b128 v[32:35], v15 offset:12288
  v_mfma_f32_16x16x32_bf16 v[172:175], v[36:39], v[60:63], v[172:175]
  v_mfma_f32_16x16x32_bf16 v[180:183], v[36:39], v[64:67], v[180:183]
  v_mfma_f32_16x16x32_bf16 v[188:191], v[36:39], v[68:71], v[188:191]
  s_waitcnt lgkmcnt(2)
  v_mfma_f32_16x16x32_bf16 v[192:195], v[24:27], v[56:59], v[192:195]
  ds_read_b128 v[36:39], v15 offset:14336
  v_mfma_f32_16x16x32_bf16 v[200:203], v[24:27], v[60:63], v[200:203]
  v_mfma_f32_16x16x32_bf16 v[208:211], v[24:27], v[64:67], v[208:211]
  v_mfma_f32_16x16x32_bf16 v[216:219], v[24:27], v[68:71], v[216:219]
  s_waitcnt lgkmcnt(2)
  v_mfma_f32_16x16x32_bf16 v[196:199], v[28:31], v[56:59], v[196:199]
  v_mfma_f32_16x16x32_bf16 v[204:207], v[28:31], v[60:63], v[204:207]
  v_mfma_f32_16x16x32_bf16 v[212:215], v[28:31], v[64:67], v[212:215]
  v_mfma_f32_16x16x32_bf16 v[220:223], v[28:31], v[68:71], v[220:223]
  s_waitcnt vmcnt(12) lgkmcnt(0)
  s_barrier
  v_mfma_f32_16x16x32_bf16 v[224:227], v[32:35], v[56:59], v[224:227]
  ds_read_b128 v[24:27], v8 offset:32768
  ds_read_b64_tr_b16 v[40:41], v9 offset:32768
  s_mov_b32 m0, s86
  s_add_u32 s86, s86, 16384
  buffer_load_dwordx4 v18, s[40:43], s57 offen nt lds
  v_mfma_f32_16x16x32_bf16 v[232:235], v[32:35], v[60:63], v[232:235]
  ds_read_b64_tr_b16 v[42:43], v9 offset:34816
  ds_read_b64_tr_b16 v[44:45], v10 offset:32768
  buffer_load_dwordx4 v19, s[40:43], s57 offen offset:1024 nt lds
  s_and_b32 s86, s86, 0xffff
  s_add_u32 s57, s57, s58
  v_mfma_f32_16x16x32_bf16 v[240:243], v[32:35], v[64:67], v[240:243]
  ds_read_b64_tr_b16 v[46:47], v10 offset:34816
  v_mfma_f32_16x16x32_bf16 v[248:251], v[32:35], v[68:71], v[248:251]
  ds_read_b128 v[28:31], v8 offset:34816
  ds_read_b64_tr_b16 v[48:49], v11 offset:32768
  s_mov_b32 m0, s60
  s_add_u32 s60, s60, 2048
  buffer_load_dwordx4 v16, s[44:47], s56 offen lds
  v_mfma_f32_16x16x32_bf16 v[228:231], v[36:39], v[56:59], v[228:231]
  ds_read_b64_tr_b16 v[50:51], v11 offset:34816
  ds_read_b64_tr_b16 v[52:53], v12 offset:32768
  buffer_load_dwordx4 v17, s[44:47], s56 offen offset:1024 lds
  s_add_u32 s56, s56, s84
  v_mfma_f32_16x16x32_bf16 v[236:239], v[36:39], v[60:63], v[236:239]
  ds_read_b64_tr_b16 v[54:55], v12 offset:34816
  v_mfma_f32_16x16x32_bf16 v[244:247], v[36:39], v[64:67], v[244:247]
  v_mfma_f32_16x16x32_bf16 v[252:255], v[36:39], v[68:71], v[252:255]
  s_waitcnt lgkmcnt(7)
  v_mfma_f32_16x16x32_bf16 v[128:131], v[24:27], v[40:43], v[128:131]
  ds_read_b128 v[32:35], v8 offset:36864
  s_waitcnt lgkmcnt(6)
  v_mfma_f32_16x16x32_bf16 v[136:139], v[24:27], v[44:47], v[136:139]
  ds_read_b128 v[36:39], v8 offset:38912
  s_waitcnt lgkmcnt(4)
  v_mfma_f32_16x16x32_bf16 v[144:147], v[24:27], v[48:51], v[144:147]
  s_waitcnt lgkmcnt(2)
  v_mfma_f32_16x16x32_bf16 v[152:155], v[24:27], v[52:55], v[152:155]
  v_mfma_f32_16x16x32_bf16 v[132:135], v[28:31], v[40:43], v[132:135]
  ds_read_b128 v[24:27], v8 offset:40960
  v_mfma_f32_16x16x32_bf16 v[140:143], v[28:31], v[44:47], v[140:143]
  v_mfma_f32_16x16x32_bf16 v[148:151], v[28:31], v[48:51], v[148:151]
  s_cmp_lt_u32 s3, 4
  s_cbranch_scc0 K1_LOOPV_e3
  buffer_load_dwordx4 v[80:83], v86, s[76:79], s81 offen
K1_LOOPV_e3:
  v_mfma_f32_16x16x32_bf16 v[156:159], v[28:31], v[52:55], v[156:159]
  s_waitcnt lgkmcnt(2)
  v_mfma_f32_16x16x32_bf16 v[160:163], v[32:35], v[40:43], v[160:163]
  ds_read_b128 v[28:31], v8 offset:43008
  v_mfma_f32_16x16x32_bf16 v[168:171], v[32:35], v[44:47], v[168:171]
  v_mfma_f32_16x16x32_bf16 v[176:179], v[32:35], v[48:51], v[176:179]
  v_mfma_f32_16x16x32_bf16 v[184:187], v[32:35], v[52:55], v[184:187]
  s_waitcnt lgkmcnt(2)
  v_mfma_f32_16x16x32_bf16 v[164:167], v[36:39], v[40:43], v[164:167]
  ds_read_b128 v[32:35], v8 offset:45056
  v_mfma_f32_16x16x32_bf16 v[172:175], v[36:39], v[44:47], v[172:175]
  v_mfma_f32_16x16x32_bf16 v[180:183], v[36:39], v[48:51], v[180:183]
  v_mfma_f32_16x16x32_bf16 v[188:191], v[36:39], v[52:55], v[188:191]
  s_waitcnt lgkmcnt(2)
  v_mfma_f32_16x16x32_bf16 v[192:195], v[24:27], v[40:43], v[192:195]
  ds_read_b128 v[36:39], v8 offset:47104
  v_mfma_f32_16x16x32_bf16 v[200:203], v[24:27], v[44:47], v[200:203]
  v_mfma_f32_16x16x32_bf16 v[208:211], v[24:27], v[48:51], v[208:211]
  v_mfma_f32_16x16x32_bf16 v[216:219], v[24:27], v[52:55], v[216:219]
  s_waitcnt lgkmcnt(2)
  v_mfma_f32_16x16x32_bf16 v[196:199], v[28:31], v[40:43], v[196:199]
  v_mfma_f32_16x16x32_bf16 v[204:207], v[28:31], v[44:47], v[204:207]
  v_mfma_f32_16x16x32_bf16 v[212:215], v[28:31], v[48:51], v[212:215]
  v_mfma_f32_16x16x32_bf16 v[220:223], v[28:31], v[52:55], v[220:223]
  s_waitcnt vmcnt(14) lgkmcnt(0)
  s_barrier
  v_mfma_f32_16x16x32_bf16 v[224:227], v[32:35], v[40:43], v[224:227]
  ds_read_b128 v[24:27], v15 offset:32768
  ds_read_b64_tr_b16 v[56:57], v9 offset:49152
  s_mov_b32 m0, s86
  s_add_u32 s86, s86, 16384
  buffer_load_dwordx4 v18, s[40:43], s57 offen nt lds
  v_mfma_f32_16x16x32_bf16 v[232:235], v[32:35], v[44:47], v[232:235]
  ds_read_b64_tr_b16 v[58:59], v9 offset:51200
  ds_read_b64_tr_b16 v[60:61], v10 offset:49152
  buffer_load_dwordx4 v19, s[40:43], s57 offen offset:1024 nt lds
  s_and_b32 s86, s86, 0xffff
  s_add_u32 s57, s57, s58
  v_mfma_f32_16x16x32_bf16 v[240:243], v[32:35], v[48:51], v[240:243]
  ds_read_b64_tr_b16 v[62:63], v10 offset:51200
  v_mfma_f32_16x16x32_bf16 v[248:251], v[32:35], v[52:55], v[248:251]
  ds_read_b128 v[28:31], v15 offset:34816
  ds_read_b64_tr_b16 v[64:65], v11 offset:49152
  s_mov_b32 m0, s60
  s_add_u32 s60, s60, 30720
  buffer_load_dwordx4 v16, s[44:47], s56 offen lds
  v_mfma_f32_16x16x32_bf16 v[228:231], v[36:39], v[40:43], v[228:231]
  ds_read_b64_tr_b16 v[66:67], v11 offset:51200
  ds_read_b64_tr_b16 v[68:69], v12 offset:49152
  buffer_load_dwordx4 v17, s[44:47], s56 offen offset:1024 lds
  s_add_u32 s56, s56, s87
  s_cmp_ge_u32 s60, 163840
  s_cselect_b32 s60, s88, s60
  v_mfma_f32_16x16x32_bf16 v[236:239], v[36:39], v[44:47], v[236:239]
  ds_read_b64_tr_b16 v[70:71], v12 offset:51200
  v_mfma_f32_16x16x32_bf16 v[244:247], v[36:39], v[48:51], v[244:247]
  buffer_load_dword v4, v6, s[96:99], s100 offen
  s_add_u32 s100, s100, s101
  v_mfma_f32_16x16x32_bf16 v[252:255], v[36:39], v[52:55], v[252:255]
  s_waitcnt lgkmcnt(7)
  v_mfma_f32_16x16x32_bf16 v[128:131], v[24:27], v[56:59], v[128:131]
  ds_read_b128 v[32:35], v15 offset:36864
  s_waitcnt lgkmcnt(6)
  v_mfma_f32_16x16x32_bf16 v[136:139], v[24:27], v[60:63], v[136:139]
  ds_read_b128 v[36:39], v15 offset:38912
  s_waitcnt lgkmcnt(4)
  v_mfma_f32_16x16x32_bf16 v[144:147], v[24:27], v[64:67], v[144:147]
  s_waitcnt lgkmcnt(2)
  v_mfma_f32_16x16x32_bf16 v[152:155], v[24:27], v[68:71], v[152:155]
  v_mfma_f32_16x16x32_bf16 v[132:135], v[28:31], v[56:59], v[132:135]
  ds_read_b128 v[24:27], v15 offset:40960
  v_mfma_f32_16x16x32_bf16 v[140:143], v[28:31], v[60:63], v[140:143]
  v_mfma_f32_16x16x32_bf16 v[148:151], v[28:31], v[64:67], v[148:151]
  v_mfma_f32_16x16x32_bf16 v[156:159], v[28:31], v[68:71], v[156:159]
  s_waitcnt lgkmcnt(2)
  v_mfma_f32_16x16x32_bf16 v[160:163], v[32:35], v[56:59], v[160:163]
  ds_read_b128 v[28:31], v15 offset:43008
  v_mfma_f32_16x16x32_bf16 v[168:171], v[32:35], v[60:63], v[168:171]
  v_mfma_f32_16x16x32_bf16 v[176:179], v[32:35], v[64:67], v[176:179]
  v_mfma_f32_16x16x32_bf16 v[184:187], v[32:35], v[68:71], v[184:187]
  s_waitcnt lgkmcnt(2)
  v_mfma_f32_16x16x32_bf16 v[164:167], v[36:39], v[56:59], v[164:167]
  ds_read_b128 v[32:35], v15 offset:45056
  v_mfma_f32_16x16x32_bf16 v[172:175], v[36:39], v[60:63], v[172:175]
  v_mfma_f32_16x16x32_bf16 v[180:183], v[36:39], v[64:67], v[180:183]
  v_mfma_f32_16x16x32_bf16 v[188:191], v[36:39], v[68:71], v[188:191]
  s_waitcnt lgkmcnt(2)
  v_mfma_f32_16x16x32_bf16 v[192:195], v[24:27], v[56:59], v[192:195]
  ds_read_b128 v[36:39], v15 offset:47104
  v_mfma_f32_16x16x32_bf16 v[200:203], v[24:27], v[60:63], v[200:203]
  v_mfma_f32_16x16x32_bf16 v[208:211], v[24:27], v[64:67], v[208:211]
  v_mfma_f32_16x16x32_bf16 v[216:219], v[24:27], v[68:71], v[216:219]
  s_waitcnt lgkmcnt(2)
  v_mfma_f32_16x16x32_bf16 v[196:199], v[28:31], v[56:59], v[196:199]
  v_mfma_f32_16x16x32_bf16 v[204:207], v[28:31], v[60:63], v[204:207]
  v_mfma_f32_16x16x32_bf16 v[212:215], v[28:31], v[64:67], v[212:215]
  v_mfma_f32_16x16x32_bf16 v[220:223], v[28:31], v[68:71], v[220:223]
  s_waitcnt vmcnt(11) lgkmcnt(0)
  s_barrier
  v_mfma_f32_16x16x32_bf16 v[224:227], v[32:35], v[56:59], v[224:227]
  ds_read_b128 v[24:27], v13 offset:0
  ds_read_b64_tr_b16 v[40:41], v9 offset:0
  s_mov_b32 m0, s86
  s_add_u32 s86, s86, 16384
  buffer_load_dwordx4 v18, s[40:43], s57 offen nt lds
  v_mfma_f32_16x16x32_bf16 v[232:235], v[32:35], v[60:63], v[232:235]
  ds_read_b64_tr_b16 v[42:43], v9 offset:2048
  ds_read_b64_tr_b16 v[44:45], v10 offset:0
  buffer_load_dwordx4 v19, s[40:43], s57 offen offset:1024 nt lds
  s_and_b32 s86, s86, 0xffff
  s_add_u32 s57, s57, s58
  v_mfma_f32_16x16x32_bf16 v[240:243], v[32:35], v[64:67], v[240:243]
  ds_read_b64_tr_b16 v[46:47], v10 offset:2048
  v_mfma_f32_16x16x32_bf16 v[248:251], v[32:35], v[68:71], v[248:251]
  ds_read_b128 v[28:31], v13 offset:2048
  ds_read_b64_tr_b16 v[48:49], v11 offset:0
  s_mov_b32 m0, s60
  s_add_u32 s60, s60, 2048
  buffer_load_dwordx4 v16, s[44:47], s56 offen lds
  v_mfma_f32_16x16x32_bf16 v[228:231], v[36:39], v[56:59], v[228:231]
  ds_read_b64_tr_b16 v[50:51], v11 offset:2048
  ds_read_b64_tr_b16 v[52:53], v12 offset:0
  buffer_load_dwordx4 v17, s[44:47], s56 offen offset:1024 lds
  s_add_u32 s56, s56, s84
  v_mfma_f32_16x16x32_bf16 v[236:239], v[36:39], v[60:63], v[236:239]
  ds_read_b64_tr_b16 v[54:55], v12 offset:2048
  v_mfma_f32_16x16x32_bf16 v[244:247], v[36:39], v[64:67], v[244:247]
  buffer_load_dword v4, v6, s[96:99], s100 offen
  s_add_u32 s100, s100, s101
  v_mfma_f32_16x16x32_bf16 v[252:255], v[36:39], v[68:71], v[252:255]
  s_waitcnt lgkmcnt(7)
  v_mfma_f32_16x16x32_bf16 v[128:131], v[24:27], v[40:43], v[128:131]
  ds_read_b128 v[32:35], v13 offset:4096
  s_waitcnt lgkmcnt(6)
  v_mfma_f32_16x16x32_bf16 v[136:139], v[24:27], v[44:47], v[136:139]
  ds_read_b128 v[36:39], v13 offset:6144
  s_waitcnt lgkmcnt(4)
  v_mfma_f32_16x16x32_bf16 v[144:147], v[24:27], v[48:51], v[144:147]
  s_waitcnt lgkmcnt(2)
  v_mfma_f32_16x16x32_bf16 v[152:155], v[24:27], v[52:55], v[152:155]
  v_mfma_f32_16x16x32_bf16 v[132:135], v[28:31], v[40:43], v[132:135]
  ds_read_b128 v[24:27], v13 offset:8192
  v_mfma_f32_16x16x32_bf16 v[140:143], v[28:31], v[44:47], v[140:143]
  v_mfma_f32_16x16x32_bf16 v[148:151], v[28:31], v[48:51], v[148:151]
  s_cmp_lg_u32 s17, 0
  s_cbranch_scc0 K1_LOOPV_EI
  s_mov_b64 exec, 1
  buffer_store_byte v91, off, s[28:31], s16 sc1
  s_mov_b64 exec, -1
K1_LOOPV_EI:
  v_mfma_f32_16x16x32_bf16 v[156:159], v[28:31], v[52:55], v[156:159]
  s_waitcnt lgkmcnt(2)
  v_mfma_f32_16x16x32_bf16 v[160:163], v[32:35], v[40:43], v[160:163]
  ds_read_b128 v[28:31], v13 offset:10240
  v_mfma_f32_16x16x32_bf16 v[168:171], v[32:35], v[44:47], v[168:171]
  v_mfma_f32_16x16x32_bf16 v[176:179], v[32:35], v[48:51], v[176:179]
  v_mfma_f32_16x16x32_bf16 v[184:187], v[32:35], v[52:55], v[184:187]
  s_waitcnt vmcnt(15)
  buffer_store_dwordx4 v[72:75], v2, s[36:39], s61 offen sc1
  s_waitcnt lgkmcnt(2)
  v_mfma_f32_16x16x32_bf16 v[164:167], v[36:39], v[40:43], v[164:167]
  ds_read_b128 v[32:35], v13 offset:12288
  v_mfma_f32_16x16x32_bf16 v[172:175], v[36:39], v[44:47], v[172:175]
  v_mfma_f32_16x16x32_bf16 v[180:183], v[36:39], v[48:51], v[180:183]
  v_mfma_f32_16x16x32_bf16 v[188:191], v[36:39], v[52:55], v[188:191]
  s_waitcnt lgkmcnt(2)
  v_mfma_f32_16x16x32_bf16 v[192:195], v[24:27], v[40:43], v[192:195]
  ds_read_b128 v[36:39], v13 offset:14336
  s_waitcnt vmcnt(15)
  buffer_store_dwordx4 v[76:79], v87, s[36:39], s63 offen sc1
  v_mfma_f32_16x16x32_bf16 v[200:203], v[24:27], v[44:47], v[200:203]
  v_mfma_f32_16x16x32_bf16 v[208:211], v[24:27], v[48:51], v[208:211]
  v_mfma_f32_16x16x32_bf16 v[216:219], v[24:27], v[52:55], v[216:219]
  s_waitcnt lgkmcnt(2)
  v_mfma_f32_16x16x32_bf16 v[196:199], v[28:31], v[40:43], v[196:199]
  v_mfma_f32_16x16x32_bf16 v[204:207], v[28:31], v[44:47], v[204:207]
  v_mfma_f32_16x16x32_bf16 v[212:215], v[28:31], v[48:51], v[212:215]
  v_mfma_f32_16x16x32_bf16 v[220:223], v[28:31], v[52:55], v[220:223]
  s_waitcnt vmcnt(14) lgkmcnt(0)
  s_barrier
  v_mfma_f32_16x16x32_bf16 v[224:227], v[32:35], v[40:43], v[224:227]
  ds_read_b128 v[24:27], v14 offset:0
  ds_read_b64_tr_b16 v[56:57], v9 offset:16384
  s_mov_b32 m0, s86
  s_add_u32 s86, s86, 16384
  buffer_load_dwordx4 v18, s[40:43], s57 offen nt lds
  v_mfma_f32_16x16x32_bf16 v[232:235], v[32:35], v[44:47], v[232:235]
  ds_read_b64_tr_b16 v[58:59], v9 offset:18432
  ds_read_b64_tr_b16 v[60:61], v10 offset:16384
  buffer_load_dwordx4 v19, s[40:43], s57 offen offset:1024 nt lds
  s_and_b32 s86, s86, 0xffff
  s_add_u32 s57, s57, s58
  v_mfma_f32_16x16x32_bf16 v[240:243], v[32:35], v[48:51], v[240:243]
  ds_read_b64_tr_b16 v[62:63], v10 offset:18432
  v_mfma_f32_16x16x32_bf16 v[248:251], v[32:35], v[52:55], v[248:251]
  ds_read_b128 v[28:31], v14 offset:2048
  ds_read_b64_tr_b16 v[64:65], v11 offset:16384
  s_mov_b32 m0, s60
  s_add_u32 s60, s60, 30720
  buffer_load_dwordx4 v16, s[44:47], s56 offen lds
  v_mfma_f32_16x16x32_bf16 v[228:231], v[36:39], v[40:43], v[228:231]
  ds_read_b64_tr_b16 v[66:67], v11 offset:18432
  ds_read_b64_tr_b16 v[68:69], v12 offset:16384
  buffer_load_dwordx4 v17, s[44:47], s56 offen offset:1024 lds
  s_add_u32 s56, s56, s87
  s_cmp_ge_u32 s60, 163840
  s_cselect_b32 s60, s88, s60
  v_mfma_f32_16x16x32_bf16 v[236:239], v[36:39], v[44:47], v[236:239]
  ds_read_b64_tr_b16 v[70:71], v12 offset:18432
  v_mfma_f32_16x16x32_bf16 v[244:247], v[36:39], v[48:51], v[244:247]
  buffer_load_dword v4, v6, s[96:99], s100 offen
  s_add_u32 s100, s100, s101
  v_mfma_f32_16x16x32_bf16 v[252:255], v[36:39], v[52:55], v[252:255]
  s_waitcnt lgkmcnt(7)
  v_mfma_f32_16x16x32_bf16 v[128:131], v[24:27], v[56:59], v[128:131]
  ds_read_b128 v[32:35], v14 offset:4096
  s_waitcnt lgkmcnt(6)
  v_mfma_f32_16x16x32_bf16 v[136:139], v[24:27], v[60:63], v[136:139]
  ds_read_b128 v[36:39], v14 offset:6144
  s_waitcnt lgkmcnt(4)
  v_mfma_f32_16x16x32_bf16 v[144:147], v[24:27], v[64:67], v[144:147]
  s_waitcnt lgkmcnt(2)
  v_mfma_f32_16x16x32_bf16 v[152:155], v[24:27], v[68:71], v[152:155]
  v_mfma_f32_16x16x32_bf16 v[132:135], v[28:31], v[56:59], v[132:135]
  ds_read_b128 v[24:27], v14 offset:8192
  v_mfma_f32_16x16x32_bf16 v[140:143], v[28:31], v[60:63], v[140:143]
  v_mfma_f32_16x16x32_bf16 v[148:151], v[28:31], v[64:67], v[148:151]
  s_cmp_lt_u32 s3, 4
  s_cbranch_scc0 K1_LOOPV_E3
  s_waitcnt vmcnt(17)
  buffer_store_dwordx4 v[80:83], v88, s[36:39], s82 offen sc1
K1_LOOPV_E3:
  v_mfma_f32_16x16x32_bf16 v[156:159], v[28:31], v[68:71], v[156:159]
  s_waitcnt lgkmcnt(2)
  v_mfma_f32_16x16x32_bf16 v[160:163], v[32:35], v[56:59], v[160:163]
  ds_read_b128 v[28:31], v14 offset:10240
  v_mfma_f32_16x16x32_bf16 v[168:171], v[32:35], v[60:63], v[168:171]
  v_mfma_f32_16x16x32_bf16 v[176:179], v[32:35], v[64:67], v[176:179]
  v_mfma_f32_16x16x32_bf16 v[184:187], v[32:35], v[68:71], v[184:187]
  s_waitcnt lgkmcnt(2)
  v_mfma_f32_16x16x32_bf16 v[164:167], v[36:39], v[56:59], v[164:167]
  ds_read_b128 v[32:35], v14 offset:12288
  v_mfma_f32_16x16x32_bf16 v[172:175], v[36:39], v[60:63], v[172:175]
  v_mfma_f32_16x16x32_bf16 v[180:183], v[36:39], v[64:67], v[180:183]
  v_mfma_f32_16x16x32_bf16 v[188:191], v[36:39], v[68:71], v[188:191]
  s_waitcnt lgkmcnt(2)
  v_mfma_f32_16x16x32_bf16 v[192:195], v[24:27], v[56:59], v[192:195]
  ds_read_b128 v[36:39], v14 offset:14336
  v_mfma_f32_16x16x32_bf16 v[200:203], v[24:27], v[60:63], v[200:203]
  v_mfma_f32_16x16x32_bf16 v[208:211], v[24:27], v[64:67], v[208:211]
  v_mfma_f32_16x16x32_bf16 v[216:219], v[24:27], v[68:71], v[216:219]
  s_waitcnt lgkmcnt(2)
  v_mfma_f32_16x16x32_bf16 v[196:199], v[28:31], v[56:59], v[196:199]
  v_mfma_f32_16x16x32_bf16 v[204:207], v[28:31], v[60:63], v[204:207]
  v_mfma_f32_16x16x32_bf16 v[212:215], v[28:31], v[64:67], v[212:215]
  v_mfma_f32_16x16x32_bf16 v[220:223], v[28:31], v[68:71], v[220:223]
  s_waitcnt vmcnt(13) lgkmcnt(0)
  s_barrier
  v_mfma_f32_16x16x32_bf16 v[224:227], v[32:35], v[56:59], v[224:227]
  ds_read_b128 v[24:27], v8 offset:0
  ds_read_b64_tr_b16 v[40:41], v9 offset:32768
  s_mov_b32 m0, s86
  s_add_u32 s86, s86, 16384
  buffer_load_dwordx4 v18, s[40:43], s57 offen nt lds
  v_mfma_f32_16x16x32_bf16 v[232:235], v[32:35], v[60:63], v[232:235]
  ds_read_b64_tr_b16 v[42:43], v9 offset:34816
  ds_read_b64_tr_b16 v[44:45], v10 offset:32768
  buffer_load_dwordx4 v19, s[40:43], s57 offen offset:1024 nt lds
  s_and_b32 s86, s86, 0xffff
  s_add_u32 s57, s57, s58
  v_mfma_f32_16x16x32_bf16 v[240:243], v[32:35], v[64:67], v[240:243]
  ds_read_b64_tr_b16 v[46:47], v10 offset:34816
  v_mfma_f32_16x16x32_bf16 v[248:251], v[32:35], v[68:71], v[248:251]
  ds_read_b128 v[28:31], v8 offset:2048
  ds_read_b64_tr_b16 v[48:49], v11 offset:32768
  s_mov_b32 m0, s60
  s_add_u32 s60, s60, 2048
  buffer_load_dwordx4 v16, s[44:47], s56 offen lds
  v_mfma_f32_16x16x32_bf16 v[228:231], v[36:39], v[56:59], v[228:231]
  ds_read_b64_tr_b16 v[50:51], v11 offset:34816
  ds_read_b64_tr_b16 v[52:53], v12 offset:32768
  buffer_load_dwordx4 v17, s[44:47], s56 offen offset:1024 lds
  s_add_u32 s56, s56, s84
  v_mfma_f32_16x16x32_bf16 v[236:239], v[36:39], v[60:63], v[236:239]
  ds_read_b64_tr_b16 v[54:55], v12 offset:34816
  v_mfma_f32_16x16x32_bf16 v[244:247], v[36:39], v[64:67], v[244:247]
  buffer_load_dword v4, v6, s[96:99], s100 offen
  s_add_u32 s100, s100, s101
  v_mfma_f32_16x16x32_bf16 v[252:255], v[36:39], v[68:71], v[252:255]
  s_waitcnt lgkmcnt(7)
  v_mfma_f32_16x16x32_bf16 v[128:131], v[24:27], v[40:43], v[128:131]
  ds_read_b128 v[32:35], v8 offset:4096
  s_waitcnt lgkmcnt(6)
  v_mfma_f32_16x16x32_bf16 v[136:139], v[24:27], v[44:47], v[136:139]
  ds_read_b128 v[36:39], v8 offset:6144
  s_waitcnt lgkmcnt(4)
  v_mfma_f32_16x16x32_bf16 v[144:147], v[24:27], v[48:51], v[144:147]
  s_waitcnt lgkmcnt(2)
  v_mfma_f32_16x16x32_bf16 v[152:155], v[24:27], v[52:55], v[152:155]
  v_mfma_f32_16x16x32_bf16 v[132:135], v[28:31], v[40:43], v[132:135]
  ds_read_b128 v[24:27], v8 offset:8192
  v_mfma_f32_16x16x32_bf16 v[140:143], v[28:31], v[44:47], v[140:143]
  v_mfma_f32_16x16x32_bf16 v[148:151], v[28:31], v[48:51], v[148:151]
  v_mfma_f32_16x16x32_bf16 v[156:159], v[28:31], v[52:55], v[156:159]
  s_waitcnt lgkmcnt(2)
  v_mfma_f32_16x16x32_bf16 v[160:163], v[32:35], v[40:43], v[160:163]
  ds_read_b128 v[28:31], v8 offset:10240
  v_mfma_f32_16x16x32_bf16 v[168:171], v[32:35], v[44:47], v[168:171]
  v_mfma_f32_16x16x32_bf16 v[176:179], v[32:35], v[48:51], v[176:179]
  v_mfma_f32_16x16x32_bf16 v[184:187], v[32:35], v[52:55], v[184:187]
  s_waitcnt lgkmcnt(2)
  v_mfma_f32_16x16x32_bf16 v[164:167], v[36:39], v[40:43], v[164:167]
  ds_read_b128 v[32:35], v8 offset:12288
  v_mfma_f32_16x16x32_bf16 v[172:175], v[36:39], v[44:47], v[172:175]
  v_mfma_f32_16x16x32_bf16 v[180:183], v[36:39], v[48:51], v[180:183]
  v_mfma_f32_16x16x32_bf16 v[188:191], v[36:39], v[52:55], v[188:191]
  s_waitcnt lgkmcnt(2)
  v_mfma_f32_16x16x32_bf16 v[192:195], v[24:27], v[40:43], v[192:195]
  ds_read_b128 v[36:39], v8 offset:14336
  v_mfma_f32_16x16x32_bf16 v[200:203], v[24:27], v[44:47], v[200:203]
  v_mfma_f32_16x16x32_bf16 v[208:211], v[24:27], v[48:51], v[208:211]
  v_mfma_f32_16x16x32_bf16 v[216:219], v[24:27], v[52:55], v[216:219]
  s_waitcnt lgkmcnt(2)
  v_mfma_f32_16x16x32_bf16 v[196:199], v[28:31], v[40:43], v[196:199]
  v_mfma_f32_16x16x32_bf16 v[204:207], v[28:31], v[44:47], v[204:207]
  v_mfma_f32_16x16x32_bf16 v[212:215], v[28:31], v[48:51], v[212:215]
  v_mfma_f32_16x16x32_bf16 v[220:223], v[28:31], v[52:55], v[220:223]
  s_waitcnt vmcnt(15) lgkmcnt(0)
  s_barrier
  v_mfma_f32_16x16x32_bf16 v[224:227], v[32:35], v[40:43], v[224:227]
  ds_read_b128 v[24:27], v15 offset:0
  ds_read_b64_tr_b16 v[56:57], v9 offset:49152
  s_mov_b32 m0, s86
  s_add_u32 s86, s86, 16384
  buffer_load_dwordx4 v18, s[40:43], s57 offen nt lds
  v_mfma_f32_16x16x32_bf16 v[232:235], v[32:35], v[44:47], v[232:235]
  ds_read_b64_tr_b16 v[58:59], v9 offset:51200
  ds_read_b64_tr_b16 v[60:61], v10 offset:49152
  buffer_load_dwordx4 v19, s[40:43], s57 offen offset:1024 nt lds
  s_and_b32 s86, s86, 0xffff
  s_add_u32 s57, s57, s58
  v_mfma_f32_16x16x32_bf16 v[240:243], v[32:35], v[48:51], v[240:243]
  ds_read_b64_tr_b16 v[62:63], v10 offset:51200
  v_mfma_f32_16x16x32_bf16 v[248:251], v[32:35], v[52:55], v[248:251]
  ds_read_b128 v[28:31], v15 offset:2048
  ds_read_b64_tr_b16 v[64:65], v11 offset:49152
  s_mov_b32 m0, s60
  s_add_u32 s60, s60, 30720
  buffer_load_dwordx4 v16, s[44:47], s56 offen lds
  v_mfma_f32_16x16x32_bf16 v[228:231], v[36:39], v[40:43], v[228:231]
  ds_read_b64_tr_b16 v[66:67], v11 offset:51200
  ds_read_b64_tr_b16 v[68:69], v12 offset:49152
  buffer_load_dwordx4 v17, s[44:47], s56 offen offset:1024 lds
  s_add_u32 s56, s56, s87
  s_cmp_ge_u32 s60, 163840
  s_cselect_b32 s60, s88, s60
  v_mfma_f32_16x16x32_bf16 v[236:239], v[36:39], v[44:47], v[236:239]
  ds_read_b64_tr_b16 v[70:71], v12 offset:51200
  v_mfma_f32_16x16x32_bf16 v[244:247], v[36:39], v[48:51], v[244:247]
  buffer_load_dword v4, v6, s[96:99], s100 offen
  s_add_u32 s100, s100, s101
  v_mfma_f32_16x16x32_bf16 v[252:255], v[36:39], v[52:55], v[252:255]
  s_waitcnt lgkmcnt(7)
  v_mfma_f32_16x16x32_bf16 v[128:131], v[24:27], v[56:59], v[128:131]
  ds_read_b128 v[32:35], v15 offset:4096
  s_waitcnt lgkmcnt(6)
  v_mfma_f32_16x16x32_bf16 v[136:139], v[24:27], v[60:63], v[136:139]
  ds_read_b128 v[36:39], v15 offset:6144
  s_waitcnt lgkmcnt(4)
  v_mfma_f32_16x16x32_bf16 v[144:147], v[24:27], v[64:67], v[144:147]
  s_waitcnt lgkmcnt(2)
  v_mfma_f32_16x16x32_bf16 v[152:155], v[24:27], v[68:71], v[152:155]
  v_mfma_f32_16x16x32_bf16 v[132:135], v[28:31], v[56:59], v[132:135]
  ds_read_b128 v[24:27], v15 offset:8192
  v_mfma_f32_16x16x32_bf16 v[140:143], v[28:31], v[60:63], v[140:143]
  v_mfma_f32_16x16x32_bf16 v[148:151], v[28:31], v[64:67], v[148:151]
  v_mfma_f32_16x16x32_bf16 v[156:159], v[28:31], v[68:71], v[156:159]
  s_waitcnt lgkmcnt(2)
  v_mfma_f32_16x16x32_bf16 v[160:163], v[32:35], v[56:59], v[160:163]
  ds_read_b128 v[28:31], v15 offset:10240
  v_mfma_f32_16x16x32_bf16 v[168:171], v[32:35], v[60:63], v[168:171]
  v_mfma_f32_16x16x32_bf16 v[176:179], v[32:35], v[64:67], v[176:179]
  v_mfma_f32_16x16x32_bf16 v[184:187], v[32:35], v[68:71], v[184:187]
  s_waitcnt lgkmcnt(2)
  v_mfma_f32_16x16x32_bf16 v[164:167], v[36:39], v[56:59], v[164:167]
  ds_read_b128 v[32:35], v15 offset:12288
  v_mfma_f32_16x16x32_bf16 v[172:175], v[36:39], v[60:63], v[172:175]
  v_mfma_f32_16x16x32_bf16 v[180:183], v[36:39], v[64:67], v[180:183]
  v_mfma_f32_16x16x32_bf16 v[188:191], v[36:39], v[68:71], v[188:191]
  s_waitcnt lgkmcnt(2)
  v_mfma_f32_16x16x32_bf16 v[192:195], v[24:27], v[56:59], v[192:195]
  ds_read_b128 v[36:39], v15 offset:14336
  v_mfma_f32_16x16x32_bf16 v[200:203], v[24:27], v[60:63], v[200:203]
  v_mfma_f32_16x16x32_bf16 v[208:211], v[24:27], v[64:67], v[208:211]
  v_mfma_f32_16x16x32_bf16 v[216:219], v[24:27], v[68:71], v[216:219]
  s_waitcnt lgkmcnt(2)
  v_mfma_f32_16x16x32_bf16 v[196:199], v[28:31], v[56:59], v[196:199]
  v_mfma_f32_16x16x32_bf16 v[204:207], v[28:31], v[60:63], v[204:207]
  v_mfma_f32_16x16x32_bf16 v[212:215], v[28:31], v[64:67], v[212:215]
  v_mfma_f32_16x16x32_bf16 v[220:223], v[28:31], v[68:71], v[220:223]
  s_waitcnt vmcnt(8) lgkmcnt(0)
  s_barrier
  v_mfma_f32_16x16x32_bf16 v[224:227], v[32:35], v[56:59], v[224:227]
  ds_read_b128 v[24:27], v8 offset:32768
  ds_read_b64_tr_b16 v[40:41], v9 offset:0
  s_mov_b32 m0, s86
  s_add_u32 s86, s86, 16384
  buffer_load_dwordx4 v18, s[40:43], s57 offen nt lds
  v_mfma_f32_16x16x32_bf16 v[232:235], v[32:35], v[60:63], v[232:235]
  ds_read_b64_tr_b16 v[42:43], v9 offset:2048
  ds_read_b64_tr_b16 v[44:45], v10 offset:0
  buffer_load_dwordx4 v19, s[40:43], s57 offen offset:1024 nt lds
  s_and_b32 s86, s86, 0xffff
  s_add_u32 s57, s57, s58
  v_mfma_f32_16x16x32_bf16 v[240:243], v[32:35], v[64:67], v[240:243]
  ds_read_b64_tr_b16 v[46:47], v10 offset:2048
  v_mfma_f32_16x16x32_bf16 v[248:251], v[32:35], v[68:71], v[248:251]
  ds_read_b128 v[28:31], v8 offset:34816
  ds_read_b64_tr_b16 v[48:49], v11 offset:0
  s_mov_b32 m0, s60
  s_add_u32 s60, s60, 2048
  buffer_load_dwordx4 v16, s[44:47], s56 offen lds
  v_mfma_f32_16x16x32_bf16 v[228:231], v[36:39], v[56:59], v[228:231]
  ds_read_b64_tr_b16 v[50:51], v11 offset:2048
  ds_read_b64_tr_b16 v[52:53], v12 offset:0
  buffer_load_dwordx4 v17, s[44:47], s56 offen offset:1024 lds
  s_add_u32 s56, s56, s84
  v_mfma_f32_16x16x32_bf16 v[236:239], v[36:39], v[60:63], v[236:239]
  ds_read_b64_tr_b16 v[54:55], v12 offset:2048
  v_mfma_f32_16x16x32_bf16 v[244:247], v[36:39], v[64:67], v[244:247]
  buffer_load_dword v4, v6, s[96:99], s100 offen
  s_add_u32 s100, s100, s101
  v_mfma_f32_16x16x32_bf16 v[252:255], v[36:39], v[68:71], v[252:255]
  s_waitcnt lgkmcnt(7)
  v_mfma_f32_16x16x32_bf16 v[128:131], v[24:27], v[40:43], v[128:131]
  ds_read_b128 v[32:35], v8 offset:36864
  s_waitcnt lgkmcnt(6)
  v_mfma_f32_16x16x32_bf16 v[136:139], v[24:27], v[44:47], v[136:139]
  ds_read_b128 v[36:39], v8 offset:38912
  s_waitcnt lgkmcnt(4)
  v_mfma_f32_16x16x32_bf16 v[144:147], v[24:27], v[48:51], v[144:147]
  s_waitcnt lgkmcnt(2)
  v_mfma_f32_16x16x32_bf16 v[152:155], v[24:27], v[52:55], v[152:155]
  v_mfma_f32_16x16x32_bf16 v[132:135], v[28:31], v[40:43], v[132:135]
  ds_read_b128 v[24:27], v8 offset:40960
  v_mfma_f32_16x16x32_bf16 v[140:143], v[28:31], v[44:47], v[140:143]
  v_mfma_f32_16x16x32_bf16 v[148:151], v[28:31], v[48:51], v[148:151]
  s_cmp_lg_u32 s17, 0
  s_cbranch_scc0 K1_LOOPV_EF
  s_mov_b64 exec, 1
  buffer_store_dword v91, off, s[36:39], s17 sc1
  s_mov_b64 exec, -1
K1_LOOPV_EF:
  v_mfma_f32_16x16x32_bf16 v[156:159], v[28:31], v[52:55], v[156:159]
  s_waitcnt lgkmcnt(2)
  v_mfma_f32_16x16x32_bf16 v[160:163], v[32:35], v[40:43], v[160:163]
  ds_read_b128 v[28:31], v8 offset:43008
  v_mfma_f32_16x16x32_bf16 v[168:171], v[32:35], v[44:47], v[168:171]
  v_mfma_f32_16x16x32_bf16 v[176:179], v[32:35], v[48:51], v[176:179]
  v_mfma_f32_16x16x32_bf16 v[184:187], v[32:35], v[52:55], v[184:187]
  s_cmp_eq_u32 s3, 0
  s_cbranch_scc0 K1_LOOPV_EQ
  buffer_load_ubyte v92, v89, s[28:31], 0 offen sc1
K1_LOOPV_EQ:
  s_waitcnt lgkmcnt(2)
  v_mfma_f32_16x16x32_bf16 v[164:167], v[36:39], v[40:43], v[164:167]
  ds_read_b128 v[32:35], v8 offset:45056
  v_mfma_f32_16x16x32_bf16 v[172:175], v[36:39], v[44:47], v[172:175]
  v_mfma_f32_16x16x32_bf16 v[180:183], v[36:39], v[48:51], v[180:183]
  v_mfma_f32_16x16x32_bf16 v[188:191], v[36:39], v[52:55], v[188:191]
  s_waitcnt lgkmcnt(2)
  v_mfma_f32_16x16x32_bf16 v[192:195], v[24:27], v[40:43], v[192:195]
  ds_read_b128 v[36:39], v8 offset:47104
  v_mfma_f32_16x16x32_bf16 v[200:203], v[24:27], v[44:47], v[200:203]
  v_mfma_f32_16x16x32_bf16 v[208:211], v[24:27], v[48:51], v[208:211]
  v_mfma_f32_16x16x32_bf16 v[216:219], v[24:27], v[52:55], v[216:219]
  s_waitcnt lgkmcnt(2)
  v_mfma_f32_16x16x32_bf16 v[196:199], v[28:31], v[40:43], v[196:199]
  v_mfma_f32_16x16x32_bf16 v[204:207], v[28:31], v[44:47], v[204:207]
  v_mfma_f32_16x16x32_bf16 v[212:215], v[28:31], v[48:51], v[212:215]
  v_mfma_f32_16x16x32_bf16 v[220:223], v[28:31], v[52:55], v[220:223]
  s_waitcnt vmcnt(13) lgkmcnt(0)
  s_barrier
  v_mfma_f32_16x16x32_bf16 v[224:227], v[32:35], v[40:43], v[224:227]
  ds_read_b128 v[24:27], v15 offset:32768
  ds_read_b64_tr_b16 v[56:57], v9 offset:16384
  s_mov_b32 m0, s86
  s_add_u32 s86, s86, 16384
  buffer_load_dwordx4 v18, s[40:43], s57 offen nt lds
  v_mfma_f32_16x16x32_bf16 v[232:235], v[32:35], v[44:47], v[232:235]
  ds_read_b64_tr_b16 v[58:59], v9 offset:18432
  ds_read_b64_tr_b16 v[60:61], v10 offset:16384
  buffer_load_dwordx4 v19, s[40:43], s57 offen offset:1024 nt lds
  s_and_b32 s86, s86, 0xffff
  s_add_u32 s57, s57, s58
  v_mfma_f32_16x16x32_bf16 v[240:243], v[32:35], v[48:51], v[240:243]
  ds_read_b64_tr_b16 v[62:63], v10 offset:18432
  v_mfma_f32_16x16x32_bf16 v[248:251], v[32:35], v[52:55], v[248:251]
  ds_read_b128 v[28:31], v15 offset:34816
  ds_read_b64_tr_b16 v[64:65], v11 offset:16384
  s_mov_b32 m0, s60
  s_add_u32 s60, s60, 30720
  buffer_load_dwordx4 v16, s[44:47], s56 offen lds
  v_mfma_f32_16x16x32_bf16 v[228:231], v[36:39], v[40:43], v[228:231]
  ds_read_b64_tr_b16 v[66:67], v11 offset:18432
  ds_read_b64_tr_b16 v[68:69], v12 offset:16384
  buffer_load_dwordx4 v17, s[44:47], s56 offen offset:1024 lds
  s_add_u32 s56, s56, s87
  s_cmp_ge_u32 s60, 163840
  s_cselect_b32 s60, s88, s60
  v_mfma_f32_16x16x32_bf16 v[236:239], v[36:39], v[44:47], v[236:239]
  ds_read_b64_tr_b16 v[70:71], v12 offset:18432
  v_mfma_f32_16x16x32_bf16 v[244:247], v[36:39], v[48:51], v[244:247]
  buffer_load_dword v4, v6, s[96:99], s100 offen
  s_add_u32 s100, s100, s101
  v_mfma_f32_16x16x32_bf16 v[252:255], v[36:39], v[52:55], v[252:255]
  s_waitcnt lgkmcnt(7)
  v_mfma_f32_16x16x32_bf16 v[128:131], v[24:27], v[56:59], v[128:131]
  ds_read_b128 v[32:35], v15 offset:36864
  s_waitcnt lgkmcnt(6)
  v_mfma_f32_16x16x32_bf16 v[136:139], v[24:27], v[60:63], v[136:139]
  ds_read_b128 v[36:39], v15 offset:38912
  s_waitcnt lgkmcnt(4)
  v_mfma_f32_16x16x32_bf16 v[144:147], v[24:27], v[64:67], v[144:147]
  s_waitcnt lgkmcnt(2)
  v_mfma_f32_16x16x32_bf16 v[152:155], v[24:27], v[68:71], v[152:155]
  v_mfma_f32_16x16x32_bf16 v[132:135], v[28:31], v[56:59], v[132:135]
  ds_read_b128 v[24:27], v15 offset:40960
  v_mfma_f32_16x16x32_bf16 v[140:143], v[28:31], v[60:63], v[140:143]
  v_mfma_f32_16x16x32_bf16 v[148:151], v[28:31], v[64:67], v[148:151]
  v_mfma_f32_16x16x32_bf16 v[156:159], v[28:31], v[68:71], v[156:159]
  s_waitcnt lgkmcnt(2)
  v_mfma_f32_16x16x32_bf16 v[160:163], v[32:35], v[56:59], v[160:163]
  ds_read_b128 v[28:31], v15 offset:43008
  v_mfma_f32_16x16x32_bf16 v[168:171], v[32:35], v[60:63], v[168:171]
  v_mfma_f32_16x16x32_bf16 v[176:179], v[32:35], v[64:67], v[176:179]
  v_mfma_f32_16x16x32_bf16 v[184:187], v[32:35], v[68:71], v[184:187]
  s_waitcnt lgkmcnt(2)
  v_mfma_f32_16x16x32_bf16 v[164:167], v[36:39], v[56:59], v[164:167]
  ds_read_b128 v[32:35], v15 offset:45056
  v_mfma_f32_16x16x32_bf16 v[172:175], v[36:39], v[60:63], v[172:175]
  v_mfma_f32_16x16x32_bf16 v[180:183], v[36:39], v[64:67], v[180:183]
  v_mfma_f32_16x16x32_bf16 v[188:191], v[36:39], v[68:71], v[188:191]
  s_waitcnt lgkmcnt(2)
  v_mfma_f32_16x16x32_bf16 v[192:195], v[24:27], v[56:59], v[192:195]
  ds_read_b128 v[36:39], v15 offset:47104
  v_mfma_f32_16x16x32_bf16 v[200:203], v[24:27], v[60:63], v[200:203]
  v_mfma_f32_16x16x32_bf16 v[208:211], v[24:27], v[64:67], v[208:211]
  v_mfma_f32_16x16x32_bf16 v[216:219], v[24:27], v[68:71], v[216:219]
  s_waitcnt lgkmcnt(2)
  v_mfma_f32_16x16x32_bf16 v[196:199], v[28:31], v[56:59], v[196:199]
  v_mfma_f32_16x16x32_bf16 v[204:207], v[28:31], v[60:63], v[204:207]
  v_mfma_f32_16x16x32_bf16 v[212:215], v[28:31], v[64:67], v[212:215]
  v_mfma_f32_16x16x32_bf16 v[220:223], v[28:31], v[68:71], v[220:223]
  s_waitcnt vmcnt(11) lgkmcnt(0)
  s_barrier
  v_mfma_f32_16x16x32_bf16 v[224:227], v[32:35], v[56:59], v[224:227]
  ds_read_b128 v[24:27], v13 offset:0
  ds_read_b64_tr_b16 v[40:41], v9 offset:32768
  s_mov_b32 m0, s86
  s_add_u32 s86, s86, 16384
  buffer_load_dwordx4 v18, s[40:43], s57 offen nt lds
  v_mfma_f32_16x16x32_bf16 v[232:235], v[32:35], v[60:63], v[232:235]
  ds_read_b64_tr_b16 v[42:43], v9 offset:34816
  ds_read_b64_tr_b16 v[44:45], v10 offset:32768
  buffer_load_dwordx4 v19, s[40:43], s57 offen offset:1024 nt lds
  s_and_b32 s86, s86, 0xffff
  s_add_u32 s57, s57, s58
  v_mfma_f32_16x16x32_bf16 v[240:243], v[32:35], v[64:67], v[240:243]
  ds_read_b64_tr_b16 v[46:47], v10 offset:34816
  v_mfma_f32_16x16x32_bf16 v[248:251], v[32:35], v[68:71], v[248:251]
  ds_read_b128 v[28:31], v13 offset:2048
  ds_read_b64_tr_b16 v[48:49], v11 offset:32768
  s_mov_b32 m0, s60
  s_add_u32 s60, s60, 2048
  buffer_load_dwordx4 v16, s[44:47], s56 offen lds
  v_mfma_f32_16x16x32_bf16 v[228:231], v[36:39], v[56:59], v[228:231]
  ds_read_b64_tr_b16 v[50:51], v11 offset:34816
  ds_read_b64_tr_b16 v[52:53], v12 offset:32768
  buffer_load_dwordx4 v17, s[44:47], s56 offen offset:1024 lds
  s_add_u32 s56, s56, s84
  v_mfma_f32_16x16x32_bf16 v[236:239], v[36:39], v[60:63], v[236:239]
  ds_read_b64_tr_b16 v[54:55], v12 offset:34816
  v_mfma_f32_16x16x32_bf16 v[244:247], v[36:39], v[64:67], v[244:247]
  buffer_load_dword v4, v6, s[96:99], s100 offen
  s_add_u32 s100, s100, s101
  v_mfma_f32_16x16x32_bf16 v[252:255], v[36:39], v[68:71], v[252:255]
  s_waitcnt lgkmcnt(7)
  v_mfma_f32_16x16x32_bf16 v[128:131], v[24:27], v[40:43], v[128:131]
  ds_read_b128 v[32:35], v13 offset:4096
  s_waitcnt lgkmcnt(6)
  v_mfma_f32_16x16x32_bf16 v[136:139], v[24:27], v[44:47], v[136:139]
  ds_read_b128 v[36:39], v13 offset:6144
  s_waitcnt lgkmcnt(4)
  v_mfma_f32_16x16x32_bf16 v[144:147], v[24:27], v[48:51], v[144:147]
  s_waitcnt lgkmcnt(2)
  v_mfma_f32_16x16x32_bf16 v[152:155], v[24:27], v[52:55], v[152:155]
  v_mfma_f32_16x16x32_bf16 v[132:135], v[28:31], v[40:43], v[132:135]
  ds_read_b128 v[24:27], v13 offset:8192
  v_mfma_f32_16x16x32_bf16 v[140:143], v[28:31], v[44:47], v[140:143]
  v_mfma_f32_16x16x32_bf16 v[148:151], v[28:31], v[48:51], v[148:151]
  s_cmp_eq_u32 s3, 0
  s_cbranch_scc0 K1_LOOPV_EP
  s_waitcnt vmcnt(10)
  v_cmp_ne_u32 s[18:19], 1, v92
  buffer_load_dword v90, v93, s[36:39], 0 offen sc1
K1_LOOPV_EP:
  v_mfma_f32_16x16x32_bf16 v[156:159], v[28:31], v[52:55], v[156:159]
  s_waitcnt lgkmcnt(2)
  v_mfma_f32_16x16x32_bf16 v[160:163], v[32:35], v[40:43], v[160:163]
  ds_read_b128 v[28:31], v13 offset:10240
  v_mfma_f32_16x16x32_bf16 v[168:171], v[32:35], v[44:47], v[168:171]
  v_mfma_f32_16x16x32_bf16 v[176:179], v[32:35], v[48:51], v[176:179]
  v_mfma_f32_16x16x32_bf16 v[184:187], v[32:35], v[52:55], v[184:187]
  s_waitcnt lgkmcnt(2)
  v_mfma_f32_16x16x32_bf16 v[164:167], v[36:39], v[40:43], v[164:167]
  ds_read_b128 v[32:35], v13 offset:12288
  v_mfma_f32_16x16x32_bf16 v[172:175], v[36:39], v[44:47], v[172:175]
  v_mfma_f32_16x16x32_bf16 v[180:183], v[36:39], v[48:51], v[180:183]
  v_mfma_f32_16x16x32_bf16 v[188:191], v[36:39], v[52:55], v[188:191]
  s_waitcnt lgkmcnt(2)
  v_mfma_f32_16x16x32_bf16 v[192:195], v[24:27], v[40:43], v[192:195]
  ds_read_b128 v[36:39], v13 offset:14336
  v_mfma_f32_16x16x32_bf16 v[200:203], v[24:27], v[44:47], v[200:203]
  v_mfma_f32_16x16x32_bf16 v[208:211], v[24:27], v[48:51], v[208:211]
  v_mfma_f32_16x16x32_bf16 v[216:219], v[24:27], v[52:55], v[216:219]
  s_waitcnt lgkmcnt(2)
  v_mfma_f32_16x16x32_bf16 v[196:199], v[28:31], v[40:43], v[196:199]
  v_mfma_f32_16x16x32_bf16 v[204:207], v[28:31], v[44:47], v[204:207]
  v_mfma_f32_16x16x32_bf16 v[212:215], v[28:31], v[48:51], v[212:215]
  v_mfma_f32_16x16x32_bf16 v[220:223], v[28:31], v[52:55], v[220:223]
  s_waitcnt vmcnt(13) lgkmcnt(0)
  s_barrier
  v_mfma_f32_16x16x32_bf16 v[224:227], v[32:35], v[40:43], v[224:227]
  ds_read_b128 v[24:27], v14 offset:0
  ds_read_b64_tr_b16 v[56:57], v9 offset:49152
  s_mov_b32 m0, s86
  s_add_u32 s86, s86, 16384
  buffer_load_dwordx4 v18, s[40:43], s57 offen nt lds
  v_mfma_f32_16x16x32_bf16 v[232:235], v[32:35], v[44:47], v[232:235]
  ds_read_b64_tr_b16 v[58:59], v9 offset:51200
  ds_read_b64_tr_b16 v[60:61], v10 offset:49152
  buffer_load_dwordx4 v19, s[40:43], s57 offen offset:1024 nt lds
  s_and_b32 s86, s86, 0xffff
  s_add_u32 s57, s57, s58
  v_mfma_f32_16x16x32_bf16 v[240:243], v[32:35], v[48:51], v[240:243]
  ds_read_b64_tr_b16 v[62:63], v10 offset:51200
  v_mfma_f32_16x16x32_bf16 v[248:251], v[32:35], v[52:55], v[248:251]
  ds_read_b128 v[28:31], v14 offset:2048
  ds_read_b64_tr_b16 v[64:65], v11 offset:49152
  s_mov_b32 m0, s60
  s_add_u32 s60, s60, 30720
  buffer_load_dwordx4 v16, s[44:47], s56 offen lds
  v_mfma_f32_16x16x32_bf16 v[228:231], v[36:39], v[40:43], v[228:231]
  ds_read_b64_tr_b16 v[66:67], v11 offset:51200
  ds_read_b64_tr_b16 v[68:69], v12 offset:49152
  buffer_load_dwordx4 v17, s[44:47], s56 offen offset:1024 lds
  s_add_u32 s56, s56, s87
  s_cmp_ge_u32 s60, 163840
  s_cselect_b32 s60, s88, s60
  v_mfma_f32_16x16x32_bf16 v[236:239], v[36:39], v[44:47], v[236:239]
  ds_read_b64_tr_b16 v[70:71], v12 offset:51200
  v_mfma_f32_16x16x32_bf16 v[244:247], v[36:39], v[48:51], v[244:247]
  buffer_load_dword v4, v6, s[96:99], s100 offen
  s_add_u32 s100, s100, s101
  v_mfma_f32_16x16x32_bf16 v[252:255], v[36:39], v[52:55], v[252:255]
  s_waitcnt lgkmcnt(7)
  v_mfma_f32_16x16x32_bf16 v[128:131], v[24:27], v[56:59], v[128:131]
  ds_read_b128 v[32:35], v14 offset:4096
  s_waitcnt lgkmcnt(6)
  v_mfma_f32_16x16x32_bf16 v[136:139], v[24:27], v[60:63], v[136:139]
  ds_read_b128 v[36:39], v14 offset:6144
  s_waitcnt lgkmcnt(4)
  v_mfma_f32_16x16x32_bf16 v[144:147], v[24:27], v[64:67], v[144:147]
  s_mov_b32 s44, s8
  s_waitcnt lgkmcnt(2)
  v_mfma_f32_16x16x32_bf16 v[152:155], v[24:27], v[68:71], v[152:155]
  v_mfma_f32_16x16x32_bf16 v[132:135], v[28:31], v[56:59], v[132:135]
  ds_read_b128 v[24:27], v14 offset:8192
  s_mov_b32 s45, s9
  v_mfma_f32_16x16x32_bf16 v[140:143], v[28:31], v[60:63], v[140:143]
  v_mfma_f32_16x16x32_bf16 v[148:151], v[28:31], v[64:67], v[148:151]
  v_mfma_f32_16x16x32_bf16 v[156:159], v[28:31], v[68:71], v[156:159]
  s_mov_b32 s46, 2621440
  s_waitcnt lgkmcnt(2)
  v_mfma_f32_16x16x32_bf16 v[160:163], v[32:35], v[56:59], v[160:163]
  ds_read_b128 v[28:31], v14 offset:10240
  v_mfma_f32_16x16x32_bf16 v[168:171], v[32:35], v[60:63], v[168:171]
  s_mov_b32 s56, 0
  v_mfma_f32_16x16x32_bf16 v[176:179], v[32:35], v[64:67], v[176:179]
  v_mfma_f32_16x16x32_bf16 v[184:187], v[32:35], v[68:71], v[184:187]
  s_waitcnt lgkmcnt(2)
  v_mfma_f32_16x16x32_bf16 v[164:167], v[36:39], v[56:59], v[164:167]
  ds_read_b128 v[32:35], v14 offset:12288
  s_movk_i32 s84, 128
  v_mfma_f32_16x16x32_bf16 v[172:175], v[36:39], v[60:63], v[172:175]
  v_mfma_f32_16x16x32_bf16 v[180:183], v[36:39], v[64:67], v[180:183]
  s_movk_i32 s87, 128
  v_mfma_f32_16x16x32_bf16 v[188:191], v[36:39], v[68:71], v[188:191]
  s_waitcnt lgkmcnt(2)
  v_mfma_f32_16x16x32_bf16 v[192:195], v[24:27], v[56:59], v[192:195]
  ds_read_b128 v[36:39], v14 offset:14336
  v_mfma_f32_16x16x32_bf16 v[200:203], v[24:27], v[60:63], v[200:203]
  v_mov_b32 v16, v20
  v_mfma_f32_16x16x32_bf16 v[208:211], v[24:27], v[64:67], v[208:211]
  v_mfma_f32_16x16x32_bf16 v[216:219], v[24:27], v[68:71], v[216:219]
  v_mov_b32 v17, v21
  s_waitcnt lgkmcnt(2)
  v_mfma_f32_16x16x32_bf16 v[196:199], v[28:31], v[56:59], v[196:199]
  v_mfma_f32_16x16x32_bf16 v[204:207], v[28:31], v[60:63], v[204:207]
  v_mfma_f32_16x16x32_bf16 v[212:215], v[28:31], v[64:67], v[212:215]
  s_cmp_eq_u32 s3, 0
  s_cbranch_scc0 K1_LOOPV_EC
  s_waitcnt vmcnt(5)
  v_cmp_eq_u32 vcc, 0, v90
  s_nop 0
  s_or_b64 vcc, vcc, s[18:19]
  s_cbranch_scc1 K1_ESLOW
K1_LOOPV_EC:
  v_mfma_f32_16x16x32_bf16 v[220:223], v[28:31], v[68:71], v[220:223]
  s_waitcnt vmcnt(11) lgkmcnt(0)
  s_barrier
  v_mfma_f32_16x16x32_bf16 v[224:227], v[32:35], v[56:59], v[224:227]
  ds_read_b128 v[24:27], v8 offset:0
  ds_read_b64_tr_b16 v[40:41], v9 offset:0
  s_mov_b32 m0, s86
  s_add_u32 s86, s86, 16384
  buffer_load_dwordx4 v18, s[40:43], s57 offen nt lds
  v_mfma_f32_16x16x32_bf16 v[232:235], v[32:35], v[60:63], v[232:235]
  ds_read_b64_tr_b16 v[42:43], v9 offset:2048
  ds_read_b64_tr_b16 v[44:45], v10 offset:0
  buffer_load_dwordx4 v19, s[40:43], s57 offen offset:1024 nt lds
  s_and_b32 s86, s86, 0xffff
  s_add_u32 s57, s57, s58
  v_mfma_f32_16x16x32_bf16 v[240:243], v[32:35], v[64:67], v[240:243]
  ds_read_b64_tr_b16 v[46:47], v10 offset:2048
  v_mfma_f32_16x16x32_bf16 v[248:251], v[32:35], v[68:71], v[248:251]
  ds_read_b128 v[28:31], v8 offset:2048
  ds_read_b64_tr_b16 v[48:49], v11 offset:0
  s_mov_b32 m0, s60
  s_add_u32 s60, s60, 2048
  buffer_load_dwordx4 v16, s[44:47], s56 offen lds
  v_mfma_f32_16x16x32_bf16 v[228:231], v[36:39], v[56:59], v[228:231]
  ds_read_b64_tr_b16 v[50:51], v11 offset:2048
  ds_read_b64_tr_b16 v[52:53], v12 offset:0
  buffer_load_dwordx4 v17, s[44:47], s56 offen offset:1024 lds
  s_add_u32 s56, s56, s84
  v_mfma_f32_16x16x32_bf16 v[236:239], v[36:39], v[60:63], v[236:239]
  ds_read_b64_tr_b16 v[54:55], v12 offset:2048
  v_mfma_f32_16x16x32_bf16 v[244:247], v[36:39], v[64:67], v[244:247]
  buffer_load_dword v4, v6, s[96:99], s100 offen
  s_add_u32 s100, s100, s101
  v_mfma_f32_16x16x32_bf16 v[252:255], v[36:39], v[68:71], v[252:255]
  s_waitcnt lgkmcnt(7)
  v_mfma_f32_16x16x32_bf16 v[128:131], v[24:27], v[40:43], v[128:131]
  ds_read_b128 v[32:35], v8 offset:4096
  s_waitcnt lgkmcnt(6)
  v_mfma_f32_16x16x32_bf16 v[136:139], v[24:27], v[44:47], v[136:139]
  ds_read_b128 v[36:39], v8 offset:6144
  s_waitcnt lgkmcnt(4)
  v_mfma_f32_16x16x32_bf16 v[144:147], v[24:27], v[48:51], v[144:147]
  s_mov_b32 s40, s36
  s_waitcnt lgkmcnt(2)
  v_mfma_f32_16x16x32_bf16 v[152:155], v[24:27], v[52:55], v[152:155]
  v_mfma_f32_16x16x32_bf16 v[132:135], v[28:31], v[40:43], v[132:135]
  ds_read_b128 v[24:27], v8 offset:8192
  s_mov_b32 s41, s37
  v_mfma_f32_16x16x32_bf16 v[140:143], v[28:31], v[44:47], v[140:143]
  v_mfma_f32_16x16x32_bf16 v[148:151], v[28:31], v[48:51], v[148:151]
  v_mfma_f32_16x16x32_bf16 v[156:159], v[28:31], v[52:55], v[156:159]
  s_mov_b32 s42, s38
  s_waitcnt lgkmcnt(2)
  v_mfma_f32_16x16x32_bf16 v[160:163], v[32:35], v[40:43], v[160:163]
  ds_read_b128 v[28:31], v8 offset:10240
  v_mfma_f32_16x16x32_bf16 v[168:171], v[32:35], v[44:47], v[168:171]
  s_mul_i32 s57, s80, 163840
  v_mfma_f32_16x16x32_bf16 v[176:179], v[32:35], v[48:51], v[176:179]
  v_mfma_f32_16x16x32_bf16 v[184:187], v[32:35], v[52:55], v[184:187]
  s_waitcnt lgkmcnt(2)
  v_mfma_f32_16x16x32_bf16 v[164:167], v[36:39], v[40:43], v[164:167]
  ds_read_b128 v[32:35], v8 offset:12288
  s_add_u32 s57, s57, 88080384
  v_mfma_f32_16x16x32_bf16 v[172:175], v[36:39], v[44:47], v[172:175]
  v_mfma_f32_16x16x32_bf16 v[180:183], v[36:39], v[48:51], v[180:183]
  s_movk_i32 s58, 16384
  v_mfma_f32_16x16x32_bf16 v[188:191], v[36:39], v[52:55], v[188:191]
  s_waitcnt lgkmcnt(2)
  v_mfma_f32_16x16x32_bf16 v[192:195], v[24:27], v[40:43], v[192:195]
  ds_read_b128 v[36:39], v8 offset:14336
  v_mfma_f32_16x16x32_bf16 v[200:203], v[24:27], v[44:47], v[200:203]
  v_add_u32 v18, s86, v2
  v_mfma_f32_16x16x32_bf16 v[208:211], v[24:27], v[48:51], v[208:211]
  v_mfma_f32_16x16x32_bf16 v[216:219], v[24:27], v[52:55], v[216:219]
  v_add_u32 v19, s86, v2
  s_waitcnt lgkmcnt(2)
  v_mfma_f32_16x16x32_bf16 v[196:199], v[28:31], v[40:43], v[196:199]
  v_mfma_f32_16x16x32_bf16 v[204:207], v[28:31], v[44:47], v[204:207]
  v_mfma_f32_16x16x32_bf16 v[212:215], v[28:31], v[48:51], v[212:215]
  v_mfma_f32_16x16x32_bf16 v[220:223], v[28:31], v[52:55], v[220:223]
  s_waitcnt vmcnt(13) lgkmcnt(0)
  s_barrier
  v_mfma_f32_16x16x32_bf16 v[224:227], v[32:35], v[40:43], v[224:227]
  ds_read_b128 v[24:27], v15 offset:0
  ds_read_b64_tr_b16 v[56:57], v9 offset:16384
  s_mov_b32 m0, s86
  s_add_u32 s86, s86, 16384
  buffer_load_dwordx4 v18, s[40:43], s57 offen sc1 lds
  v_mfma_f32_16x16x32_bf16 v[232:235], v[32:35], v[44:47], v[232:235]
  ds_read_b64_tr_b16 v[58:59], v9 offset:18432
  ds_read_b64_tr_b16 v[60:61], v10 offset:16384
  buffer_load_dwordx4 v19, s[40:43], s57 offen offset:1024 sc1 lds
  s_and_b32 s86, s86, 0xffff
  s_add_u32 s57, s57, s58
  v_mfma_f32_16x16x32_bf16 v[240:243], v[32:35], v[48:51], v[240:243]
  ds_read_b64_tr_b16 v[62:63], v10 offset:18432
  v_mfma_f32_16x16x32_bf16 v[248:251], v[32:35], v[52:55], v[248:251]
  ds_read_b128 v[28:31], v15 offset:2048
  ds_read_b64_tr_b16 v[64:65], v11 offset:16384
  s_mov_b32 m0, s60
  s_add_u32 s60, s60, 30720
  buffer_load_dwordx4 v16, s[44:47], s56 offen lds
  v_mfma_f32_16x16x32_bf16 v[228:231], v[36:39], v[40:43], v[228:231]
  ds_read_b64_tr_b16 v[66:67], v11 offset:18432
  ds_read_b64_tr_b16 v[68:69], v12 offset:16384
  buffer_load_dwordx4 v17, s[44:47], s56 offen offset:1024 lds
  s_add_u32 s56, s56, s87
  s_cmp_ge_u32 s60, 163840
  s_cselect_b32 s60, s88, s60
  v_mfma_f32_16x16x32_bf16 v[236:239], v[36:39], v[44:47], v[236:239]
  ds_read_b64_tr_b16 v[70:71], v12 offset:18432
  v_mfma_f32_16x16x32_bf16 v[244:247], v[36:39], v[48:51], v[244:247]
  buffer_load_dword v4, v6, s[96:99], s100 offen
  s_add_u32 s100, s100, s101
  v_mfma_f32_16x16x32_bf16 v[252:255], v[36:39], v[52:55], v[252:255]
  s_waitcnt lgkmcnt(7)
  v_mfma_f32_16x16x32_bf16 v[128:131], v[24:27], v[56:59], v[128:131]
  ds_read_b128 v[32:35], v15 offset:4096
  s_waitcnt lgkmcnt(6)
  v_mfma_f32_16x16x32_bf16 v[136:139], v[24:27], v[60:63], v[136:139]
  ds_read_b128 v[36:39], v15 offset:6144
  s_waitcnt lgkmcnt(4)
  v_mfma_f32_16x16x32_bf16 v[144:147], v[24:27], v[64:67], v[144:147]
  s_waitcnt lgkmcnt(2)
  v_mfma_f32_16x16x32_bf16 v[152:155], v[24:27], v[68:71], v[152:155]
  v_mfma_f32_16x16x32_bf16 v[132:135], v[28:31], v[56:59], v[132:135]
  ds_read_b128 v[24:27], v15 offset:8192
  v_mfma_f32_16x16x32_bf16 v[140:143], v[28:31], v[60:63], v[140:143]
  v_mfma_f32_16x16x32_bf16 v[148:151], v[28:31], v[64:67], v[148:151]
  v_mfma_f32_16x16x32_bf16 v[156:159], v[28:31], v[68:71], v[156:159]
  s_waitcnt lgkmcnt(2)
  v_mfma_f32_16x16x32_bf16 v[160:163], v[32:35], v[56:59], v[160:163]
  ds_read_b128 v[28:31], v15 offset:10240
  v_mfma_f32_16x16x32_bf16 v[168:171], v[32:35], v[60:63], v[168:171]
  v_mfma_f32_16x16x32_bf16 v[176:179], v[32:35], v[64:67], v[176:179]
  v_mfma_f32_16x16x32_bf16 v[184:187], v[32:35], v[68:71], v[184:187]
  s_waitcnt lgkmcnt(2)
  v_mfma_f32_16x16x32_bf16 v[164:167], v[36:39], v[56:59], v[164:167]
  ds_read_b128 v[32:35], v15 offset:12288
  v_mfma_f32_16x16x32_bf16 v[172:175], v[36:39], v[60:63], v[172:175]
  v_mfma_f32_16x16x32_bf16 v[180:183], v[36:39], v[64:67], v[180:183]
  v_mfma_f32_16x16x32_bf16 v[188:191], v[36:39], v[68:71], v[188:191]
  s_waitcnt lgkmcnt(2)
  v_mfma_f32_16x16x32_bf16 v[192:195], v[24:27], v[56:59], v[192:195]
  ds_read_b128 v[36:39], v15 offset:14336
  v_mfma_f32_16x16x32_bf16 v[200:203], v[24:27], v[60:63], v[200:203]
  v_mfma_f32_16x16x32_bf16 v[208:211], v[24:27], v[64:67], v[208:211]
  v_mfma_f32_16x16x32_bf16 v[216:219], v[24:27], v[68:71], v[216:219]
  s_waitcnt lgkmcnt(2)
  v_mfma_f32_16x16x32_bf16 v[196:199], v[28:31], v[56:59], v[196:199]
  v_mfma_f32_16x16x32_bf16 v[204:207], v[28:31], v[60:63], v[204:207]
  v_mfma_f32_16x16x32_bf16 v[212:215], v[28:31], v[64:67], v[212:215]
  v_mfma_f32_16x16x32_bf16 v[220:223], v[28:31], v[68:71], v[220:223]
  s_waitcnt vmcnt(11) lgkmcnt(0)
  s_barrier
  v_mfma_f32_16x16x32_bf16 v[224:227], v[32:35], v[56:59], v[224:227]
  ds_read_b128 v[24:27], v8 offset:32768
  ds_read_b64_tr_b16 v[40:41], v9 offset:32768
  s_mov_b32 m0, s86
  s_add_u32 s86, s86, 16384
  buffer_load_dwordx4 v18, s[40:43], s57 offen sc1 lds
  v_mfma_f32_16x16x32_bf16 v[232:235], v[32:35], v[60:63], v[232:235]
  ds_read_b64_tr_b16 v[42:43], v9 offset:34816
  ds_read_b64_tr_b16 v[44:45], v10 offset:32768
  buffer_load_dwordx4 v19, s[40:43], s57 offen offset:1024 sc1 lds
  s_and_b32 s86, s86, 0xffff
  s_add_u32 s57, s57, s58
  v_mfma_f32_16x16x32_bf16 v[240:243], v[32:35], v[64:67], v[240:243]
  ds_read_b64_tr_b16 v[46:47], v10 offset:34816
  v_mfma_f32_16x16x32_bf16 v[248:251], v[32:35], v[68:71], v[248:251]
  ds_read_b128 v[28:31], v8 offset:34816
  ds_read_b64_tr_b16 v[48:49], v11 offset:32768
  s_mov_b32 m0, s60
  s_add_u32 s60, s60, 2048
  buffer_load_dwordx4 v16, s[44:47], s56 offen lds
  v_mfma_f32_16x16x32_bf16 v[228:231], v[36:39], v[56:59], v[228:231]
  ds_read_b64_tr_b16 v[50:51], v11 offset:34816
  ds_read_b64_tr_b16 v[52:53], v12 offset:32768
  buffer_load_dwordx4 v17, s[44:47], s56 offen offset:1024 lds
  s_add_u32 s56, s56, s84
  v_mfma_f32_16x16x32_bf16 v[236:239], v[36:39], v[60:63], v[236:239]
  ds_read_b64_tr_b16 v[54:55], v12 offset:34816
  v_mfma_f32_16x16x32_bf16 v[244:247], v[36:39], v[64:67], v[244:247]
  buffer_load_dword v4, v6, s[96:99], s100 offen
  s_add_u32 s100, s100, s101
  v_mfma_f32_16x16x32_bf16 v[252:255], v[36:39], v[68:71], v[252:255]
  s_waitcnt lgkmcnt(7)
  v_mfma_f32_16x16x32_bf16 v[128:131], v[24:27], v[40:43], v[128:131]
  ds_read_b128 v[32:35], v8 offset:36864
  s_waitcnt lgkmcnt(6)
  v_mfma_f32_16x16x32_bf16 v[136:139], v[24:27], v[44:47], v[136:139]
  ds_read_b128 v[36:39], v8 offset:38912
  s_waitcnt lgkmcnt(4)
  v_mfma_f32_16x16x32_bf16 v[144:147], v[24:27], v[48:51], v[144:147]
  s_waitcnt lgkmcnt(2)
  v_mfma_f32_16x16x32_bf16 v[152:155], v[24:27], v[52:55], v[152:155]
  v_mfma_f32_16x16x32_bf16 v[132:135], v[28:31], v[40:43], v[132:135]
  ds_read_b128 v[24:27], v8 offset:40960
  v_mfma_f32_16x16x32_bf16 v[140:143], v[28:31], v[44:47], v[140:143]
  v_mfma_f32_16x16x32_bf16 v[148:151], v[28:31], v[48:51], v[148:151]
  v_mfma_f32_16x16x32_bf16 v[156:159], v[28:31], v[52:55], v[156:159]
  s_waitcnt lgkmcnt(2)
  v_mfma_f32_16x16x32_bf16 v[160:163], v[32:35], v[40:43], v[160:163]
  ds_read_b128 v[28:31], v8 offset:43008
  v_mfma_f32_16x16x32_bf16 v[168:171], v[32:35], v[44:47], v[168:171]
  v_mfma_f32_16x16x32_bf16 v[176:179], v[32:35], v[48:51], v[176:179]
  v_mfma_f32_16x16x32_bf16 v[184:187], v[32:35], v[52:55], v[184:187]
  s_waitcnt lgkmcnt(2)
  v_mfma_f32_16x16x32_bf16 v[164:167], v[36:39], v[40:43], v[164:167]
  ds_read_b128 v[32:35], v8 offset:45056
  v_mfma_f32_16x16x32_bf16 v[172:175], v[36:39], v[44:47], v[172:175]
  v_mfma_f32_16x16x32_bf16 v[180:183], v[36:39], v[48:51], v[180:183]
  v_mfma_f32_16x16x32_bf16 v[188:191], v[36:39], v[52:55], v[188:191]
  s_waitcnt lgkmcnt(2)
  v_mfma_f32_16x16x32_bf16 v[192:195], v[24:27], v[40:43], v[192:195]
  ds_read_b128 v[36:39], v8 offset:47104
  v_mfma_f32_16x16x32_bf16 v[200:203], v[24:27], v[44:47], v[200:203]
  v_mfma_f32_16x16x32_bf16 v[208:211], v[24:27], v[48:51], v[208:211]
  v_mfma_f32_16x16x32_bf16 v[216:219], v[24:27], v[52:55], v[216:219]
  s_waitcnt lgkmcnt(2)
  v_mfma_f32_16x16x32_bf16 v[196:199], v[28:31], v[40:43], v[196:199]
  v_mfma_f32_16x16x32_bf16 v[204:207], v[28:31], v[44:47], v[204:207]
  v_mfma_f32_16x16x32_bf16 v[212:215], v[28:31], v[48:51], v[212:215]
  v_mfma_f32_16x16x32_bf16 v[220:223], v[28:31], v[52:55], v[220:223]
  s_waitcnt vmcnt(13) lgkmcnt(0)
  s_barrier
  v_mfma_f32_16x16x32_bf16 v[224:227], v[32:35], v[40:43], v[224:227]
  ds_read_b128 v[24:27], v15 offset:32768
  ds_read_b64_tr_b16 v[56:57], v9 offset:49152
  s_mov_b32 m0, s86
  s_add_u32 s86, s86, 16384
  buffer_load_dwordx4 v18, s[40:43], s57 offen sc1 lds
  v_mfma_f32_16x16x32_bf16 v[232:235], v[32:35], v[44:47], v[232:235]
  ds_read_b64_tr_b16 v[58:59], v9 offset:51200
  ds_read_b64_tr_b16 v[60:61], v10 offset:49152
  buffer_load_dwordx4 v19, s[40:43], s57 offen offset:1024 sc1 lds
  s_and_b32 s86, s86, 0xffff
  s_add_u32 s57, s57, s58
  v_mfma_f32_16x16x32_bf16 v[240:243], v[32:35], v[48:51], v[240:243]
  ds_read_b64_tr_b16 v[62:63], v10 offset:51200
  v_mfma_f32_16x16x32_bf16 v[248:251], v[32:35], v[52:55], v[248:251]
  ds_read_b128 v[28:31], v15 offset:34816
  ds_read_b64_tr_b16 v[64:65], v11 offset:49152
  s_mov_b32 m0, s60
  s_add_u32 s60, s60, 30720
  buffer_load_dwordx4 v16, s[44:47], s56 offen lds
  v_mfma_f32_16x16x32_bf16 v[228:231], v[36:39], v[40:43], v[228:231]
  ds_read_b64_tr_b16 v[66:67], v11 offset:51200
  ds_read_b64_tr_b16 v[68:69], v12 offset:49152
  buffer_load_dwordx4 v17, s[44:47], s56 offen offset:1024 lds
  s_add_u32 s56, s56, s87
  s_cmp_ge_u32 s60, 163840
  s_cselect_b32 s60, s88, s60
  v_mfma_f32_16x16x32_bf16 v[236:239], v[36:39], v[44:47], v[236:239]
  ds_read_b64_tr_b16 v[70:71], v12 offset:51200
  v_mfma_f32_16x16x32_bf16 v[244:247], v[36:39], v[48:51], v[244:247]
  buffer_load_dword v4, v6, s[96:99], s100 offen
  s_add_u32 s100, s100, s101
  v_mfma_f32_16x16x32_bf16 v[252:255], v[36:39], v[52:55], v[252:255]
  s_waitcnt lgkmcnt(7)
  v_mfma_f32_16x16x32_bf16 v[128:131], v[24:27], v[56:59], v[128:131]
  ds_read_b128 v[32:35], v15 offset:36864
  s_waitcnt lgkmcnt(6)
  v_mfma_f32_16x16x32_bf16 v[136:139], v[24:27], v[60:63], v[136:139]
  ds_read_b128 v[36:39], v15 offset:38912
  s_waitcnt lgkmcnt(4)
  v_mfma_f32_16x16x32_bf16 v[144:147], v[24:27], v[64:67], v[144:147]
  s_waitcnt lgkmcnt(2)
  v_mfma_f32_16x16x32_bf16 v[152:155], v[24:27], v[68:71], v[152:155]
  v_mfma_f32_16x16x32_bf16 v[132:135], v[28:31], v[56:59], v[132:135]
  ds_read_b128 v[24:27], v15 offset:40960
  v_mfma_f32_16x16x32_bf16 v[140:143], v[28:31], v[60:63], v[140:143]
  v_mfma_f32_16x16x32_bf16 v[148:151], v[28:31], v[64:67], v[148:151]
  v_mfma_f32_16x16x32_bf16 v[156:159], v[28:31], v[68:71], v[156:159]
  s_waitcnt lgkmcnt(2)
  v_mfma_f32_16x16x32_bf16 v[160:163], v[32:35], v[56:59], v[160:163]
  ds_read_b128 v[28:31], v15 offset:43008
  v_mfma_f32_16x16x32_bf16 v[168:171], v[32:35], v[60:63], v[168:171]
  v_mfma_f32_16x16x32_bf16 v[176:179], v[32:35], v[64:67], v[176:179]
  v_mfma_f32_16x16x32_bf16 v[184:187], v[32:35], v[68:71], v[184:187]
  s_waitcnt lgkmcnt(2)
  v_mfma_f32_16x16x32_bf16 v[164:167], v[36:39], v[56:59], v[164:167]
  ds_read_b128 v[32:35], v15 offset:45056
  v_mfma_f32_16x16x32_bf16 v[172:175], v[36:39], v[60:63], v[172:175]
  v_mfma_f32_16x16x32_bf16 v[180:183], v[36:39], v[64:67], v[180:183]
  v_mfma_f32_16x16x32_bf16 v[188:191], v[36:39], v[68:71], v[188:191]
  s_waitcnt lgkmcnt(2)
  v_mfma_f32_16x16x32_bf16 v[192:195], v[24:27], v[56:59], v[192:195]
  ds_read_b128 v[36:39], v15 offset:47104
  v_mfma_f32_16x16x32_bf16 v[200:203], v[24:27], v[60:63], v[200:203]
  v_mfma_f32_16x16x32_bf16 v[208:211], v[24:27], v[64:67], v[208:211]
  v_mfma_f32_16x16x32_bf16 v[216:219], v[24:27], v[68:71], v[216:219]
  s_waitcnt lgkmcnt(2)
  v_mfma_f32_16x16x32_bf16 v[196:199], v[28:31], v[56:59], v[196:199]
  v_mfma_f32_16x16x32_bf16 v[204:207], v[28:31], v[60:63], v[204:207]
  v_mfma_f32_16x16x32_bf16 v[212:215], v[28:31], v[64:67], v[212:215]
  v_mfma_f32_16x16x32_bf16 v[220:223], v[28:31], v[68:71], v[220:223]
  s_waitcnt vmcnt(13) lgkmcnt(0)
  s_barrier
  v_mfma_f32_16x16x32_bf16 v[224:227], v[32:35], v[56:59], v[224:227]
  ds_read_b128 v[24:27], v122 offset:0
  ds_read_b64_tr_b16 v[40:41], v124 offset:0
  s_mov_b32 m0, s86
  s_add_u32 s86, s86, 16384
  buffer_load_dwordx4 v18, s[40:43], s57 offen sc1 lds
  v_mfma_f32_16x16x32_bf16 v[232:235], v[32:35], v[60:63], v[232:235]
  ds_read_b64_tr_b16 v[42:43], v124 offset:1024
  ds_read_b64_tr_b16 v[44:45], v125 offset:0
  buffer_load_dwordx4 v19, s[40:43], s57 offen offset:1024 sc1 lds
  s_and_b32 s86, s86, 0xffff
  s_add_u32 s57, s57, s58
  v_mfma_f32_16x16x32_bf16 v[240:243], v[32:35], v[64:67], v[240:243]
  ds_read_b64_tr_b16 v[46:47], v125 offset:1024
  v_mfma_f32_16x16x32_bf16 v[248:251], v[32:35], v[68:71], v[248:251]
  ds_read_b64_tr_b16 v[48:49], v126 offset:0
  ds_read_b64_tr_b16 v[50:51], v126 offset:1024
  s_mov_b32 m0, s60
  s_add_u32 s60, s60, 2048
  buffer_load_dwordx4 v16, s[44:47], s56 offen lds
  v_mfma_f32_16x16x32_bf16 v[228:231], v[36:39], v[56:59], v[228:231]
  ds_read_b64_tr_b16 v[52:53], v127 offset:0
  ds_read_b64_tr_b16 v[54:55], v127 offset:1024
  buffer_load_dwordx4 v17, s[44:47], s56 offen offset:1024 lds
  s_add_u32 s56, s56, s84
  v_mfma_f32_16x16x32_bf16 v[236:239], v[36:39], v[60:63], v[236:239]
  ds_read_b128 v[28:31], v122 offset:4096
  v_mfma_f32_16x16x32_bf16 v[244:247], v[36:39], v[64:67], v[244:247]
  buffer_load_dword v4, v6, s[96:99], s100 offen
  s_add_u32 s100, s100, s101
  v_mfma_f32_16x16x32_bf16 v[252:255], v[36:39], v[68:71], v[252:255]
K1_EPI1:
  s_mov_b32 m0, s60
  s_add_u32 s60, s60, 30720
  buffer_load_dwordx4 v16, s[44:47], s56 offen lds
  buffer_load_dwordx4 v17, s[44:47], s56 offen offset:1024 lds
  s_add_u32 s56, s56, s87
  s_cmp_ge_u32 s60, 163840
  s_cselect_b32 s60, s88, s60
  s_waitcnt lgkmcnt(7)
  v_mfma_f32_16x16x32_bf16 v[72:75], v[40:43], v[24:27], 0
  ds_read_b128 v[32:35], v123 offset:0
  ds_read_b64_tr_b16 v[56:57], v124 offset:8192
  v_cvt_pk_bf16_f32 v128, v128, v129
  s_waitcnt lgkmcnt(7)
  v_mfma_f32_16x16x32_bf16 v[76:79], v[44:47], v[24:27], 0
  ds_read_b64_tr_b16 v[58:59], v124 offset:9216
  ds_read_b64_tr_b16 v[60:61], v125 offset:8192
  v_cvt_pk_bf16_f32 v129, v130, v131
  s_waitcnt lgkmcnt(7)
  v_mfma_f32_16x16x32_bf16 v[80:83], v[48:51], v[24:27], 0
  ds_read_b64_tr_b16 v[62:63], v125 offset:9216
  v_cvt_pk_bf16_f32 v130, v132, v133
  s_waitcnt lgkmcnt(6)
  v_mfma_f32_16x16x32_bf16 v[84:87], v[52:55], v[24:27], 0
  ds_read_b64_tr_b16 v[64:65], v126 offset:8192
  ds_read_b64_tr_b16 v[66:67], v126 offset:9216
  v_cvt_pk_bf16_f32 v131, v134, v135
  s_waitcnt lgkmcnt(7)
  v_mfma_f32_16x16x32_bf16 v[88:91], v[40:43], v[28:31], 0
  ds_read_b64_tr_b16 v[68:69], v127 offset:8192
  ds_read_b64_tr_b16 v[70:71], v127 offset:9216
  v_cvt_pk_bf16_f32 v136, v136, v137
  v_mfma_f32_16x16x32_bf16 v[92:95], v[44:47], v[28:31], 0
  ds_read_b128 v[36:39], v123 offset:4096
  v_cvt_pk_bf16_f32 v137, v138, v139
  v_mfma_f32_16x16x32_bf16 v[96:99], v[48:51], v[28:31], 0
  v_cvt_pk_bf16_f32 v138, v140, v141
  v_mfma_f32_16x16x32_bf16 v[100:103], v[52:55], v[28:31], 0
  v_cvt_pk_bf16_f32 v139, v142, v143
  s_waitcnt vmcnt(15) lgkmcnt(0)
  s_barrier
  v_mfma_f32_16x16x32_bf16 v[72:75], v[56:59], v[32:35], v[72:75]
  ds_read_b128 v[24:27], v122 offset:2048
  ds_read_b64_tr_b16 v[40:41], v124 offset:16384
  v_cvt_pk_bf16_f32 v144, v144, v145
  v_mfma_f32_16x16x32_bf16 v[76:79], v[60:63], v[32:35], v[76:79]
  ds_read_b64_tr_b16 v[42:43], v124 offset:17408
  ds_read_b64_tr_b16 v[44:45], v125 offset:16384
  v_cvt_pk_bf16_f32 v145, v146, v147
  s_mov_b32 m0, s86
  s_add_u32 s86, s86, 16384
  buffer_load_dwordx4 v18, s[40:43], s57 offen sc1 lds
  v_mfma_f32_16x16x32_bf16 v[80:83], v[64:67], v[32:35], v[80:83]
  ds_read_b64_tr_b16 v[46:47], v125 offset:17408
  v_cvt_pk_bf16_f32 v146, v148, v149
  buffer_load_dwordx4 v19, s[40:43], s57 offen offset:1024 sc1 lds
  s_and_b32 s86, s86, 0xffff
  s_add_u32 s57, s57, s58
  v_mfma_f32_16x16x32_bf16 v[84:87], v[68:71], v[32:35], v[84:87]
  ds_read_b64_tr_b16 v[48:49], v126 offset:16384
  ds_read_b64_tr_b16 v[50:51], v126 offset:17408
  v_cvt_pk_bf16_f32 v147, v150, v151
  v_mfma_f32_16x16x32_bf16 v[88:91], v[56:59], v[36:39], v[88:91]
  ds_read_b64_tr_b16 v[52:53], v127 offset:16384
  ds_read_b64_tr_b16 v[54:55], v127 offset:17408
  v_cvt_pk_bf16_f32 v152, v152, v153
  s_mov_b32 m0, s60
  s_add_u32 s60, s60, 2048
  buffer_load_dwordx4 v16, s[44:47], s56 offen lds
  v_mfma_f32_16x16x32_bf16 v[92:95], v[60:63], v[36:39], v[92:95]
  ds_read_b128 v[28:31], v122 offset:6144
  v_cvt_pk_bf16_f32 v153, v154, v155
  v_mfma_f32_16x16x32_bf16 v[96:99], v[64:67], v[36:39], v[96:99]
  v_cvt_pk_bf16_f32 v154, v156, v157
  buffer_load_dwordx4 v17, s[44:47], s56 offen offset:1024 lds
  s_add_u32 s56, s56, s84
  v_mfma_f32_16x16x32_bf16 v[100:103], v[68:71], v[36:39], v[100:103]
  v_cvt_pk_bf16_f32 v155, v158, v159
  s_waitcnt lgkmcnt(7)
  v_mfma_f32_16x16x32_bf16 v[72:75], v[40:43], v[24:27], v[72:75]
  ds_read_b128 v[32:35], v123 offset:2048
  ds_read_b64_tr_b16 v[56:57], v124 offset:24576
  v_cvt_pk_bf16_f32 v160, v160, v161
  s_waitcnt lgkmcnt(7)
  v_mfma_f32_16x16x32_bf16 v[76:79], v[44:47], v[24:27], v[76:79]
  ds_read_b64_tr_b16 v[58:59], v124 offset:25600
  ds_read_b64_tr_b16 v[60:61], v125 offset:24576
  v_cvt_pk_bf16_f32 v161, v162, v163
  buffer_store_dwordx4 v[128:131], v2, s[36:39], s48 offen offset:0 sc1
  s_waitcnt lgkmcnt(7)
  v_mfma_f32_16x16x32_bf16 v[80:83], v[48:51], v[24:27], v[80:83]
  ds_read_b64_tr_b16 v[62:63], v125 offset:25600
  v_cvt_pk_bf16_f32 v162, v164, v165
  s_waitcnt lgkmcnt(6)
  v_mfma_f32_16x16x32_bf16 v[84:87], v[52:55], v[24:27], v[84:87]
  ds_read_b64_tr_b16 v[64:65], v126 offset:24576
  ds_read_b64_tr_b16 v[66:67], v126 offset:25600
  v_cvt_pk_bf16_f32 v163, v166, v167
  s_waitcnt lgkmcnt(7)
  v_mfma_f32_16x16x32_bf16 v[88:91], v[40:43], v[28:31], v[88:91]
  ds_read_b64_tr_b16 v[68:69], v127 offset:24576
  ds_read_b64_tr_b16 v[70:71], v127 offset:25600
  v_cvt_pk_bf16_f32 v168, v168, v169
  v_mfma_f32_16x16x32_bf16 v[92:95], v[44:47], v[28:31], v[92:95]
  ds_read_b128 v[36:39], v123 offset:6144
  v_cvt_pk_bf16_f32 v169, v170, v171
  v_mfma_f32_16x16x32_bf16 v[96:99], v[48:51], v[28:31], v[96:99]
  v_cvt_pk_bf16_f32 v170, v172, v173
  v_mfma_f32_16x16x32_bf16 v[100:103], v[52:55], v[28:31], v[100:103]
  v_cvt_pk_bf16_f32 v171, v174, v175
  s_waitcnt vmcnt(15) lgkmcnt(0)
  s_barrier
  v_mfma_f32_16x16x32_bf16 v[72:75], v[56:59], v[32:35], v[72:75]
  ds_read_b128 v[24:27], v120 offset:0
  ds_read_b64_tr_b16 v[40:41], v124 offset:32768
  v_cvt_pk_bf16_f32 v240, v240, v241
  v_mfma_f32_16x16x32_bf16 v[76:79], v[60:63], v[32:35], v[76:79]
  ds_read_b64_tr_b16 v[42:43], v124 offset:33792
  ds_read_b64_tr_b16 v[44:45], v125 offset:32768
  v_cvt_pk_bf16_f32 v241, v242, v243
  s_mov_b32 m0, s86
  s_add_u32 s86, s86, 16384
  buffer_load_dwordx4 v18, s[40:43], s57 offen sc1 lds
  v_mfma_f32_16x16x32_bf16 v[80:83], v[64:67], v[32:35], v[80:83]
  ds_read_b64_tr_b16 v[46:47], v125 offset:33792
  v_cvt_pk_bf16_f32 v242, v244, v245
  buffer_load_dwordx4 v19, s[40:43], s57 offen offset:1024 sc1 lds
  s_and_b32 s86, s86, 0xffff
  s_add_u32 s57, s57, s58
  v_mfma_f32_16x16x32_bf16 v[84:87], v[68:71], v[32:35], v[84:87]
  ds_read_b64_tr_b16 v[48:49], v126 offset:32768
  ds_read_b64_tr_b16 v[50:51], v126 offset:33792
  v_cvt_pk_bf16_f32 v243, v246, v247
  v_mfma_f32_16x16x32_bf16 v[88:91], v[56:59], v[36:39], v[88:91]
  ds_read_b64_tr_b16 v[52:53], v127 offset:32768
  ds_read_b64_tr_b16 v[54:55], v127 offset:33792
  v_cvt_pk_bf16_f32 v244, v248, v249
  s_mov_b32 m0, s60
  s_add_u32 s60, s60, 30720
  buffer_load_dwordx4 v16, s[44:47], s56 offen lds
  v_mfma_f32_16x16x32_bf16 v[92:95], v[60:63], v[36:39], v[92:95]
  ds_read_b128 v[28:31], v120 offset:4096
  v_cvt_pk_bf16_f32 v245, v250, v251
  v_mfma_f32_16x16x32_bf16 v[96:99], v[64:67], v[36:39], v[96:99]
  v_cvt_pk_bf16_f32 v246, v252, v253
  buffer_load_dwordx4 v17, s[44:47], s56 offen offset:1024 lds
  s_add_u32 s56, s56, s87
  s_cmp_ge_u32 s60, 163840
  s_cselect_b32 s60, s88, s60
  v_mfma_f32_16x16x32_bf16 v[100:103], v[68:71], v[36:39], v[100:103]
  v_cvt_pk_bf16_f32 v247, v254, v255
  s_waitcnt lgkmcnt(7)
  v_mfma_f32_16x16x32_bf16 v[72:75], v[40:43], v[24:27], v[72:75]
  ds_read_b128 v[32:35], v121 offset:0
  ds_read_b64_tr_b16 v[56:57], v124 offset:40960
  v_cvt_pk_bf16_f32 v248, v224, v225
  s_waitcnt lgkmcnt(7)
  v_mfma_f32_16x16x32_bf16 v[76:79], v[44:47], v[24:27], v[76:79]
  ds_read_b64_tr_b16 v[58:59], v124 offset:41984
  ds_read_b64_tr_b16 v[60:61], v125 offset:40960
  v_cvt_pk_bf16_f32 v249, v226, v227
  buffer_store_dwordx4 v[136:139], v2, s[36:39], s48 offen offset:1024 sc1
  s_add_u32 s48, s48, s34
  s_xor_b32 s34, s34, s35
  s_waitcnt lgkmcnt(7)
  v_mfma_f32_16x16x32_bf16 v[80:83], v[48:51], v[24:27], v[80:83]
  ds_read_b64_tr_b16 v[62:63], v125 offset:41984
  v_cvt_pk_bf16_f32 v250, v228, v229
  s_waitcnt lgkmcnt(6)
  v_mfma_f32_16x16x32_bf16 v[84:87], v[52:55], v[24:27], v[84:87]
  ds_read_b64_tr_b16 v[64:65], v126 offset:40960
  ds_read_b64_tr_b16 v[66:67], v126 offset:41984
  v_cvt_pk_bf16_f32 v251, v230, v231
  s_waitcnt lgkmcnt(7)
  v_mfma_f32_16x16x32_bf16 v[88:91], v[40:43], v[28:31], v[88:91]
  ds_read_b64_tr_b16 v[68:69], v127 offset:40960
  ds_read_b64_tr_b16 v[70:71], v127 offset:41984
  v_cvt_pk_bf16_f32 v252, v232, v233
  v_mfma_f32_16x16x32_bf16 v[92:95], v[44:47], v[28:31], v[92:95]
  ds_read_b128 v[36:39], v121 offset:4096
  v_cvt_pk_bf16_f32 v253, v234, v235
  v_mfma_f32_16x16x32_bf16 v[96:99], v[48:51], v[28:31], v[96:99]
  v_cvt_pk_bf16_f32 v254, v236, v237
  v_mfma_f32_16x16x32_bf16 v[100:103], v[52:55], v[28:31], v[100:103]
  v_cvt_pk_bf16_f32 v255, v238, v239
  s_waitcnt vmcnt(15) lgkmcnt(0)
  s_barrier
  v_mfma_f32_16x16x32_bf16 v[72:75], v[56:59], v[32:35], v[72:75]
  ds_read_b128 v[24:27], v120 offset:2048
  ds_read_b64_tr_b16 v[40:41], v124 offset:49152
  v_cvt_pk_bf16_f32 v216, v216, v217
  v_mfma_f32_16x16x32_bf16 v[76:79], v[60:63], v[32:35], v[76:79]
  ds_read_b64_tr_b16 v[42:43], v124 offset:50176
  ds_read_b64_tr_b16 v[44:45], v125 offset:49152
  v_cvt_pk_bf16_f32 v217, v218, v219
  s_mov_b32 m0, s86
  s_add_u32 s86, s86, 16384
  buffer_load_dwordx4 v18, s[40:43], s57 offen sc1 lds
  v_mfma_f32_16x16x32_bf16 v[80:83], v[64:67], v[32:35], v[80:83]
  ds_read_b64_tr_b16 v[46:47], v125 offset:50176
  v_cvt_pk_bf16_f32 v218, v220, v221
  buffer_load_dwordx4 v19, s[40:43], s57 offen offset:1024 sc1 lds
  s_and_b32 s86, s86, 0xffff
  s_add_u32 s57, s57, s58
  v_mfma_f32_16x16x32_bf16 v[84:87], v[68:71], v[32:35], v[84:87]
  ds_read_b64_tr_b16 v[48:49], v126 offset:49152
  ds_read_b64_tr_b16 v[50:51], v126 offset:50176
  v_cvt_pk_bf16_f32 v219, v222, v223
  v_mfma_f32_16x16x32_bf16 v[88:91], v[56:59], v[36:39], v[88:91]
  ds_read_b64_tr_b16 v[52:53], v127 offset:49152
  ds_read_b64_tr_b16 v[54:55], v127 offset:50176
  v_cvt_pk_bf16_f32 v220, v208, v209
  s_mov_b32 m0, s60
  s_add_u32 s60, s60, 2048
  buffer_load_dwordx4 v16, s[44:47], s56 offen lds
  v_mfma_f32_16x16x32_bf16 v[92:95], v[60:63], v[36:39], v[92:95]
  ds_read_b128 v[28:31], v120 offset:6144
  v_cvt_pk_bf16_f32 v221, v210, v211
  v_mfma_f32_16x16x32_bf16 v[96:99], v[64:67], v[36:39], v[96:99]
  v_cvt_pk_bf16_f32 v222, v212, v213
  buffer_load_dwordx4 v17, s[44:47], s56 offen offset:1024 lds
  s_add_u32 s56, s56, s84
  v_mfma_f32_16x16x32_bf16 v[100:103], v[68:71], v[36:39], v[100:103]
  v_cvt_pk_bf16_f32 v223, v214, v215
  s_waitcnt lgkmcnt(7)
  v_mfma_f32_16x16x32_bf16 v[72:75], v[40:43], v[24:27], v[72:75]
  ds_read_b128 v[32:35], v121 offset:2048
  ds_read_b64_tr_b16 v[56:57], v124 offset:57344
  v_cvt_pk_bf16_f32 v224, v176, v177
  v_cvt_pk_bf16_f32 v225, v178, v179
  s_waitcnt lgkmcnt(7)
  v_mfma_f32_16x16x32_bf16 v[76:79], v[44:47], v[24:27], v[76:79]
  ds_read_b64_tr_b16 v[58:59], v124 offset:58368
  ds_read_b64_tr_b16 v[60:61], v125 offset:57344
  v_cvt_pk_bf16_f32 v226, v180, v181
  v_cvt_pk_bf16_f32 v227, v182, v183
  buffer_store_dwordx4 v[144:147], v2, s[36:39], s48 offen offset:0 sc1
  s_waitcnt lgkmcnt(7)
  v_mfma_f32_16x16x32_bf16 v[80:83], v[48:51], v[24:27], v[80:83]
  ds_read_b64_tr_b16 v[62:63], v125 offset:58368
  v_cvt_pk_bf16_f32 v228, v184, v185
  v_cvt_pk_bf16_f32 v229, v186, v187
  s_waitcnt lgkmcnt(6)
  v_mfma_f32_16x16x32_bf16 v[84:87], v[52:55], v[24:27], v[84:87]
  ds_read_b64_tr_b16 v[64:65], v126 offset:57344
  ds_read_b64_tr_b16 v[66:67], v126 offset:58368
  v_cvt_pk_bf16_f32 v230, v188, v189
  s_waitcnt lgkmcnt(7)
  v_mfma_f32_16x16x32_bf16 v[88:91], v[40:43], v[28:31], v[88:91]
  ds_read_b64_tr_b16 v[68:69], v127 offset:57344
  ds_read_b64_tr_b16 v[70:71], v127 offset:58368
  v_cvt_pk_bf16_f32 v231, v190, v191
  v_cvt_pk_bf16_f32 v232, v192, v193
  v_mfma_f32_16x16x32_bf16 v[92:95], v[44:47], v[28:31], v[92:95]
  ds_read_b128 v[36:39], v121 offset:6144
  v_cvt_pk_bf16_f32 v233, v194, v195
  v_cvt_pk_bf16_f32 v234, v196, v197
  v_mfma_f32_16x16x32_bf16 v[96:99], v[48:51], v[28:31], v[96:99]
  v_cvt_pk_bf16_f32 v235, v198, v199
  v_cvt_pk_bf16_f32 v236, v200, v201
  v_mfma_f32_16x16x32_bf16 v[100:103], v[52:55], v[28:31], v[100:103]
  v_cvt_pk_bf16_f32 v237, v202, v203
  s_waitcnt vmcnt(13) lgkmcnt(0)
  s_barrier
  v_mfma_f32_16x16x32_bf16 v[72:75], v[56:59], v[32:35], v[72:75]
  ds_read_b128 v[24:27], v120 offset:32768
  ds_read_b64_tr_b16 v[40:41], v124 offset:0
  v_cvt_pk_bf16_f32 v238, v204, v205
  v_cvt_pk_bf16_f32 v239, v206, v207
  v_mfma_f32_16x16x32_bf16 v[76:79], v[60:63], v[32:35], v[76:79]
  ds_read_b64_tr_b16 v[42:43], v124 offset:1024
  ds_read_b64_tr_b16 v[44:45], v125 offset:0
  v_lshrrev_b32 v8, 4, v1
  v_and_b32 v20, 15, v1
  s_mov_b32 m0, s86
  s_add_u32 s86, s86, 16384
  buffer_load_dwordx4 v18, s[40:43], s57 offen sc1 lds
  v_mfma_f32_16x16x32_bf16 v[80:83], v[64:67], v[32:35], v[80:83]
  ds_read_b64_tr_b16 v[46:47], v125 offset:1024
  v_lshlrev_b32 v9, 1, v8
  buffer_load_dwordx4 v19, s[40:43], s57 offen offset:1024 sc1 lds
  s_and_b32 s86, s86, 0xffff
  s_add_u32 s57, s57, s58
  v_mfma_f32_16x16x32_bf16 v[84:87], v[68:71], v[32:35], v[84:87]
  ds_read_b64_tr_b16 v[48:49], v126 offset:0
  ds_read_b64_tr_b16 v[50:51], v126 offset:1024
  v_xor_b32 v20, v20, v9
  s_lshl_b32 s64, s3, 3
  v_mfma_f32_16x16x32_bf16 v[88:91], v[56:59], v[36:39], v[88:91]
  ds_read_b64_tr_b16 v[52:53], v127 offset:0
  ds_read_b64_tr_b16 v[54:55], v127 offset:1024
  s_and_b32 s64, s64, 8
  v_xor_b32 v20, s64, v20
  s_mov_b32 m0, s60
  s_add_u32 s60, s60, 30720
  buffer_load_dwordx4 v16, s[44:47], s56 offen lds
  v_mfma_f32_16x16x32_bf16 v[92:95], v[60:63], v[36:39], v[92:95]
  ds_read_b128 v[28:31], v120 offset:36864
  v_mul_u32_u24 v9, 1280, v8
  v_mfma_f32_16x16x32_bf16 v[96:99], v[64:67], v[36:39], v[96:99]
  v_lshl_add_u32 v20, v20, 4, v9
  s_mul_i32 s68, s2, 3
  buffer_load_dwordx4 v17, s[44:47], s56 offen offset:1024 lds
  s_add_u32 s56, s56, s87
  s_cmp_ge_u32 s60, 163840
  s_cselect_b32 s60, s88, s60
  v_mfma_f32_16x16x32_bf16 v[100:103], v[68:71], v[36:39], v[100:103]
  s_mul_i32 s69, s3, 5120
  s_waitcnt lgkmcnt(7)
  v_mfma_f32_16x16x32_bf16 v[72:75], v[40:43], v[24:27], v[72:75]
  ds_read_b128 v[32:35], v121 offset:32768
  ds_read_b64_tr_b16 v[56:57], v124 offset:8192
  s_mul_i32 s64, s68, 52429
  s_lshr_b32 s64, s64, 18
  s_mul_i32 s65, s64, 5
  s_waitcnt lgkmcnt(7)
  v_mfma_f32_16x16x32_bf16 v[76:79], v[44:47], v[24:27], v[76:79]
  ds_read_b64_tr_b16 v[58:59], v124 offset:9216
  ds_read_b64_tr_b16 v[60:61], v125 offset:8192
  s_sub_u32 s65, s68, s65
  s_add_u32 s68, s68, 1
  s_lshl3_add_u32 s66, s65, s3
  buffer_store_dwordx4 v[152:155], v2, s[36:39], s48 offen offset:1024 sc1
  s_add_u32 s48, s48, s34
  s_xor_b32 s34, s34, s35
  s_waitcnt lgkmcnt(7)
  v_mfma_f32_16x16x32_bf16 v[80:83], v[48:51], v[24:27], v[80:83]
  ds_read_b64_tr_b16 v[62:63], v125 offset:9216
  s_mul_i32 s96, s66, 52
  s_lshr_b32 s96, s96, 8
  s_mul_i32 s96, s96, 147
  s_waitcnt lgkmcnt(6)
  v_mfma_f32_16x16x32_bf16 v[84:87], v[52:55], v[24:27], v[84:87]
  ds_read_b64_tr_b16 v[64:65], v126 offset:8192
  ds_read_b64_tr_b16 v[66:67], v126 offset:9216
  s_add_u32 s96, s96, s64
  s_mul_i32 s96, s96, 5
  s_waitcnt lgkmcnt(7)
  v_mfma_f32_16x16x32_bf16 v[88:91], v[40:43], v[28:31], v[88:91]
  ds_read_b64_tr_b16 v[68:69], v127 offset:8192
  ds_read_b64_tr_b16 v[70:71], v127 offset:9216
  s_add_u32 s96, s96, s66
  s_lshl_b32 s96, s96, 10
  s_add_u32 s96, s96, 71303168
  v_mfma_f32_16x16x32_bf16 v[92:95], v[44:47], v[28:31], v[92:95]
  ds_read_b128 v[36:39], v121 offset:36864
  s_cmp_lt_u32 s64, 148
  s_cselect_b32 s96, s96, 92274688
  s_lshl_b32 s65, s65, 8
  s_add_u32 s65, s65, s69
  v_mfma_f32_16x16x32_bf16 v[96:99], v[48:51], v[28:31], v[96:99]
  s_mov_b32 s46, 819200
  s_cmp_lt_u32 s64, 128
  s_cselect_b32 s44, s26, s14
  s_cselect_b32 s45, s27, s15
  s_cselect_b32 s46, 5242880, s46
  s_and_b32 s64, s64, 127
  v_mfma_f32_16x16x32_bf16 v[100:103], v[52:55], v[28:31], v[100:103]
  s_mul_i32 s64, s64, 40960
  s_add_u32 s67, s64, s65
  s_waitcnt vmcnt(13) lgkmcnt(0)
  s_barrier
  v_mfma_f32_16x16x32_bf16 v[72:75], v[56:59], v[32:35], v[72:75]
  ds_read_b128 v[24:27], v120 offset:34816
  ds_read_b64_tr_b16 v[40:41], v124 offset:16384
  s_and_b32 s70, s3, 3
  v_mfma_f32_16x16x32_bf16 v[76:79], v[60:63], v[32:35], v[76:79]
  ds_read_b64_tr_b16 v[42:43], v124 offset:17408
  ds_read_b64_tr_b16 v[44:45], v125 offset:16384
  s_lshl_b32 s70, s70, 5
  s_add_u32 m0, s88, 32768
  s_nop 0
  buffer_load_dwordx4 v20, s[44:47], s67 offen lds
  v_mfma_f32_16x16x32_bf16 v[80:83], v[64:67], v[32:35], v[80:83]
  ds_read_b64_tr_b16 v[46:47], v125 offset:17408
  v_mfma_f32_16x16x32_bf16 v[84:87], v[68:71], v[32:35], v[84:87]
  ds_read_b64_tr_b16 v[48:49], v126 offset:16384
  ds_read_b64_tr_b16 v[50:51], v126 offset:17408
  v_xor_b32 v21, s70, v124
  s_mov_b32 m0, s86
  s_add_u32 s86, s86, 16384
  buffer_load_dwordx4 v18, s[40:43], s57 offen sc1 lds
  v_mfma_f32_16x16x32_bf16 v[88:91], v[56:59], v[36:39], v[88:91]
  ds_read_b64_tr_b16 v[52:53], v127 offset:16384
  ds_read_b64_tr_b16 v[54:55], v127 offset:17408
  v_lshl_add_u32 v21, v8, 11, v21
  v_mfma_f32_16x16x32_bf16 v[92:95], v[60:63], v[36:39], v[92:95]
  ds_read_b128 v[28:31], v120 offset:38912
  buffer_load_dwordx4 v19, s[40:43], s57 offen offset:1024 sc1 lds
  s_and_b32 s86, s86, 0xffff
  s_add_u32 s57, s57, s58
  v_mfma_f32_16x16x32_bf16 v[96:99], v[64:67], v[36:39], v[96:99]
  v_add_u32 v21, 98304, v21
  v_mfma_f32_16x16x32_bf16 v[100:103], v[68:71], v[36:39], v[100:103]
  s_waitcnt lgkmcnt(7)
  v_mfma_f32_16x16x32_bf16 v[72:75], v[40:43], v[24:27], v[72:75]
  ds_read_b128 v[32:35], v121 offset:34816
  ds_read_b64_tr_b16 v[56:57], v124 offset:24576
  s_mul_i32 s64, s68, 52429
  s_lshr_b32 s64, s64, 18
  s_mul_i32 s65, s64, 5
  s_waitcnt lgkmcnt(7)
  v_mfma_f32_16x16x32_bf16 v[76:79], v[44:47], v[24:27], v[76:79]
  ds_read_b64_tr_b16 v[58:59], v124 offset:25600
  ds_read_b64_tr_b16 v[60:61], v125 offset:24576
  s_sub_u32 s65, s68, s65
  s_add_u32 s68, s68, 1
  s_lshl3_add_u32 s66, s65, s3
  buffer_store_dwordx4 v[160:163], v2, s[36:39], s48 offen offset:0 sc1
  s_waitcnt lgkmcnt(7)
  v_mfma_f32_16x16x32_bf16 v[80:83], v[48:51], v[24:27], v[80:83]
  ds_read_b64_tr_b16 v[62:63], v125 offset:25600
  s_mul_i32 s97, s66, 52
  s_lshr_b32 s97, s97, 8
  s_mul_i32 s97, s97, 147
  s_waitcnt lgkmcnt(6)
  v_mfma_f32_16x16x32_bf16 v[84:87], v[52:55], v[24:27], v[84:87]
  ds_read_b64_tr_b16 v[64:65], v126 offset:24576
  ds_read_b64_tr_b16 v[66:67], v126 offset:25600
  s_add_u32 s97, s97, s64
  s_mul_i32 s97, s97, 5
  s_waitcnt lgkmcnt(7)
  v_mfma_f32_16x16x32_bf16 v[88:91], v[40:43], v[28:31], v[88:91]
  ds_read_b64_tr_b16 v[68:69], v127 offset:24576
  ds_read_b64_tr_b16 v[70:71], v127 offset:25600
  s_add_u32 s97, s97, s66
  s_lshl_b32 s97, s97, 10
  s_add_u32 s97, s97, 71303168
  v_mfma_f32_16x16x32_bf16 v[92:95], v[44:47], v[28:31], v[92:95]
  ds_read_b128 v[36:39], v121 offset:38912
  s_cmp_lt_u32 s64, 148
  s_cselect_b32 s97, s97, 92274688
  s_lshl_b32 s65, s65, 8
  s_add_u32 s65, s65, s69
  v_mfma_f32_16x16x32_bf16 v[96:99], v[48:51], v[28:31], v[96:99]
  s_mov_b32 s46, 819200
  s_cmp_lt_u32 s64, 128
  s_cselect_b32 s44, s26, s14
  s_cselect_b32 s45, s27, s15
  s_cselect_b32 s46, 5242880, s46
  s_and_b32 s64, s64, 127
  v_mfma_f32_16x16x32_bf16 v[100:103], v[52:55], v[28:31], v[100:103]
  s_mul_i32 s64, s64, 40960
  s_add_u32 s67, s64, s65
  s_waitcnt vmcnt(12) lgkmcnt(0)
  s_barrier
  v_mfma_f32_16x16x32_bf16 v[72:75], v[56:59], v[32:35], v[72:75]
  ds_read_b128 v[24:27], v122 offset:0
  ds_read_b64_tr_b16 v[40:41], v124 offset:32768
  s_lshl_b32 s71, s3, 11
  s_add_u32 s71, s71, 32768
  v_mfma_f32_16x16x32_bf16 v[76:79], v[60:63], v[32:35], v[76:79]
  ds_read_b64_tr_b16 v[42:43], v124 offset:33792
  ds_read_b64_tr_b16 v[44:45], v125 offset:32768
  s_add_u32 s70, s71, 1600
  s_add_u32 m0, s88, 33792
  s_nop 0
  buffer_load_dwordx4 v20, s[44:47], s67 offen lds
  v_mfma_f32_16x16x32_bf16 v[80:83], v[64:67], v[32:35], v[80:83]
  ds_read_b64_tr_b16 v[46:47], v125 offset:33792
  v_lshrrev_b32 v10, 2, v1
  v_mfma_f32_16x16x32_bf16 v[84:87], v[68:71], v[32:35], v[84:87]
  ds_read_b64_tr_b16 v[48:49], v126 offset:32768
  ds_read_b64_tr_b16 v[50:51], v126 offset:33792
  v_bfe_u32 v11, v1, 1, 1
  s_mov_b32 m0, s86
  s_add_u32 s86, s86, 16384
  buffer_load_dwordx4 v18, s[40:43], s57 offen sc1 lds
  v_mfma_f32_16x16x32_bf16 v[88:91], v[56:59], v[36:39], v[88:91]
  ds_read_b64_tr_b16 v[52:53], v127 offset:32768
  ds_read_b64_tr_b16 v[54:55], v127 offset:33792
  v_mul_u32_u24 v11, 20, v11
  v_mfma_f32_16x16x32_bf16 v[92:95], v[60:63], v[36:39], v[92:95]
  ds_read_b128 v[28:31], v122 offset:4096
  v_sub_u32 v11, v10, v11
  buffer_load_dwordx4 v19, s[40:43], s57 offen offset:1024 sc1 lds
  s_and_b32 s86, s86, 0xffff
  s_add_u32 s57, s57, s58
  v_mfma_f32_16x16x32_bf16 v[96:99], v[64:67], v[36:39], v[96:99]
  v_mad_u32_u24 v10, 40, v10, s71
  v_mfma_f32_16x16x32_bf16 v[100:103], v[68:71], v[36:39], v[100:103]
  v_mov_b32 v22, s70
  s_waitcnt lgkmcnt(7)
  v_mfma_f32_16x16x32_bf16 v[72:75], v[40:43], v[24:27], v[72:75]
  ds_read_b128 v[32:35], v123 offset:0
  ds_read_b64_tr_b16 v[56:57], v124 offset:40960
  s_mul_i32 s64, s68, 52429
  s_lshr_b32 s64, s64, 18
  s_mul_i32 s65, s64, 5
  s_sub_u32 s65, s68, s65
  s_waitcnt lgkmcnt(7)
  v_mfma_f32_16x16x32_bf16 v[76:79], v[44:47], v[24:27], v[76:79]
  ds_read_b64_tr_b16 v[58:59], v124 offset:41984
  ds_read_b64_tr_b16 v[60:61], v125 offset:40960
  s_add_u32 s68, s68, 1
  s_lshl3_add_u32 s66, s65, s3
  s_mul_i32 s98, s66, 52
  buffer_store_dwordx4 v[168:171], v2, s[36:39], s48 offen offset:1024 sc1
  s_add_u32 s48, s48, s34
  s_xor_b32 s34, s34, s35
  s_waitcnt lgkmcnt(7)
  v_mfma_f32_16x16x32_bf16 v[80:83], v[48:51], v[24:27], v[80:83]
  ds_read_b64_tr_b16 v[62:63], v125 offset:41984
  s_lshr_b32 s98, s98, 8
  s_mul_i32 s98, s98, 147
  s_add_u32 s98, s98, s64
  s_waitcnt lgkmcnt(6)
  v_mfma_f32_16x16x32_bf16 v[84:87], v[52:55], v[24:27], v[84:87]
  ds_read_b64_tr_b16 v[64:65], v126 offset:40960
  ds_read_b64_tr_b16 v[66:67], v126 offset:41984
  s_mul_i32 s98, s98, 5
  s_add_u32 s98, s98, s66
  s_lshl_b32 s98, s98, 10
  s_waitcnt lgkmcnt(7)
  v_mfma_f32_16x16x32_bf16 v[88:91], v[40:43], v[28:31], v[88:91]
  ds_read_b64_tr_b16 v[68:69], v127 offset:40960
  ds_read_b64_tr_b16 v[70:71], v127 offset:41984
  s_add_u32 s98, s98, 71303168
  s_cmp_lt_u32 s64, 148
  s_cselect_b32 s98, s98, 92274688
  s_lshl_b32 s65, s65, 8
  v_mfma_f32_16x16x32_bf16 v[92:95], v[44:47], v[28:31], v[92:95]
  ds_read_b128 v[36:39], v123 offset:4096
  s_add_u32 s65, s65, s69
  s_mov_b32 s46, 819200
  s_cmp_lt_u32 s64, 128
  s_cselect_b32 s44, s26, s14
  s_cselect_b32 s45, s27, s15
  s_cselect_b32 s46, 5242880, s46
  v_mfma_f32_16x16x32_bf16 v[96:99], v[48:51], v[28:31], v[96:99]
  s_and_b32 s64, s64, 127
  s_mul_i32 s64, s64, 40960
  s_add_u32 s67, s64, s65
  v_mfma_f32_16x16x32_bf16 v[100:103], v[52:55], v[28:31], v[100:103]
  v_add_u32 v23, 0, v11
  v_cmp_gt_u32 vcc, 20, v23
  v_add_u32 v12, 0, v10
  s_waitcnt vmcnt(11) lgkmcnt(0)
  s_barrier
  v_mfma_f32_16x16x32_bf16 v[72:75], v[56:59], v[32:35], v[72:75]
  ds_read_b128 v[24:27], v122 offset:2048
  ds_read_b64_tr_b16 v[40:41], v124 offset:49152
  v_cndmask_b32 v12, v22, v12, vcc
  v_add_u32 v23, 16, v11
  v_mfma_f32_16x16x32_bf16 v[76:79], v[60:63], v[32:35], v[76:79]
  ds_read_b64_tr_b16 v[42:43], v124 offset:50176
  ds_read_b64_tr_b16 v[44:45], v125 offset:49152
  v_cmp_gt_u32 vcc, 20, v23
  v_add_u32 v13, 640, v10
  s_add_u32 m0, s88, 34816
  s_nop 0
  buffer_load_dwordx4 v20, s[44:47], s67 offen lds
  v_mfma_f32_16x16x32_bf16 v[80:83], v[64:67], v[32:35], v[80:83]
  ds_read_b64_tr_b16 v[46:47], v125 offset:50176
  v_cndmask_b32 v13, v22, v13, vcc
  v_mfma_f32_16x16x32_bf16 v[84:87], v[68:71], v[32:35], v[84:87]
  ds_read_b64_tr_b16 v[48:49], v126 offset:49152
  ds_read_b64_tr_b16 v[50:51], v126 offset:50176
  v_add_u32 v23, 32, v11
  v_cmp_gt_u32 vcc, 20, v23
  s_add_u32 m0, s86, 0
  s_nop 0
  buffer_load_dwordx4 v2, s[52:55], 0 offen lds
  v_mfma_f32_16x16x32_bf16 v[88:91], v[56:59], v[36:39], v[88:91]
  ds_read_b64_tr_b16 v[52:53], v127 offset:49152
  ds_read_b64_tr_b16 v[54:55], v127 offset:50176
  v_add_u32 v14, 1280, v10
  v_cndmask_b32 v14, v22, v14, vcc
  v_mfma_f32_16x16x32_bf16 v[92:95], v[60:63], v[36:39], v[92:95]
  ds_read_b128 v[28:31], v122 offset:6144
  v_lshlrev_b32 v10, 29, v1
  buffer_load_dwordx4 v2, s[52:55], 0 offen offset:1024 lds
  v_mfma_f32_16x16x32_bf16 v[96:99], v[64:67], v[36:39], v[96:99]
  v_and_b32 v10, 0x80000000, v10
  v_lshrrev_b32 v9, 16, v10
  v_mfma_f32_16x16x32_bf16 v[100:103], v[68:71], v[36:39], v[100:103]
  v_or_b32 v9, v9, v10
  s_waitcnt lgkmcnt(7)
  v_mfma_f32_16x16x32_bf16 v[72:75], v[40:43], v[24:27], v[72:75]
  ds_read_b128 v[32:35], v123 offset:2048
  ds_read_b64_tr_b16 v[56:57], v124 offset:57344
  s_and_b32 s66, s3, 3
  s_lshl_b32 s66, s66, 5
  v_and_b32 v22, 15, v1
  s_waitcnt lgkmcnt(7)
  v_mfma_f32_16x16x32_bf16 v[76:79], v[44:47], v[24:27], v[76:79]
  ds_read_b64_tr_b16 v[58:59], v124 offset:58368
  ds_read_b64_tr_b16 v[60:61], v125 offset:57344
  v_add_u32 v22, s66, v22
  v_lshrrev_b32 v23, 4, v1
  s_lshr_b32 s67, s3, 2
  buffer_store_dwordx4 v[224:227], v2, s[36:39], s48 offen offset:0 sc1
  s_waitcnt lgkmcnt(7)
  v_mfma_f32_16x16x32_bf16 v[80:83], v[48:51], v[24:27], v[80:83]
  ds_read_b64_tr_b16 v[62:63], v125 offset:58368
  s_mul_i32 s67, s67, 48
  v_mul_u32_u24 v17, 104, v22
  v_add_u32 v17, 114688, v17
  s_waitcnt lgkmcnt(6)
  v_mfma_f32_16x16x32_bf16 v[84:87], v[52:55], v[24:27], v[84:87]
  ds_read_b64_tr_b16 v[64:65], v126 offset:57344
  ds_read_b64_tr_b16 v[66:67], v126 offset:58368
  v_lshl_add_u32 v16, v23, 3, v17
  v_add_u32 v16, s67, v16
  s_waitcnt lgkmcnt(7)
  v_mfma_f32_16x16x32_bf16 v[88:91], v[40:43], v[28:31], v[88:91]
  ds_read_b64_tr_b16 v[68:69], v127 offset:57344
  ds_read_b64_tr_b16 v[70:71], v127 offset:58368
  v_mov_b32 v10, 0x3f803f80
  v_mov_b32 v11, 0x3f803f80
  v_mul_u32_u24 v18, 168, v22
  buffer_store_dwordx4 v[228:231], v2, s[36:39], s48 offen offset:1024 sc1
  s_add_u32 s48, s48, s34
  s_xor_b32 s34, s34, s35
  v_mfma_f32_16x16x32_bf16 v[92:95], v[44:47], v[28:31], v[92:95]
  ds_read_b128 v[36:39], v123 offset:6144
  v_mad_u32_u24 v18, 40, v23, v18
  v_add_u32 v18, 131072, v18
  v_bfe_u32 v23, v1, 4, 1
  v_mfma_f32_16x16x32_bf16 v[96:99], v[48:51], v[28:31], v[96:99]
  v_lshl_add_u32 v22, v23, 11, v22
  v_lshrrev_b32 v23, 5, v1
  v_mul_u32_u24 v23, 163840, v23
  v_mfma_f32_16x16x32_bf16 v[100:103], v[52:55], v[28:31], v[100:103]
  v_lshl_add_u32 v19, v22, 3, v23
  v_lshl_add_u32 v22, v22, 4, v23
  s_waitcnt vmcnt(10) lgkmcnt(0)
  s_barrier
  v_mfma_f32_16x16x32_bf16 v[72:75], v[56:59], v[32:35], v[72:75]
  ds_read_b128 v[24:27], v120 offset:0
  ds_read_b64_tr_b16 v[40:41], v124 offset:0
  s_mul_i32 s49, s80, 327680
  s_add_u32 s49, s49, 79691776
  s_lshl_b32 s66, s83, 10
  v_mfma_f32_16x16x32_bf16 v[76:79], v[60:63], v[32:35], v[76:79]
  ds_read_b64_tr_b16 v[42:43], v124 offset:1024
  ds_read_b64_tr_b16 v[44:45], v125 offset:0
  s_add_u32 s51, s49, s66
  s_add_u32 s49, s51, s66
  s_add_u32 s50, s49, 65536
  v_mfma_f32_16x16x32_bf16 v[80:83], v[64:67], v[32:35], v[80:83]
  ds_read_b64_tr_b16 v[46:47], v125 offset:1024
  s_add_u32 s51, s51, 131072
  s_mov_b32 s8, 0x3fb8aa3b
  s_mov_b32 s9, s8
  v_mfma_f32_16x16x32_bf16 v[84:87], v[68:71], v[32:35], v[84:87]
  ds_read_b64_tr_b16 v[48:49], v126 offset:0
  ds_read_b64_tr_b16 v[50:51], v126 offset:1024
  s_movk_i32 s10, 104
  s_mul_i32 s12, s3, 40
  v_mfma_f32_16x16x32_bf16 v[88:91], v[56:59], v[36:39], v[88:91]
  ds_read_b64_tr_b16 v[52:53], v127 offset:0
  ds_read_b64_tr_b16 v[54:55], v127 offset:1024
  s_add_u32 s12, s12, 131072
  s_lshr_b32 s64, s3, 1
  s_mul_i32 s13, s64, 40
  v_mfma_f32_16x16x32_bf16 v[92:95], v[60:63], v[36:39], v[92:95]
  ds_read_b128 v[28:31], v120 offset:4096
  s_add_u32 s13, s13, 114688
  s_lshl1_add_u32 s64, s80, s64
  s_lshl4_add_u32 s64, s64, s83
  v_mfma_f32_16x16x32_bf16 v[96:99], v[64:67], v[36:39], v[96:99]
  s_lshl_b32 s64, s64, 12
  s_and_b32 s11, s3, 1
  s_mul_i32 s11, s11, 1920
  v_mfma_f32_16x16x32_bf16 v[100:103], v[68:71], v[36:39], v[100:103]
  s_add_u32 s11, s64, s11
  s_add_u32 s11, s11, 85983232
  s_waitcnt lgkmcnt(7)
  v_mfma_f32_16x16x32_bf16 v[72:75], v[40:43], v[24:27], v[72:75]
  ds_read_b128 v[32:35], v121 offset:0
  ds_read_b64_tr_b16 v[56:57], v124 offset:8192
  s_and_b32 s80, s2, 7
  s_bfe_u32 s4, s2, 0x20003
  s_waitcnt lgkmcnt(7)
  v_mfma_f32_16x16x32_bf16 v[76:79], v[44:47], v[24:27], v[76:79]
  ds_read_b64_tr_b16 v[58:59], v124 offset:9216
  ds_read_b64_tr_b16 v[60:61], v125 offset:8192
  s_lshl2_add_u32 s4, s80, s4
  s_lshr_b32 s5, s2, 5
  buffer_store_dwordx4 v[232:235], v2, s[36:39], s48 offen offset:0 sc1
  s_waitcnt lgkmcnt(7)
  v_mfma_f32_16x16x32_bf16 v[80:83], v[48:51], v[24:27], v[80:83]
  ds_read_b64_tr_b16 v[62:63], v125 offset:9216
  s_lshr_b32 s6, s3, 2
  s_and_b32 s7, s3, 3
  s_waitcnt lgkmcnt(6)
  v_mfma_f32_16x16x32_bf16 v[84:87], v[52:55], v[24:27], v[84:87]
  ds_read_b64_tr_b16 v[64:65], v126 offset:8192
  ds_read_b64_tr_b16 v[66:67], v126 offset:9216
  s_lshl_b32 s66, s3, 11
  s_lshl_b32 s80, s5, 2
  s_waitcnt lgkmcnt(7)
  v_mfma_f32_16x16x32_bf16 v[88:91], v[40:43], v[28:31], v[88:91]
  ds_read_b64_tr_b16 v[68:69], v127 offset:8192
  ds_read_b64_tr_b16 v[70:71], v127 offset:9216
  s_add_u32 s60, s80, s7
  s_sub_u32 s61, 60, s80
  v_mfma_f32_16x16x32_bf16 v[92:95], v[44:47], v[28:31], v[92:95]
  ds_read_b128 v[36:39], v121 offset:4096
  s_add_u32 s61, s61, s7
  s_xor_b32 s61, s61, 2
  v_mfma_f32_16x16x32_bf16 v[96:99], v[48:51], v[28:31], v[96:99]
  s_cmp_eq_u32 s6, 0
  s_cselect_b32 s60, s60, s61
  v_lshrrev_b32 v20, 4, v1
  v_mfma_f32_16x16x32_bf16 v[100:103], v[52:55], v[28:31], v[100:103]
  v_and_b32 v23, 15, v1
  s_waitcnt vmcnt(3) lgkmcnt(0)
  s_barrier
  v_mfma_f32_16x16x32_bf16 v[72:75], v[56:59], v[32:35], v[72:75]
  ds_read_b128 v[24:27], v120 offset:2048
  ds_read_b64_tr_b16 v[40:41], v124 offset:16384
  s_and_b32 s80, s3, 1
  s_lshl_b32 s80, s80, 7
  v_mfma_f32_16x16x32_bf16 v[76:79], v[60:63], v[32:35], v[76:79]
  ds_read_b64_tr_b16 v[42:43], v124 offset:17408
  ds_read_b64_tr_b16 v[44:45], v125 offset:16384
  s_lshl_b32 s24, s3, 16
  v_lshlrev_b32 v6, 1, v20
  v_mfma_f32_16x16x32_bf16 v[80:83], v[64:67], v[32:35], v[80:83]
  ds_read_b64_tr_b16 v[46:47], v125 offset:17408
  v_xor_b32 v23, v23, v6
  v_lshlrev_b32 v23, 4, v23
  v_mfma_f32_16x16x32_bf16 v[84:87], v[68:71], v[32:35], v[84:87]
  ds_read_b64_tr_b16 v[48:49], v126 offset:16384
  ds_read_b64_tr_b16 v[50:51], v126 offset:17408
  v_xor_b32 v23, s80, v23
  v_mfma_f32_16x16x32_bf16 v[88:91], v[56:59], v[36:39], v[88:91]
  ds_read_b64_tr_b16 v[52:53], v127 offset:16384
  ds_read_b64_tr_b16 v[54:55], v127 offset:17408
  v_lshl_add_u32 v6, v20, 13, v23
  s_add_u32 s25, s24, 31744
  v_mfma_f32_16x16x32_bf16 v[92:95], v[60:63], v[36:39], v[92:95]
  ds_read_b128 v[28:31], v120 offset:6144
  s_mul_i32 s26, s60, 40960
  s_lshl_b32 s81, s4, 8
  v_mfma_f32_16x16x32_bf16 v[96:99], v[64:67], v[36:39], v[96:99]
  s_mov_b32 s22, 5234944
  s_mov_b32 s23, 0x00020000
  v_mfma_f32_16x16x32_bf16 v[100:103], v[68:71], v[36:39], v[100:103]
  s_add_u32 s20, s20, s81
  s_addc_u32 s21, s21, 0
  s_waitcnt lgkmcnt(7)
  v_mfma_f32_16x16x32_bf16 v[72:75], v[40:43], v[24:27], v[72:75]
  ds_read_b128 v[32:35], v121 offset:2048
  ds_read_b64_tr_b16 v[56:57], v124 offset:24576
  ds_read_b64_tr_b16 v[58:59], v124 offset:25600
  ds_read_b64_tr_b16 v[60:61], v125 offset:24576
  s_waitcnt lgkmcnt(9)
  v_mfma_f32_16x16x32_bf16 v[76:79], v[44:47], v[24:27], v[76:79]
  ds_read_b64_tr_b16 v[62:63], v125 offset:25600
  ds_read_b64_tr_b16 v[64:65], v126 offset:24576
  ds_read_b64_tr_b16 v[66:67], v126 offset:25600
  ds_read_b64_tr_b16 v[68:69], v127 offset:24576
  buffer_store_dwordx4 v[236:239], v2, s[36:39], s48 offen offset:1024 sc1
  s_add_u32 s48, s48, s34
  s_xor_b32 s34, s34, s35
  s_waitcnt lgkmcnt(11)
  v_mfma_f32_16x16x32_bf16 v[80:83], v[48:51], v[24:27], v[80:83]
  ds_read_b64_tr_b16 v[70:71], v127 offset:25600
  ds_read_b128 v[36:39], v121 offset:6144
  ds_read_b64_tr_b16 v[128:129], v12 offset:0
  ds_read_b64_tr_b16 v[130:131], v13 offset:0
  s_waitcnt lgkmcnt(13)
  v_mfma_f32_16x16x32_bf16 v[84:87], v[52:55], v[24:27], v[84:87]
  ds_read_b64_tr_b16 v[132:133], v14 offset:0
  ds_read_b64_tr_b16 v[136:137], v12 offset:8
  ds_read_b64_tr_b16 v[138:139], v13 offset:8
  ds_read_b64_tr_b16 v[140:141], v14 offset:8
  s_waitcnt lgkmcnt(15)
  v_mfma_f32_16x16x32_bf16 v[88:91], v[40:43], v[28:31], v[88:91]
  ds_read_b64_tr_b16 v[144:145], v12 offset:16
  ds_read_b64_tr_b16 v[146:147], v13 offset:16
  ds_read_b64_tr_b16 v[148:149], v14 offset:16
  ds_read_b64_tr_b16 v[152:153], v12 offset:24
  v_mfma_f32_16x16x32_bf16 v[92:95], v[44:47], v[28:31], v[92:95]
  ds_read_b64_tr_b16 v[154:155], v13 offset:24
  ds_read_b64_tr_b16 v[156:157], v14 offset:24
  ds_read_b64_tr_b16 v[160:161], v12 offset:32
  ds_read_b64_tr_b16 v[162:163], v13 offset:32
  v_mfma_f32_16x16x32_bf16 v[96:99], v[48:51], v[28:31], v[96:99]
  ds_read_b64_tr_b16 v[164:165], v14 offset:32
  ds_read_b64_tr_b16 v[176:177], v21 offset:0
  ds_read_b64_tr_b16 v[178:179], v21 offset:16384
  ds_read_b64_tr_b16 v[180:181], v21 offset:1024
  v_mfma_f32_16x16x32_bf16 v[100:103], v[52:55], v[28:31], v[100:103]
  ds_read_b64_tr_b16 v[182:183], v21 offset:17408
  ds_read_b64_tr_b16 v[184:185], v21 offset:2048
  ds_read_b64_tr_b16 v[186:187], v21 offset:18432
  s_waitcnt lgkmcnt(0)
  s_barrier
  v_mfma_f32_16x16x32_bf16 v[72:75], v[56:59], v[32:35], v[72:75]
  v_mov_b32 v134, 0
  v_mov_b32 v135, 0
  v_mov_b32 v142, 0
  v_mov_b32 v143, 0
  v_mov_b32 v150, 0
  v_mfma_f32_16x16x32_bf16 v[76:79], v[60:63], v[32:35], v[76:79]
  v_mov_b32 v151, 0
  v_mov_b32 v158, 0
  v_mov_b32 v159, 0
  v_mov_b32 v166, 0
  v_mov_b32 v167, 0
  s_add_u32 m0, s66, 0
  s_nop 0
  buffer_load_dwordx4 v6, s[20:23], s24 offen lds
  s_add_u32 s24, s24, 524288
  v_mfma_f32_16x16x32_bf16 v[80:83], v[64:67], v[32:35], v[80:83]
  v_xor_b32 v128, v9, v128
  v_xor_b32 v129, v9, v129
  v_xor_b32 v130, v9, v130
  v_xor_b32 v131, v9, v131
  v_xor_b32 v132, v9, v132
  v_mfma_f32_16x16x32_bf16 v[84:87], v[68:71], v[32:35], v[84:87]
  v_xor_b32 v133, v9, v133
  v_xor_b32 v136, v9, v136
  v_xor_b32 v137, v9, v137
  v_xor_b32 v138, v9, v138
  v_xor_b32 v139, v9, v139
  v_mfma_f32_16x16x32_bf16 v[88:91], v[56:59], v[36:39], v[88:91]
  v_xor_b32 v140, v9, v140
  v_xor_b32 v141, v9, v141
  v_xor_b32 v144, v9, v144
  v_xor_b32 v145, v9, v145
  v_xor_b32 v146, v9, v146
  buffer_load_dwordx4 v6, s[20:23], s25 offen offset:1024 lds
  s_add_u32 s25, s25, 524288
  v_mfma_f32_16x16x32_bf16 v[92:95], v[60:63], v[36:39], v[92:95]
  v_xor_b32 v147, v9, v147
  v_xor_b32 v148, v9, v148
  v_xor_b32 v149, v9, v149
  v_xor_b32 v152, v9, v152
  v_xor_b32 v153, v9, v153
  v_mfma_f32_16x16x32_bf16 v[96:99], v[64:67], v[36:39], v[96:99]
  v_xor_b32 v154, v9, v154
  v_xor_b32 v155, v9, v155
  v_xor_b32 v156, v9, v156
  v_xor_b32 v157, v9, v157
  v_xor_b32 v160, v9, v160
  v_mfma_f32_16x16x32_bf16 v[100:103], v[68:71], v[36:39], v[100:103]
  v_xor_b32 v161, v9, v161
  v_xor_b32 v162, v9, v162
  v_xor_b32 v163, v9, v163
  v_xor_b32 v164, v9, v164
  v_xor_b32 v165, v9, v165
  v_cvt_pk_bf16_f32 v104, v72, v73
  v_cvt_pk_bf16_f32 v105, v74, v75
  v_cvt_pk_bf16_f32 v106, v76, v77
  v_cvt_pk_bf16_f32 v107, v78, v79
  v_cvt_pk_bf16_f32 v108, v80, v81
  v_cvt_pk_bf16_f32 v109, v82, v83
  v_cvt_pk_bf16_f32 v110, v84, v85
  v_cvt_pk_bf16_f32 v111, v86, v87
  v_mov_b32 v48, v176
  v_mov_b32 v49, v177
  v_mov_b32 v50, v178
  v_mov_b32 v51, v179
  v_mov_b32 v52, v180
  v_mov_b32 v53, v181
  v_mov_b32 v54, v182
  v_mov_b32 v55, v183
  v_mov_b32 v56, v184
  v_mov_b32 v57, v185
  v_mov_b32 v58, v186
  v_mov_b32 v59, v187
  v_mfma_f32_16x16x32_bf16 v[168:171], v[128:131], v[104:107], 0
  v_cvt_pk_bf16_f32 v112, v88, v89
  v_cvt_pk_bf16_f32 v113, v90, v91
  s_add_u32 m0, s66, 16384
  s_nop 0
  buffer_load_dwordx4 v6, s[20:23], s24 offen lds
  s_add_u32 s24, s24, 524288
  v_mfma_f32_16x16x32_bf16 v[172:175], v[136:139], v[104:107], 0
  v_cvt_pk_bf16_f32 v114, v92, v93
  v_mfma_f32_16x16x32_bf16 v[176:179], v[144:147], v[104:107], 0
  v_cvt_pk_bf16_f32 v115, v94, v95
  v_mfma_f32_16x16x32_bf16 v[180:183], v[152:155], v[104:107], 0
  v_cvt_pk_bf16_f32 v116, v96, v97
  v_mfma_f32_16x16x32_bf16 v[184:187], v[160:163], v[104:107], 0
  v_cvt_pk_bf16_f32 v117, v98, v99
  v_cvt_pk_bf16_f32 v118, v100, v101
  v_mfma_f32_16x16x32_bf16 v[168:171], v[132:135], v[108:111], v[168:171]
  v_cvt_pk_bf16_f32 v119, v102, v103
  buffer_load_dwordx4 v6, s[20:23], s25 offen offset:1024 lds
  s_add_u32 s25, s25, 524288
  v_mfma_f32_16x16x32_bf16 v[172:175], v[140:143], v[108:111], v[172:175]
  ds_write_b64 v16, v[110:111] offset:32
  v_mfma_f32_16x16x32_bf16 v[176:179], v[148:151], v[108:111], v[176:179]
  ds_write_b64 v17, v[10:11] offset:112
  v_mfma_f32_16x16x32_bf16 v[180:183], v[156:159], v[108:111], v[180:183]
  v_mfma_f32_16x16x32_bf16 v[184:187], v[164:167], v[108:111], v[184:187]
  v_mfma_f32_16x16x32_bf16 v[188:191], v[128:131], v[112:115], 0
  ds_write_b64 v16, v[118:119] offset:1696
  ds_write_b64 v17, v[10:11] offset:1776
  v_bfe_u32 v125, v1, 2, 2
  buffer_store_dwordx4 v[220:223], v2, s[36:39], s48 offen offset:0 sc1
  v_mfma_f32_16x16x32_bf16 v[192:195], v[136:139], v[112:115], 0
  v_lshrrev_b32 v126, 5, v1
  v_lshl_add_u32 v125, v126, 3, v125
  v_mfma_f32_16x16x32_bf16 v[196:199], v[144:147], v[112:115], 0
  v_and_b32 v127, 31, v1
  v_mad_u32_u24 v122, 24, v126, v127
  v_lshlrev_b32 v122, 4, v122
  v_mfma_f32_16x16x32_bf16 v[200:203], v[152:155], v[112:115], 0
  v_cmp_gt_u32 vcc, 24, v127
  v_bfe_u32 v126, v1, 4, 1
  v_mfma_f32_16x16x32_bf16 v[204:207], v[160:163], v[112:115], 0
  v_cndmask_b32 v122, v5, v122, vcc
  v_cmp_gt_u32 vcc, 24, v1
  v_mfma_f32_16x16x32_bf16 v[188:191], v[132:135], v[116:119], v[188:191]
  v_and_b32 v127, 3, v1
  v_cndmask_b32 v123, v5, v122, vcc
  v_lshl_add_u32 v126, v126, 2, v127
  v_mfma_f32_16x16x32_bf16 v[192:195], v[140:143], v[116:119], v[192:195]
  v_min_u32 v127, 4, v126
  v_mul_u32_u24 v120, 168, v125
  v_mfma_f32_16x16x32_bf16 v[196:199], v[148:151], v[116:119], v[196:199]
  v_lshl_add_u32 v120, v127, 3, v120
  v_add_u32 v120, s12, v120
  v_lshl_add_u32 v127, v127, 3, s13
  v_mfma_f32_16x16x32_bf16 v[200:203], v[156:159], v[116:119], v[200:203]
  v_cmp_lt_u32 vcc, 4, v126
  v_mov_b32 v126, 114784
  v_mfma_f32_16x16x32_bf16 v[204:207], v[164:167], v[116:119], v[204:207]
  v_cndmask_b32 v127, v127, v126, vcc
  v_mad_u32_u24 v121, v125, s10, v127
  s_mov_b32 exec_lo, 0
  ds_write_b64 v16, v[108:109] offset:0
  ds_write_b64 v16, v[116:117] offset:1664
  s_mov_b32 exec_lo, -1
  v_max3_f32 v208, v168, v169, v170
  buffer_load_dwordx4 v[64:67], v2, s[36:39], s26 offen offset:0 sc1
  s_add_u32 s67, s66, 65536
  v_max3_f32 v212, v188, v189, v190
  v_max3_f32 v209, v171, v172, v173
  s_lshl1_add_u32 s53, s5, 1
  v_max3_f32 v213, v191, v192, v193
  v_max3_f32 v208, v208, v174, v175
  v_max3_f32 v212, v212, v194, v195
  s_lshl_b32 s56, s53, 14
  v_max3_f32 v209, v209, v176, v177
  v_max3_f32 v213, v213, v196, v197
  v_max3_f32 v208, v208, v178, v179
  s_add_u32 s56, s56, 16384
  v_max3_f32 v212, v212, v198, v199
  v_max3_f32 v209, v209, v180, v181
  buffer_load_dwordx4 v[68:71], v2, s[36:39], s26 offen offset:1024 sc1
  v_max3_f32 v213, v213, v200, v201
  s_mov_b32 s88, s56
  v_max3_f32 v208, v208, v182, v183
  v_max3_f32 v212, v212, v202, v203
  v_max3_f32 v209, v209, v184, v185
  s_cmp_lt_u32 s3, 2
  s_subb_u32 s62, s53, 0
  v_max3_f32 v213, v213, v204, v205
  v_max3_f32 v208, v208, v186, v187
  v_max3_f32 v212, v212, v206, v207
  s_lshr_b32 s59, s7, 1
  v_max_f32 v208, v208, v209
  v_max_f32 v212, v212, v213
  v_mul_f32 v208, s8, v208
  buffer_load_dwordx4 v[72:75], v2, s[36:39], s26 offen offset:2048 sc1
  s_xor_b32 s59, s59, s6
  v_mul_f32 v212, s8, v212
  v_pk_fma_f32 v[168:169], v[168:169], s[8:9], v[208:209] op_sel_hi:[1,1,0] neg_lo:[0,0,1] neg_hi:[0,0,1]
  v_pk_fma_f32 v[188:189], v[188:189], s[8:9], v[212:213] op_sel_hi:[1,1,0] neg_lo:[0,0,1] neg_hi:[0,0,1]
  s_add_u32 s59, s59, s53
  v_pk_fma_f32 v[170:171], v[170:171], s[8:9], v[208:209] op_sel_hi:[1,1,0] neg_lo:[0,0,1] neg_hi:[0,0,1]
  v_pk_fma_f32 v[190:191], v[190:191], s[8:9], v[212:213] op_sel_hi:[1,1,0] neg_lo:[0,0,1] neg_hi:[0,0,1]
  v_pk_fma_f32 v[172:173], v[172:173], s[8:9], v[208:209] op_sel_hi:[1,1,0] neg_lo:[0,0,1] neg_hi:[0,0,1]
  s_lshl_b32 s59, s59, 1
  v_pk_fma_f32 v[192:193], v[192:193], s[8:9], v[212:213] op_sel_hi:[1,1,0] neg_lo:[0,0,1] neg_hi:[0,0,1]
  v_pk_fma_f32 v[174:175], v[174:175], s[8:9], v[208:209] op_sel_hi:[1,1,0] neg_lo:[0,0,1] neg_hi:[0,0,1]
  v_pk_fma_f32 v[194:195], v[194:195], s[8:9], v[212:213] op_sel_hi:[1,1,0] neg_lo:[0,0,1] neg_hi:[0,0,1]
  s_sub_u32 s59, 2, s59
  v_pk_fma_f32 v[176:177], v[176:177], s[8:9], v[208:209] op_sel_hi:[1,1,0] neg_lo:[0,0,1] neg_hi:[0,0,1]
  v_pk_fma_f32 v[196:197], v[196:197], s[8:9], v[212:213] op_sel_hi:[1,1,0] neg_lo:[0,0,1] neg_hi:[0,0,1]
  buffer_load_dwordx4 v[76:79], v2, s[36:39], s26 offen offset:3072 sc1
  s_add_u32 s26, s26, 4096
  v_pk_fma_f32 v[178:179], v[178:179], s[8:9], v[208:209] op_sel_hi:[1,1,0] neg_lo:[0,0,1] neg_hi:[0,0,1]
  s_mov_b32 s54, 0
  v_pk_fma_f32 v[198:199], v[198:199], s[8:9], v[212:213] op_sel_hi:[1,1,0] neg_lo:[0,0,1] neg_hi:[0,0,1]
  v_pk_fma_f32 v[180:181], v[180:181], s[8:9], v[208:209] op_sel_hi:[1,1,0] neg_lo:[0,0,1] neg_hi:[0,0,1]
  v_pk_fma_f32 v[200:201], v[200:201], s[8:9], v[212:213] op_sel_hi:[1,1,0] neg_lo:[0,0,1] neg_hi:[0,0,1]
  s_mov_b32 s55, 0
  v_pk_fma_f32 v[182:183], v[182:183], s[8:9], v[208:209] op_sel_hi:[1,1,0] neg_lo:[0,0,1] neg_hi:[0,0,1]
  v_pk_fma_f32 v[202:203], v[202:203], s[8:9], v[212:213] op_sel_hi:[1,1,0] neg_lo:[0,0,1] neg_hi:[0,0,1]
  v_pk_fma_f32 v[184:185], v[184:185], s[8:9], v[208:209] op_sel_hi:[1,1,0] neg_lo:[0,0,1] neg_hi:[0,0,1]
  s_lshl_b32 s82, s4, 19
  v_pk_fma_f32 v[204:205], v[204:205], s[8:9], v[212:213] op_sel_hi:[1,1,0] neg_lo:[0,0,1] neg_hi:[0,0,1]
  v_pk_fma_f32 v[186:187], v[186:187], s[8:9], v[208:209] op_sel_hi:[1,1,0] neg_lo:[0,0,1] neg_hi:[0,0,1]
  v_pk_fma_f32 v[206:207], v[206:207], s[8:9], v[212:213] op_sel_hi:[1,1,0] neg_lo:[0,0,1] neg_hi:[0,0,1]
  buffer_load_dwordx4 v[80:83], v2, s[36:39], s26 offen offset:0 sc1
  s_mov_b32 s43, 0x00020000
  v_exp_f32 v168, v168
  v_exp_f32 v188, v188
  v_exp_f32 v169, v169
  s_mov_b32 s42, 540672
  v_exp_f32 v189, v189
  v_exp_f32 v170, v170
  v_exp_f32 v190, v190
  s_mov_b32 s47, 0x00020000
  v_exp_f32 v171, v171
  v_exp_f32 v191, v191
  s_mov_b32 s46, 540672
  v_exp_f32 v172, v172
  v_exp_f32 v192, v192
  v_exp_f32 v173, v173
  buffer_load_dwordx4 v[84:87], v2, s[36:39], s26 offen offset:1024 sc1
  s_add_u32 s83, s82, 16777216
  v_exp_f32 v193, v193
  v_exp_f32 v174, v174
  v_exp_f32 v194, v194
  s_add_u32 s84, s82, 33554432
  v_exp_f32 v175, v175
  v_exp_f32 v195, v195
  v_exp_f32 v176, v176
  s_add_u32 s40, s32, s83
  s_addc_u32 s41, s33, 0
  v_exp_f32 v196, v196
  v_exp_f32 v177, v177
  v_exp_f32 v197, v197
  s_add_u32 s44, s32, s84
  s_addc_u32 s45, s33, 0
  v_exp_f32 v178, v178
  buffer_load_dwordx4 v[88:91], v2, s[36:39], s26 offen offset:2048 sc1
  v_exp_f32 v198, v198
  v_exp_f32 v179, v179
  s_lshl_b32 s81, s4, 14
  v_exp_f32 v199, v199
  v_exp_f32 v180, v180
  v_exp_f32 v200, v200
  s_add_u32 s81, s81, 50331648
  v_exp_f32 v181, v181
  v_exp_f32 v201, v201
  v_exp_f32 v182, v182
  s_lshr_b32 s80, s60, 1
  v_exp_f32 v202, v202
  v_exp_f32 v183, v183
  v_exp_f32 v203, v203
  buffer_load_dwordx4 v[92:95], v2, s[36:39], s26 offen offset:3072 sc1
  s_add_u32 s26, s26, 4096
  s_mul_i32 s69, s80, 606208
  v_exp_f32 v184, v184
  v_exp_f32 v204, v204
  v_exp_f32 v185, v185
  s_and_b32 s80, s60, 1
  v_exp_f32 v205, v205
  v_exp_f32 v186, v186
  v_exp_f32 v206, v206
  s_lshl_b32 s80, s80, 11
  v_exp_f32 v187, v187
  v_exp_f32 v207, v207
  v_pk_add_f32 v[208:209], v[168:169], v[170:171]
  s_add_u32 s69, s69, s80
  v_pk_add_f32 v[212:213], v[188:189], v[190:191]
  s_add_u32 m0, s66, 32768
  s_nop 0
  buffer_load_dwordx4 v6, s[20:23], s24 offen lds
  s_add_u32 s24, s24, 524288
  v_pk_add_f32 v[210:211], v[172:173], v[174:175]
  v_pk_add_f32 v[214:215], v[192:193], v[194:195]
  s_add_u32 s69, s69, s81
  v_pk_add_f32 v[208:209], v[208:209], v[176:177]
  v_pk_add_f32 v[212:213], v[212:213], v[196:197]
  v_pk_add_f32 v[210:211], v[210:211], v[178:179]
  s_lshr_b32 s80, s61, 1
  v_pk_add_f32 v[214:215], v[214:215], v[198:199]
  v_pk_add_f32 v[208:209], v[208:209], v[180:181]
  v_pk_add_f32 v[212:213], v[212:213], v[200:201]
  s_mul_i32 s70, s80, 606208
  v_pk_add_f32 v[210:211], v[210:211], v[182:183]
  v_pk_add_f32 v[214:215], v[214:215], v[202:203]
  v_pk_add_f32 v[208:209], v[208:209], v[184:185]
  buffer_load_dwordx4 v6, s[20:23], s25 offen offset:1024 lds
  s_add_u32 s25, s25, 524288
  s_and_b32 s80, s61, 1
  v_pk_add_f32 v[212:213], v[212:213], v[204:205]
  v_pk_add_f32 v[210:211], v[210:211], v[186:187]
  s_lshl_b32 s80, s80, 11
  v_pk_add_f32 v[214:215], v[214:215], v[206:207]
  v_pk_add_f32 v[208:209], v[208:209], v[210:211]
  v_pk_add_f32 v[212:213], v[212:213], v[214:215]
  s_add_u32 s70, s70, s80
  v_add_f32 v208, v208, v209
  v_add_f32 v212, v212, v213
  v_rcp_f32 v208, v208
  s_add_u32 s70, s70, s81
  v_rcp_f32 v212, v212
  v_pk_mul_f32 v[168:169], v[168:169], v[208:209] op_sel_hi:[1,0]
  buffer_store_dwordx4 v[216:219], v2, s[36:39], s48 offen offset:1024 sc1
  s_add_u32 s48, s48, s34
  s_xor_b32 s34, s34, s35
  v_pk_mul_f32 v[188:189], v[188:189], v[212:213] op_sel_hi:[1,0]
  s_mov_b32 s63, 0x71800000
  v_pk_mul_f32 v[170:171], v[170:171], v[208:209] op_sel_hi:[1,0]
  v_pk_mul_f32 v[190:191], v[190:191], v[212:213] op_sel_hi:[1,0]
  v_pk_mul_f32 v[172:173], v[172:173], v[208:209] op_sel_hi:[1,0]
  s_mov_b32 s64, s63
  v_pk_mul_f32 v[192:193], v[192:193], v[212:213] op_sel_hi:[1,0]
  v_pk_mul_f32 v[174:175], v[174:175], v[208:209] op_sel_hi:[1,0]
  v_pk_mul_f32 v[194:195], v[194:195], v[212:213] op_sel_hi:[1,0]
  s_mov_b32 s71, 0xff800000
  v_pk_mul_f32 v[176:177], v[176:177], v[208:209] op_sel_hi:[1,0]
  v_pk_mul_f32 v[196:197], v[196:197], v[212:213] op_sel_hi:[1,0]
  v_pk_mul_f32 v[178:179], v[178:179], v[208:209] op_sel_hi:[1,0]
  s_mov_b32 s65, 0xff800000
  v_pk_mul_f32 v[198:199], v[198:199], v[212:213] op_sel_hi:[1,0]
  s_add_u32 m0, s66, 49152
  s_nop 0
  buffer_load_dwordx4 v6, s[20:23], s24 offen lds
  s_add_u32 s24, s24, 524288
  v_pk_mul_f32 v[180:181], v[180:181], v[208:209] op_sel_hi:[1,0]
  v_pk_mul_f32 v[200:201], v[200:201], v[212:213] op_sel_hi:[1,0]
  s_mov_b32 s86, 0x3e0293ee
  v_pk_mul_f32 v[182:183], v[182:183], v[208:209] op_sel_hi:[1,0]
  v_pk_mul_f32 v[202:203], v[202:203], v[212:213] op_sel_hi:[1,0]
  v_pk_mul_f32 v[184:185], v[184:185], v[208:209] op_sel_hi:[1,0]
  s_mov_b32 s87, s86
  v_pk_mul_f32 v[204:205], v[204:205], v[212:213] op_sel_hi:[1,0]
  v_pk_mul_f32 v[186:187], v[186:187], v[208:209] op_sel_hi:[1,0]
  v_pk_mul_f32 v[206:207], v[206:207], v[212:213] op_sel_hi:[1,0]
  s_sub_u32 s57, 0, s60
  v_cvt_pk_bf16_f32 v128, v168, v169
  v_cvt_pk_bf16_f32 v140, v188, v189
  buffer_load_dwordx4 v6, s[20:23], s25 offen offset:1024 lds
  s_add_u32 s25, s25, 524288
  v_cvt_pk_bf16_f32 v129, v170, v171
  s_add_u32 s58, s57, 2
  v_cvt_pk_bf16_f32 v141, v190, v191
  v_cvt_pk_bf16_f32 v130, v172, v173
  v_cvt_pk_bf16_f32 v142, v192, v193
  s_lshl_b32 s85, s6, 7
  v_cvt_pk_bf16_f32 v131, v174, v175
  v_cvt_pk_bf16_f32 v143, v194, v195
  v_cvt_pk_bf16_f32 v132, v176, v177
  s_lshl1_add_u32 s84, s62, 2
  v_cvt_pk_bf16_f32 v144, v196, v197
  v_cvt_pk_bf16_f32 v133, v178, v179
  v_cvt_pk_bf16_f32 v145, v198, v199
  s_add_u32 s61, s61, 2
  v_cvt_pk_bf16_f32 v134, v180, v181
  v_cvt_pk_bf16_f32 v146, v200, v201
  v_cvt_pk_bf16_f32 v135, v182, v183
  s_cmp_eq_u32 s62, 0
  s_cselect_b32 s58, -9, s58
  v_cvt_pk_bf16_f32 v147, v202, v203
  v_cvt_pk_bf16_f32 v136, v184, v185
  v_cvt_pk_bf16_f32 v148, v204, v205
  s_cmp_eq_u32 s6, 0
  s_cselect_b32 s62, s62, 99
  v_cvt_pk_bf16_f32 v137, v186, v187
  v_cvt_pk_bf16_f32 v149, v206, v207
  s_cmp_lt_u32 s3, 4
  s_cbranch_scc1 K1_PQ
  ds_write_b64 v18, v[128:129] offset:0
  ds_write_b64 v18, v[130:131] offset:8
  ds_write_b64 v18, v[132:133] offset:16
  ds_write_b64 v18, v[134:135] offset:24
  ds_write_b64 v18, v[136:137] offset:32
  ds_write_b64 v18, v[140:141] offset:2688
  ds_write_b64 v18, v[142:143] offset:2696
  ds_write_b64 v18, v[144:145] offset:2704
  ds_write_b64 v18, v[146:147] offset:2712
  ds_write_b64 v18, v[148:149] offset:2720
  v_xor_b32 v16, s85, v124
  v_xor_b32 v17, 32, v16
  v_xor_b32 v18, 64, v16
  v_xor_b32 v19, 96, v16
  v_xor_b32 v20, 128, v16
  v_xor_b32 v21, 160, v16
  v_xor_b32 v22, 192, v16
  v_xor_b32 v23, 224, v16
  s_waitcnt vmcnt(16) lgkmcnt(0)
  s_barrier
  s_branch K1_FIN
K1_PQ:
  buffer_store_dwordx4 v[128:131], v22, s[36:39], s49 offen offset:0 sc1
  buffer_store_dwordx4 v[132:135], v22, s[36:39], s50 offen offset:0 sc1
  buffer_store_dwordx2 v[136:137], v19, s[36:39], s51 offen offset:0 sc1
  buffer_store_dwordx4 v[140:143], v22, s[36:39], s49 offen offset:256 sc1
  buffer_store_dwordx4 v[144:147], v22, s[36:39], s50 offen offset:256 sc1
  buffer_store_dwordx2 v[148:149], v19, s[36:39], s51 offen offset:128 sc1
  s_waitcnt vmcnt(22) lgkmcnt(0)
  s_barrier
  ds_read_b64_tr_b16 v[152:153], v120 offset:0
  ds_read_b64_tr_b16 v[154:155], v120 offset:672
  ds_read_b64_tr_b16 v[156:157], v121 offset:16
  ds_read_b64_tr_b16 v[158:159], v121 offset:432
  ds_read_b64_tr_b16 v[160:161], v120 offset:2688
  ds_read_b64_tr_b16 v[162:163], v120 offset:3360
  ds_read_b64_tr_b16 v[164:165], v121 offset:1680
  ds_read_b64_tr_b16 v[166:167], v121 offset:2096
  ds_read_b64_tr_b16 v[168:169], v120 offset:5376
  ds_read_b64_tr_b16 v[170:171], v120 offset:6048
  ds_read_b64_tr_b16 v[172:173], v121 offset:3344
  ds_read_b64_tr_b16 v[174:175], v121 offset:3760
  ds_read_b64_tr_b16 v[176:177], v120 offset:8064
  ds_read_b64_tr_b16 v[178:179], v120 offset:8736
  ds_read_b64_tr_b16 v[180:181], v121 offset:5008
  ds_read_b64_tr_b16 v[182:183], v121 offset:5424
  s_waitcnt lgkmcnt(12)
  v_mfma_f32_32x32x16_bf16 v[104:119], v[152:155], v[156:159], 0
  ds_read_b64_tr_b16 v[184:185], v120 offset:10752
  ds_read_b64_tr_b16 v[186:187], v120 offset:11424
  ds_read_b64_tr_b16 v[188:189], v121 offset:6672
  ds_read_b64_tr_b16 v[190:191], v121 offset:7088
  v_xor_b32 v16, s85, v124
  s_waitcnt lgkmcnt(12)
  v_mfma_f32_32x32x16_bf16 v[104:119], v[160:163], v[164:167], v[104:119]
  ds_read_b64_tr_b16 v[192:193], v120 offset:13440
  ds_read_b64_tr_b16 v[194:195], v120 offset:14112
  ds_read_b64_tr_b16 v[196:197], v121 offset:8336
  ds_read_b64_tr_b16 v[198:199], v121 offset:8752
  v_xor_b32 v17, 32, v16
  s_waitcnt lgkmcnt(12)
  v_mfma_f32_32x32x16_bf16 v[104:119], v[168:171], v[172:175], v[104:119]
  ds_read_b64_tr_b16 v[200:201], v120 offset:16128
  ds_read_b64_tr_b16 v[202:203], v120 offset:16800
  ds_read_b64_tr_b16 v[204:205], v121 offset:10000
  ds_read_b64_tr_b16 v[206:207], v121 offset:10416
  v_xor_b32 v18, 64, v16
  s_waitcnt lgkmcnt(12)
  v_mfma_f32_32x32x16_bf16 v[104:119], v[176:179], v[180:183], v[104:119]
  ds_read_b64_tr_b16 v[208:209], v120 offset:18816
  ds_read_b64_tr_b16 v[210:211], v120 offset:19488
  ds_read_b64_tr_b16 v[212:213], v121 offset:11664
  ds_read_b64_tr_b16 v[214:215], v121 offset:12080
  v_xor_b32 v19, 96, v16
  s_waitcnt lgkmcnt(12)
  v_mfma_f32_32x32x16_bf16 v[104:119], v[184:187], v[188:191], v[104:119]
  v_xor_b32 v20, 128, v16
  s_waitcnt lgkmcnt(8)
  v_mfma_f32_32x32x16_bf16 v[104:119], v[192:195], v[196:199], v[104:119]
  v_xor_b32 v21, 160, v16
  s_waitcnt lgkmcnt(4)
  v_mfma_f32_32x32x16_bf16 v[104:119], v[200:203], v[204:207], v[104:119]
  v_xor_b32 v22, 192, v16
  s_waitcnt lgkmcnt(0)
  v_mfma_f32_32x32x16_bf16 v[104:119], v[208:211], v[212:215], v[104:119]
  v_xor_b32 v23, 224, v16
  s_nop 10
  buffer_store_dwordx4 v[104:107], v122, s[36:39], s11 offen offset:0 sc1
  buffer_store_dwordx4 v[108:111], v122, s[36:39], s11 offen offset:768 sc1
  buffer_store_dwordx4 v[112:115], v123, s[36:39], s11 offen offset:1536 sc1
K1_FIN:
  s_nop 1
  ds_read_b64_tr_b16 v[112:113], v16 offset:0
  ds_read_b64_tr_b16 v[114:115], v16 offset:1024
  ds_read_b64_tr_b16 v[116:117], v17 offset:0
  ds_read_b64_tr_b16 v[118:119], v17 offset:1024
  ds_read_b64_tr_b16 v[120:121], v18 offset:0
  ds_read_b64_tr_b16 v[122:123], v18 offset:1024
  ds_read_b64_tr_b16 v[124:125], v19 offset:0
  ds_read_b64_tr_b16 v[126:127], v19 offset:1024
  ds_read_b64_tr_b16 v[128:129], v20 offset:0
  ds_read_b64_tr_b16 v[130:131], v20 offset:1024
  ds_read_b64_tr_b16 v[132:133], v21 offset:0
  ds_read_b64_tr_b16 v[134:135], v21 offset:1024
  ds_read_b64_tr_b16 v[136:137], v22 offset:0
  ds_read_b64_tr_b16 v[138:139], v22 offset:1024
  ds_read_b64_tr_b16 v[140:141], v23 offset:0
  ds_read_b64_tr_b16 v[142:143], v23 offset:1024
  s_waitcnt vmcnt(12) lgkmcnt(14)
  v_mfma_f32_16x16x32_bf16 v[176:179], v[112:115], v[64:67], 0
  ds_read_b64_tr_b16 v[144:145], v16 offset:8192
  ds_read_b64_tr_b16 v[146:147], v16 offset:9216
  v_mov_b32 v10, 2
  s_waitcnt vmcnt(11)
  v_mfma_f32_16x16x32_bf16 v[184:187], v[112:115], v[68:71], 0
  ds_read_b64_tr_b16 v[148:149], v17 offset:8192
  s_lshl_b32 s50, s4, 3
  s_waitcnt lgkmcnt(15)
  v_mfma_f32_16x16x32_bf16 v[180:183], v[116:119], v[64:67], 0
  ds_read_b64_tr_b16 v[150:151], v17 offset:9216
  s_and_b32 s51, s50, 0xd0
  buffer_load_dwordx4 v[96:99], v2, s[36:39], s26 offen offset:0 sc1
  v_mfma_f32_16x16x32_bf16 v[188:191], v[116:119], v[68:71], 0
  ds_read_b64_tr_b16 v[152:153], v18 offset:8192
  ds_read_b64_tr_b16 v[154:155], v18 offset:9216
  s_and_b32 s50, s50, 0xf0
  s_waitcnt lgkmcnt(15)
  v_mfma_f32_16x16x32_bf16 v[192:195], v[120:123], v[64:67], 0
  ds_read_b64_tr_b16 v[156:157], v19 offset:8192
  v_and_b32 v25, 15, v1
  buffer_load_dwordx4 v[100:103], v2, s[36:39], s26 offen offset:1024 sc1
  v_mfma_f32_16x16x32_bf16 v[200:203], v[120:123], v[68:71], 0
  ds_read_b64_tr_b16 v[158:159], v19 offset:9216
  v_and_b32 v9, 8, v1
  s_waitcnt lgkmcnt(15)
  v_mfma_f32_16x16x32_bf16 v[196:199], v[124:127], v[64:67], 0
  ds_read_b64_tr_b16 v[160:161], v20 offset:8192
  ds_read_b64_tr_b16 v[162:163], v20 offset:9216
  v_mad_u32_u24 v9, 3, v9, v25
  v_mfma_f32_16x16x32_bf16 v[204:207], v[124:127], v[68:71], 0
  ds_read_b64_tr_b16 v[164:165], v21 offset:8192
  v_add_u32 v25, s50, v25
  buffer_load_dwordx4 v[104:107], v2, s[36:39], s26 offen offset:2048 sc1
  s_waitcnt lgkmcnt(15)
  v_mfma_f32_16x16x32_bf16 v[208:211], v[128:131], v[64:67], 0
  ds_read_b64_tr_b16 v[166:167], v21 offset:9216
  s_and_b32 s50, s4, 4
  v_mfma_f32_16x16x32_bf16 v[216:219], v[128:131], v[68:71], 0
  ds_read_b64_tr_b16 v[168:169], v22 offset:8192
  ds_read_b64_tr_b16 v[170:171], v22 offset:9216
  s_lshl1_add_u32 s51, s50, s51
  buffer_load_dwordx4 v[108:111], v2, s[36:39], s26 offen offset:3072 sc1
  s_add_u32 s26, s26, 4096
  v_mfma_f32_16x16x32_bf16 v[212:215], v[132:135], v[64:67], 0
  ds_read_b64_tr_b16 v[172:173], v23 offset:8192
  v_add_u32 v9, s51, v9
  v_mfma_f32_16x16x32_bf16 v[220:223], v[132:135], v[68:71], 0
  ds_read_b64_tr_b16 v[174:175], v23 offset:9216
  v_cmp_gt_u32 vcc, 16, v1
  s_waitcnt lgkmcnt(15)
  v_mfma_f32_16x16x32_bf16 v[224:227], v[136:139], v[64:67], 0
  v_cndmask_b32 v25, v25, v9, vcc
  buffer_store_dwordx4 v[248:251], v2, s[36:39], s48 offen offset:0 sc1
  v_mfma_f32_16x16x32_bf16 v[232:235], v[136:139], v[68:71], 0
  v_lshlrev_b32 v8, 8, v25
  v_mfma_f32_16x16x32_bf16 v[228:231], v[140:143], v[64:67], 0
  v_add_u32 v8, 93323264, v8
  v_mfma_f32_16x16x32_bf16 v[236:239], v[140:143], v[68:71], 0
  s_waitcnt vmcnt(19) lgkmcnt(0)
  s_barrier
  s_waitcnt vmcnt(15)
  v_mfma_f32_16x16x32_bf16 v[176:179], v[144:147], v[72:75], v[176:179]
  v_and_b32 v26, 255, v0
  ds_read_b64_tr_b16 v[112:113], v16 offset:16384
  ds_read_b64_tr_b16 v[114:115], v16 offset:17408
  s_waitcnt vmcnt(14)
  v_mfma_f32_16x16x32_bf16 v[184:187], v[144:147], v[76:79], v[184:187]
  v_lshlrev_b32 v24, 4, v0
  ds_read_b64_tr_b16 v[116:117], v17 offset:16384
  v_mfma_f32_16x16x32_bf16 v[180:183], v[148:151], v[72:75], v[180:183]
  ds_read_b64_tr_b16 v[118:119], v17 offset:17408
  buffer_load_dwordx4 v[32:35], v2, s[36:39], s26 offen offset:0 sc1
  v_mfma_f32_16x16x32_bf16 v[188:191], v[148:151], v[76:79], v[188:191]
  v_mov_b32 v27, 2146435072
  ds_read_b64_tr_b16 v[120:121], v18 offset:16384
  ds_read_b64_tr_b16 v[122:123], v18 offset:17408
  v_mfma_f32_16x16x32_bf16 v[192:195], v[152:155], v[72:75], v[192:195]
  ds_read_b64_tr_b16 v[124:125], v19 offset:16384
  buffer_load_dwordx4 v[36:39], v2, s[36:39], s26 offen offset:1024 sc1
  v_mfma_f32_16x16x32_bf16 v[200:203], v[152:155], v[76:79], v[200:203]
  v_cmp_gt_u32 vcc, 240, v26
  ds_read_b64_tr_b16 v[126:127], v19 offset:17408
  v_mfma_f32_16x16x32_bf16 v[196:199], v[156:159], v[72:75], v[196:199]
  ds_read_b64_tr_b16 v[128:129], v20 offset:16384
  ds_read_b64_tr_b16 v[130:131], v20 offset:17408
  v_mfma_f32_16x16x32_bf16 v[204:207], v[156:159], v[76:79], v[204:207]
  s_lshl_b32 s8, s4, 16
  ds_read_b64_tr_b16 v[132:133], v21 offset:16384
  buffer_load_dwordx4 v[40:43], v2, s[36:39], s26 offen offset:2048 sc1
  v_mfma_f32_16x16x32_bf16 v[208:211], v[160:163], v[72:75], v[208:211]
  ds_read_b64_tr_b16 v[134:135], v21 offset:17408
  v_mfma_f32_16x16x32_bf16 v[216:219], v[160:163], v[76:79], v[216:219]
  v_cndmask_b32 v24, v27, v24, vcc
  ds_read_b64_tr_b16 v[136:137], v22 offset:16384
  ds_read_b64_tr_b16 v[138:139], v22 offset:17408
  buffer_load_dwordx4 v[44:47], v2, s[36:39], s26 offen offset:3072 sc1
  s_add_u32 s26, s26, 4096
  v_mfma_f32_16x16x32_bf16 v[212:215], v[164:167], v[72:75], v[212:215]
  ds_read_b64_tr_b16 v[140:141], v23 offset:16384
  v_mfma_f32_16x16x32_bf16 v[220:223], v[164:167], v[76:79], v[220:223]
  s_add_u32 s8, s8, 85983232
  ds_read_b64_tr_b16 v[142:143], v23 offset:17408
  v_mfma_f32_16x16x32_bf16 v[224:227], v[168:171], v[72:75], v[224:227]
  buffer_store_dwordx4 v[252:255], v2, s[36:39], s48 offen offset:1024 sc1
  s_add_u32 s48, s48, s34
  s_xor_b32 s34, s34, s35
  v_mfma_f32_16x16x32_bf16 v[232:235], v[168:171], v[76:79], v[232:235]
  s_cmp_eq_u32 s3, 0
  s_cbranch_scc0 K2_PQ
  buffer_load_ubyte v11, v25, s[28:31], 0 offen sc1
K2_PQ:
  v_mfma_f32_16x16x32_bf16 v[228:231], v[172:175], v[72:75], v[228:231]
  v_mfma_f32_16x16x32_bf16 v[236:239], v[172:175], v[76:79], v[236:239]
  s_waitcnt vmcnt(18) lgkmcnt(14)
  v_mfma_f32_16x16x32_bf16 v[176:179], v[112:115], v[80:83], v[176:179]
  ds_read_b64_tr_b16 v[144:145], v16 offset:24576
  ds_read_b64_tr_b16 v[146:147], v16 offset:25600
  v_mul_u32_u24 v27, 2731, v26
  s_waitcnt vmcnt(17)
  v_mfma_f32_16x16x32_bf16 v[184:187], v[112:115], v[84:87], v[184:187]
  ds_read_b64_tr_b16 v[148:149], v17 offset:24576
  v_lshrrev_b32 v27, 16, v27
  s_waitcnt lgkmcnt(15)
  v_mfma_f32_16x16x32_bf16 v[180:183], v[116:119], v[80:83], v[180:183]
  ds_read_b64_tr_b16 v[150:151], v17 offset:25600
  v_mul_u32_u24 v26, 48, v26
  s_add_u32 m0, s66, 65536
  s_nop 0
  buffer_load_dwordx4 v6, s[20:23], s24 offen lds
  s_add_u32 s24, s24, 524288
  v_mfma_f32_16x16x32_bf16 v[188:191], v[116:119], v[84:87], v[188:191]
  ds_read_b64_tr_b16 v[152:153], v18 offset:24576
  ds_read_b64_tr_b16 v[154:155], v18 offset:25600
  s_waitcnt lgkmcnt(15)
  v_mfma_f32_16x16x32_bf16 v[192:195], v[120:123], v[80:83], v[192:195]
  ds_read_b64_tr_b16 v[156:157], v19 offset:24576
  v_mul_u32_u24 v28, 1144, v27
  v_mfma_f32_16x16x32_bf16 v[200:203], v[120:123], v[84:87], v[200:203]
  ds_read_b64_tr_b16 v[158:159], v19 offset:25600
  v_sub_u32 v26, v26, v28
  buffer_load_dwordx4 v6, s[20:23], s25 offen offset:1024 lds
  s_add_u32 s25, s25, 524288
  s_waitcnt lgkmcnt(15)
  v_mfma_f32_16x16x32_bf16 v[196:199], v[124:127], v[80:83], v[196:199]
  ds_read_b64_tr_b16 v[160:161], v20 offset:24576
  ds_read_b64_tr_b16 v[162:163], v20 offset:25600
  s_lshl_b32 s9, s6, 12
  v_mfma_f32_16x16x32_bf16 v[204:207], v[124:127], v[84:87], v[204:207]
  ds_read_b64_tr_b16 v[164:165], v21 offset:24576
  s_waitcnt lgkmcnt(15)
  v_mfma_f32_16x16x32_bf16 v[208:211], v[128:131], v[80:83], v[208:211]
  ds_read_b64_tr_b16 v[166:167], v21 offset:25600
  s_add_u32 s9, s9, 114688
  buffer_store_dwordx4 v[240:243], v2, s[36:39], s48 offen offset:0 sc1
  v_mfma_f32_16x16x32_bf16 v[216:219], v[128:131], v[84:87], v[216:219]
  ds_read_b64_tr_b16 v[168:169], v22 offset:24576
  ds_read_b64_tr_b16 v[170:171], v22 offset:25600
  v_cmp_lt_u32 vcc, 4, v27
  v_mfma_f32_16x16x32_bf16 v[212:215], v[132:135], v[80:83], v[212:215]
  ds_read_b64_tr_b16 v[172:173], v23 offset:24576
  v_add_u32 v26, s9, v26
  v_mfma_f32_16x16x32_bf16 v[220:223], v[132:135], v[84:87], v[220:223]
  ds_read_b64_tr_b16 v[174:175], v23 offset:25600
  buffer_store_dwordx4 v[244:247], v2, s[36:39], s48 offen offset:1024 sc1
  s_add_u32 s48, s48, s34
  s_xor_b32 s34, s34, s35
  s_waitcnt lgkmcnt(15)
  v_mfma_f32_16x16x32_bf16 v[224:227], v[136:139], v[80:83], v[224:227]
  v_add_u32 v27, 1112, v26
  v_mfma_f32_16x16x32_bf16 v[232:235], v[136:139], v[84:87], v[232:235]
  v_cndmask_b32 v26, v26, v27, vcc
  v_mfma_f32_16x16x32_bf16 v[228:231], v[140:143], v[80:83], v[228:231]
  v_mfma_f32_16x16x32_bf16 v[236:239], v[140:143], v[84:87], v[236:239]
  s_waitcnt vmcnt(17) lgkmcnt(0)
  s_barrier
  v_mfma_f32_16x16x32_bf16 v[176:179], v[144:147], v[88:91], v[176:179]
  v_and_b32 v27, 31, v1
  ds_read_b64_tr_b16 v[112:113], v16 offset:32768
  ds_read_b64_tr_b16 v[114:115], v16 offset:33792
  v_mfma_f32_16x16x32_bf16 v[184:187], v[144:147], v[92:95], v[184:187]
  v_min_u32 v27, 20, v27
  ds_read_b64_tr_b16 v[116:117], v17 offset:32768
  v_mfma_f32_16x16x32_bf16 v[180:183], v[148:151], v[88:91], v[180:183]
  v_lshrrev_b32 v31, 5, v1
  ds_read_b64_tr_b16 v[118:119], v17 offset:33792
  v_mov_b32 v240, v48
  v_mov_b32 v241, v49
  v_mov_b32 v242, v50
  v_mov_b32 v243, v51
  v_mov_b32 v244, v52
  v_mov_b32 v245, v53
  v_mov_b32 v246, v54
  v_mov_b32 v247, v55
  v_mov_b32 v248, v56
  v_mov_b32 v249, v57
  v_mov_b32 v250, v58
  v_mov_b32 v251, v59
  v_mfma_f32_16x16x32_bf16 v[188:191], v[148:151], v[92:95], v[188:191]
  v_mad_u32_u24 v27, 24, v31, v27
  ds_read_b64_tr_b16 v[120:121], v18 offset:32768
  ds_read_b64_tr_b16 v[122:123], v18 offset:33792
  v_mfma_f32_16x16x32_bf16 v[192:195], v[152:155], v[88:91], v[192:195]
  v_mul_u32_u24 v27, 48, v27
  ds_read_b64_tr_b16 v[124:125], v19 offset:32768
  buffer_load_dwordx4 v[48:51], v2, s[36:39], s26 offen offset:0 sc1
  v_mfma_f32_16x16x32_bf16 v[200:203], v[152:155], v[92:95], v[200:203]
  v_add_u32 v27, 114688, v27
  ds_read_b64_tr_b16 v[126:127], v19 offset:33792
  v_mfma_f32_16x16x32_bf16 v[196:199], v[156:159], v[88:91], v[196:199]
  s_lshl3_add_u32 s12, s5, s3
  ds_read_b64_tr_b16 v[128:129], v20 offset:32768
  ds_read_b64_tr_b16 v[130:131], v20 offset:33792
  v_mfma_f32_16x16x32_bf16 v[204:207], v[156:159], v[92:95], v[204:207]
  s_mul_i32 s9, s4, 163840
  ds_read_b64_tr_b16 v[132:133], v21 offset:32768
  buffer_load_dwordx4 v[52:55], v2, s[36:39], s26 offen offset:1024 sc1
  v_mfma_f32_16x16x32_bf16 v[208:211], v[160:163], v[88:91], v[208:211]
  s_add_u32 s9, s9, 79691776
  ds_read_b64_tr_b16 v[134:135], v21 offset:33792
  v_mfma_f32_16x16x32_bf16 v[216:219], v[160:163], v[92:95], v[216:219]
  s_lshl_b32 s10, s12, 8
  ds_read_b64_tr_b16 v[136:137], v22 offset:32768
  ds_read_b64_tr_b16 v[138:139], v22 offset:33792
  buffer_load_dwordx4 v[56:59], v2, s[36:39], s26 offen offset:2048 sc1
  v_mfma_f32_16x16x32_bf16 v[212:215], v[164:167], v[88:91], v[212:215]
  s_add_u32 s11, s9, s10
  ds_read_b64_tr_b16 v[140:141], v23 offset:32768
  v_mfma_f32_16x16x32_bf16 v[220:223], v[164:167], v[92:95], v[220:223]
  s_add_u32 s9, s11, s10
  ds_read_b64_tr_b16 v[142:143], v23 offset:33792
  v_mfma_f32_16x16x32_bf16 v[224:227], v[168:171], v[88:91], v[224:227]
  s_add_u32 s10, s9, 65536
  buffer_load_dwordx4 v[60:63], v2, s[36:39], s26 offen offset:3072 sc1
  s_add_u32 s26, s26, 4096
  v_mfma_f32_16x16x32_bf16 v[232:235], v[168:171], v[92:95], v[232:235]
  s_add_u32 s11, s11, 131072
  v_mfma_f32_16x16x32_bf16 v[228:231], v[172:175], v[88:91], v[228:231]
  v_mfma_f32_16x16x32_bf16 v[236:239], v[172:175], v[92:95], v[236:239]
  s_waitcnt vmcnt(17) lgkmcnt(14)
  v_mfma_f32_16x16x32_bf16 v[176:179], v[112:115], v[96:99], v[176:179]
  ds_read_b64_tr_b16 v[144:145], v16 offset:40960
  ds_read_b64_tr_b16 v[146:147], v16 offset:41984
  v_lshrrev_b32 v12, 4, v1
  s_waitcnt vmcnt(16)
  v_mfma_f32_16x16x32_bf16 v[184:187], v[112:115], v[100:103], v[184:187]
  ds_read_b64_tr_b16 v[148:149], v17 offset:40960
  v_lshlrev_b32 v12, 2, v12
  s_waitcnt lgkmcnt(15)
  v_mfma_f32_16x16x32_bf16 v[180:183], v[116:119], v[96:99], v[180:183]
  ds_read_b64_tr_b16 v[150:151], v17 offset:41984
  v_and_b32 v13, 15, v1
  s_add_u32 m0, s66, 81920
  s_nop 0
  buffer_load_dwordx4 v6, s[20:23], s24 offen lds
  s_add_u32 s24, s24, 524288
  v_mfma_f32_16x16x32_bf16 v[188:191], v[116:119], v[100:103], v[188:191]
  ds_read_b64_tr_b16 v[152:153], v18 offset:40960
  ds_read_b64_tr_b16 v[154:155], v18 offset:41984
  s_waitcnt lgkmcnt(15)
  v_mfma_f32_16x16x32_bf16 v[192:195], v[120:123], v[96:99], v[192:195]
  ds_read_b64_tr_b16 v[156:157], v19 offset:40960
  v_sub_u32 v12, v13, v12
  v_mfma_f32_16x16x32_bf16 v[200:203], v[120:123], v[100:103], v[200:203]
  ds_read_b64_tr_b16 v[158:159], v19 offset:41984
  v_cmp_gt_i32 s[72:73], 0, v12
  s_waitcnt lgkmcnt(15)
  v_mfma_f32_16x16x32_bf16 v[196:199], v[124:127], v[96:99], v[196:199]
  ds_read_b64_tr_b16 v[160:161], v20 offset:40960
  ds_read_b64_tr_b16 v[162:163], v20 offset:41984
  v_cmp_gt_i32 s[74:75], 1, v12
  buffer_load_dwordx4 v6, s[20:23], s25 offen offset:1024 lds
  s_add_u32 s25, s25, 524288
  v_mfma_f32_16x16x32_bf16 v[204:207], v[124:127], v[100:103], v[204:207]
  ds_read_b64_tr_b16 v[164:165], v21 offset:40960
  s_waitcnt lgkmcnt(15)
  v_mfma_f32_16x16x32_bf16 v[208:211], v[128:131], v[96:99], v[208:211]
  ds_read_b64_tr_b16 v[166:167], v21 offset:41984
  v_cmp_gt_i32 s[76:77], 2, v12
  v_mfma_f32_16x16x32_bf16 v[216:219], v[128:131], v[100:103], v[216:219]
  ds_read_b64_tr_b16 v[168:169], v22 offset:40960
  ds_read_b64_tr_b16 v[170:171], v22 offset:41984
  v_cmp_gt_i32 s[78:79], 3, v12
  v_mfma_f32_16x16x32_bf16 v[212:215], v[132:135], v[96:99], v[212:215]
  ds_read_b64_tr_b16 v[172:173], v23 offset:40960
  v_mov_b32 v4, v2
  buffer_load_dwordx4 v[64:67], v2, s[36:39], s26 offen offset:0 sc1
  v_mfma_f32_16x16x32_bf16 v[220:223], v[132:135], v[100:103], v[220:223]
  ds_read_b64_tr_b16 v[174:175], v23 offset:41984
  s_waitcnt lgkmcnt(15)
  v_mfma_f32_16x16x32_bf16 v[224:227], v[136:139], v[96:99], v[224:227]
  v_add_u32 v5, 65536, v2
  v_mfma_f32_16x16x32_bf16 v[232:235], v[136:139], v[100:103], v[232:235]
  v_add_u32 v3, s66, v2
  v_mfma_f32_16x16x32_bf16 v[228:231], v[140:143], v[96:99], v[228:231]
  v_mfma_f32_16x16x32_bf16 v[236:239], v[140:143], v[100:103], v[236:239]
  s_waitcnt vmcnt(7) lgkmcnt(0)
  s_barrier
  v_mfma_f32_16x16x32_bf16 v[176:179], v[144:147], v[104:107], v[176:179]
  s_cmp_lg_u32 s17, 0
  s_cbranch_scc0 K2_PF
  s_mov_b64 exec, 1
  buffer_store_dword v10, off, s[36:39], s17 sc1
  s_mov_b64 exec, -1
K2_PF:
  ds_read_b64_tr_b16 v[112:113], v16 offset:49152
  ds_read_b64_tr_b16 v[114:115], v16 offset:50176
  v_mfma_f32_16x16x32_bf16 v[184:187], v[144:147], v[108:111], v[184:187]
  s_mul_i32 s82, s4, 5
  ds_read_b64_tr_b16 v[116:117], v17 offset:49152
  v_mfma_f32_16x16x32_bf16 v[180:183], v[148:151], v[104:107], v[180:183]
  v_and_b32 v14, 15, v1
  ds_read_b64_tr_b16 v[118:119], v17 offset:50176
  buffer_load_dwordx4 v[68:71], v2, s[36:39], s26 offen offset:1024 sc1
  v_mfma_f32_16x16x32_bf16 v[188:191], v[148:151], v[108:111], v[188:191]
  v_lshlrev_b32 v14, 4, v14
  ds_read_b64_tr_b16 v[120:121], v18 offset:49152
  ds_read_b64_tr_b16 v[122:123], v18 offset:50176
  v_mfma_f32_16x16x32_bf16 v[192:195], v[152:155], v[104:107], v[192:195]
  v_and_b32 v15, 16, v1
  ds_read_b64_tr_b16 v[124:125], v19 offset:49152
  v_mfma_f32_16x16x32_bf16 v[200:203], v[152:155], v[108:111], v[200:203]
  v_lshl_add_u32 v14, v15, 6, v14
  ds_read_b64_tr_b16 v[126:127], v19 offset:50176
  v_mfma_f32_16x16x32_bf16 v[196:199], v[156:159], v[104:107], v[196:199]
  v_add3_u32 v12, v31, s82, 0
  ds_read_b64_tr_b16 v[128:129], v20 offset:49152
  ds_read_b64_tr_b16 v[130:131], v20 offset:50176
  buffer_load_dwordx4 v[72:75], v2, s[36:39], s26 offen offset:2048 sc1
  v_mfma_f32_16x16x32_bf16 v[204:207], v[156:159], v[108:111], v[204:207]
  ds_read_b64_tr_b16 v[132:133], v21 offset:49152
  v_mfma_f32_16x16x32_bf16 v[208:211], v[160:163], v[104:107], v[208:211]
  v_lshrrev_b32 v15, 3, v12
  ds_read_b64_tr_b16 v[134:135], v21 offset:50176
  v_mfma_f32_16x16x32_bf16 v[216:219], v[160:163], v[108:111], v[216:219]
  v_lshl_add_u32 v28, v15, 12, v14
  ds_read_b64_tr_b16 v[136:137], v22 offset:49152
  ds_read_b64_tr_b16 v[138:139], v22 offset:50176
  v_mfma_f32_16x16x32_bf16 v[212:215], v[164:167], v[104:107], v[212:215]
  v_and_b32 v15, 3, v12
  ds_read_b64_tr_b16 v[140:141], v23 offset:49152
  buffer_load_dwordx4 v[76:79], v2, s[36:39], s26 offen offset:3072 sc1
  s_add_u32 s26, s26, 4096
  v_mfma_f32_16x16x32_bf16 v[220:223], v[164:167], v[108:111], v[220:223]
  v_lshl_add_u32 v28, v15, 8, v28
  ds_read_b64_tr_b16 v[142:143], v23 offset:50176
  v_mfma_f32_16x16x32_bf16 v[224:227], v[168:171], v[104:107], v[224:227]
  v_and_b32 v15, 4, v12
  v_mfma_f32_16x16x32_bf16 v[232:235], v[168:171], v[108:111], v[232:235]
  v_lshl_add_u32 v28, v15, 1, v28
  v_mfma_f32_16x16x32_bf16 v[228:231], v[172:175], v[104:107], v[228:231]
  v_mfma_f32_16x16x32_bf16 v[236:239], v[172:175], v[108:111], v[236:239]
  s_waitcnt lgkmcnt(14)
  v_mfma_f32_16x16x32_bf16 v[176:179], v[112:115], v[32:35], v[176:179]
  ds_read_b64_tr_b16 v[144:145], v16 offset:57344
  ds_read_b64_tr_b16 v[146:147], v16 offset:58368
  v_mfma_f32_16x16x32_bf16 v[184:187], v[112:115], v[36:39], v[184:187]
  ds_read_b64_tr_b16 v[148:149], v17 offset:57344
  ds_read_b64_tr_b16 v[150:151], v17 offset:58368
  s_waitcnt lgkmcnt(15)
  v_mfma_f32_16x16x32_bf16 v[180:183], v[116:119], v[32:35], v[180:183]
  ds_read_b64_tr_b16 v[152:153], v18 offset:57344
  s_add_u32 m0, s66, 98304
  s_nop 0
  buffer_load_dwordx4 v6, s[20:23], s24 offen lds
  s_add_u32 s24, s24, 524288
  v_mfma_f32_16x16x32_bf16 v[188:191], v[116:119], v[36:39], v[188:191]
  ds_read_b64_tr_b16 v[154:155], v18 offset:58368
  ds_read_b64_tr_b16 v[156:157], v19 offset:57344
  s_waitcnt lgkmcnt(15)
  v_mfma_f32_16x16x32_bf16 v[192:195], v[120:123], v[32:35], v[192:195]
  ds_read_b64_tr_b16 v[158:159], v19 offset:58368
  v_mfma_f32_16x16x32_bf16 v[200:203], v[120:123], v[36:39], v[200:203]
  ds_read_b64_tr_b16 v[160:161], v20 offset:57344
  ds_read_b64_tr_b16 v[162:163], v20 offset:58368
  buffer_load_dwordx4 v6, s[20:23], s25 offen offset:1024 lds
  s_add_u32 s25, s25, 524288
  v_mfma_f32_16x16x32_bf16 v[196:199], v[124:127], v[32:35], v[196:199]
  ds_read_b64_tr_b16 v[164:165], v21 offset:57344
  ds_read_b64_tr_b16 v[166:167], v21 offset:58368
  v_mfma_f32_16x16x32_bf16 v[204:207], v[124:127], v[36:39], v[204:207]
  ds_read_b64_tr_b16 v[168:169], v22 offset:57344
  s_waitcnt lgkmcnt(15)
  v_mfma_f32_16x16x32_bf16 v[208:211], v[128:131], v[32:35], v[208:211]
  ds_read_b64_tr_b16 v[170:171], v22 offset:58368
  ds_read_b64_tr_b16 v[172:173], v23 offset:57344
  buffer_load_dwordx4 v[80:83], v2, s[36:39], s26 offen offset:0 sc1
  v_mfma_f32_16x16x32_bf16 v[216:219], v[128:131], v[36:39], v[216:219]
  ds_read_b64_tr_b16 v[174:175], v23 offset:58368
  v_mfma_f32_16x16x32_bf16 v[212:215], v[132:135], v[32:35], v[212:215]
  v_add_u32 v16, 0x10000, v16
  v_add_u32 v17, 0x10000, v17
  v_mfma_f32_16x16x32_bf16 v[220:223], v[132:135], v[36:39], v[220:223]
  v_add_u32 v18, 0x10000, v18
  v_add_u32 v19, 0x10000, v19
  buffer_load_dwordx4 v[84:87], v2, s[36:39], s26 offen offset:1024 sc1
  v_mfma_f32_16x16x32_bf16 v[224:227], v[136:139], v[32:35], v[224:227]
  v_add_u32 v20, 0x10000, v20
  v_mfma_f32_16x16x32_bf16 v[232:235], v[136:139], v[36:39], v[232:235]
  v_add_u32 v21, 0x10000, v21
  v_add_u32 v22, 0x10000, v22
  s_waitcnt lgkmcnt(15)
  v_mfma_f32_16x16x32_bf16 v[228:231], v[140:143], v[32:35], v[228:231]
  v_add_u32 v23, 0x10000, v23
  v_mfma_f32_16x16x32_bf16 v[236:239], v[140:143], v[36:39], v[236:239]
  s_waitcnt vmcnt(16) lgkmcnt(0)
  s_barrier
  v_mfma_f32_16x16x32_bf16 v[176:179], v[144:147], v[40:43], v[176:179]
  ds_read_b64_tr_b16 v[112:113], v16 offset:0
  ds_read_b64_tr_b16 v[114:115], v16 offset:1024
  v_mfma_f32_16x16x32_bf16 v[184:187], v[144:147], v[44:47], v[184:187]
  ds_read_b64_tr_b16 v[116:117], v17 offset:0
  v_mfma_f32_16x16x32_bf16 v[180:183], v[148:151], v[40:43], v[180:183]
  ds_read_b64_tr_b16 v[118:119], v17 offset:1024
  buffer_load_dwordx4 v[88:91], v2, s[36:39], s26 offen offset:2048 sc1
  v_mfma_f32_16x16x32_bf16 v[188:191], v[148:151], v[44:47], v[188:191]
  ds_read_b64_tr_b16 v[120:121], v18 offset:0
  ds_read_b64_tr_b16 v[122:123], v18 offset:1024
  v_mfma_f32_16x16x32_bf16 v[192:195], v[152:155], v[40:43], v[192:195]
  ds_read_b64_tr_b16 v[124:125], v19 offset:0
  v_mfma_f32_16x16x32_bf16 v[200:203], v[152:155], v[44:47], v[200:203]
  ds_read_b64_tr_b16 v[126:127], v19 offset:1024
  v_mfma_f32_16x16x32_bf16 v[196:199], v[156:159], v[40:43], v[196:199]
  ds_read_b64_tr_b16 v[128:129], v20 offset:0
  ds_read_b64_tr_b16 v[130:131], v20 offset:1024
  buffer_load_dwordx4 v[92:95], v2, s[36:39], s26 offen offset:3072 sc1
  s_add_u32 s26, s26, 4096
  v_mfma_f32_16x16x32_bf16 v[204:207], v[156:159], v[44:47], v[204:207]
  ds_read_b64_tr_b16 v[132:133], v21 offset:0
  v_mfma_f32_16x16x32_bf16 v[208:211], v[160:163], v[40:43], v[208:211]
  ds_read_b64_tr_b16 v[134:135], v21 offset:1024
  v_mfma_f32_16x16x32_bf16 v[216:219], v[160:163], v[44:47], v[216:219]
  ds_read_b64_tr_b16 v[136:137], v22 offset:0
  ds_read_b64_tr_b16 v[138:139], v22 offset:1024
  v_mfma_f32_16x16x32_bf16 v[212:215], v[164:167], v[40:43], v[212:215]
  ds_read_b64_tr_b16 v[140:141], v23 offset:0
  buffer_store_dwordx4 v[240:243], v2, s[36:39], s96 offen sc1
  v_mfma_f32_16x16x32_bf16 v[220:223], v[164:167], v[44:47], v[220:223]
  ds_read_b64_tr_b16 v[142:143], v23 offset:1024
  v_mfma_f32_16x16x32_bf16 v[224:227], v[168:171], v[40:43], v[224:227]
  v_mfma_f32_16x16x32_bf16 v[232:235], v[168:171], v[44:47], v[232:235]
  v_mfma_f32_16x16x32_bf16 v[228:231], v[172:175], v[40:43], v[228:231]
  v_mfma_f32_16x16x32_bf16 v[236:239], v[172:175], v[44:47], v[236:239]
  s_waitcnt vmcnt(16) lgkmcnt(14)
  v_mfma_f32_16x16x32_bf16 v[176:179], v[112:115], v[48:51], v[176:179]
  ds_read_b64_tr_b16 v[144:145], v16 offset:8192
  ds_read_b64_tr_b16 v[146:147], v16 offset:9216
  v_add3_u32 v12, v31, s82, 2
  s_waitcnt vmcnt(15)
  v_mfma_f32_16x16x32_bf16 v[184:187], v[112:115], v[52:55], v[184:187]
  ds_read_b64_tr_b16 v[148:149], v17 offset:8192
  s_waitcnt lgkmcnt(15)
  v_mfma_f32_16x16x32_bf16 v[180:183], v[116:119], v[48:51], v[180:183]
  ds_read_b64_tr_b16 v[150:151], v17 offset:9216
  v_lshrrev_b32 v15, 3, v12
  s_add_u32 m0, s66, 114688
  s_nop 0
  buffer_load_dwordx4 v6, s[20:23], s24 offen lds
  s_add_u32 s24, s24, 524288
  v_mfma_f32_16x16x32_bf16 v[188:191], v[116:119], v[52:55], v[188:191]
  ds_read_b64_tr_b16 v[152:153], v18 offset:8192
  ds_read_b64_tr_b16 v[154:155], v18 offset:9216
  s_waitcnt lgkmcnt(15)
  v_mfma_f32_16x16x32_bf16 v[192:195], v[120:123], v[48:51], v[192:195]
  ds_read_b64_tr_b16 v[156:157], v19 offset:8192
  v_lshl_add_u32 v29, v15, 12, v14
  v_mfma_f32_16x16x32_bf16 v[200:203], v[120:123], v[52:55], v[200:203]
  ds_read_b64_tr_b16 v[158:159], v19 offset:9216
  buffer_load_dwordx4 v6, s[20:23], s25 offen offset:1024 lds
  s_add_u32 s25, s25, 524288
  s_waitcnt lgkmcnt(15)
  v_mfma_f32_16x16x32_bf16 v[196:199], v[124:127], v[48:51], v[196:199]
  ds_read_b64_tr_b16 v[160:161], v20 offset:8192
  ds_read_b64_tr_b16 v[162:163], v20 offset:9216
  v_and_b32 v15, 3, v12
  v_mfma_f32_16x16x32_bf16 v[204:207], v[124:127], v[52:55], v[204:207]
  ds_read_b64_tr_b16 v[164:165], v21 offset:8192
  s_waitcnt lgkmcnt(15)
  v_mfma_f32_16x16x32_bf16 v[208:211], v[128:131], v[48:51], v[208:211]
  ds_read_b64_tr_b16 v[166:167], v21 offset:9216
  v_lshl_add_u32 v29, v15, 8, v29
  buffer_load_dwordx4 v[96:99], v2, s[36:39], s26 offen offset:0 sc1
  v_mfma_f32_16x16x32_bf16 v[216:219], v[128:131], v[52:55], v[216:219]
  ds_read_b64_tr_b16 v[168:169], v22 offset:8192
  ds_read_b64_tr_b16 v[170:171], v22 offset:9216
  v_mfma_f32_16x16x32_bf16 v[212:215], v[132:135], v[48:51], v[212:215]
  ds_read_b64_tr_b16 v[172:173], v23 offset:8192
  v_and_b32 v15, 4, v12
  v_mfma_f32_16x16x32_bf16 v[220:223], v[132:135], v[52:55], v[220:223]
  ds_read_b64_tr_b16 v[174:175], v23 offset:9216
  buffer_load_dwordx4 v[100:103], v2, s[36:39], s26 offen offset:1024 sc1
  s_waitcnt lgkmcnt(15)
  v_mfma_f32_16x16x32_bf16 v[224:227], v[136:139], v[48:51], v[224:227]
  v_lshl_add_u32 v29, v15, 1, v29
  v_mfma_f32_16x16x32_bf16 v[232:235], v[136:139], v[52:55], v[232:235]
  v_mfma_f32_16x16x32_bf16 v[228:231], v[140:143], v[48:51], v[228:231]
  v_mfma_f32_16x16x32_bf16 v[236:239], v[140:143], v[52:55], v[236:239]
  s_waitcnt vmcnt(15) lgkmcnt(0)
  s_barrier
  v_mfma_f32_16x16x32_bf16 v[176:179], v[144:147], v[56:59], v[176:179]
  v_add3_u32 v12, v31, s82, 4
  v_lshrrev_b32 v15, 3, v12
  ds_read_b64_tr_b16 v[112:113], v16 offset:16384
  ds_read_b64_tr_b16 v[114:115], v16 offset:17408
  v_mfma_f32_16x16x32_bf16 v[184:187], v[144:147], v[60:63], v[184:187]
  v_lshl_add_u32 v30, v15, 12, v14
  ds_read_b64_tr_b16 v[116:117], v17 offset:16384
  v_mfma_f32_16x16x32_bf16 v[180:183], v[148:151], v[56:59], v[180:183]
  v_and_b32 v15, 3, v12
  ds_read_b64_tr_b16 v[118:119], v17 offset:17408
  buffer_load_dwordx4 v[104:107], v2, s[36:39], s26 offen offset:2048 sc1
  v_mfma_f32_16x16x32_bf16 v[188:191], v[148:151], v[60:63], v[188:191]
  v_lshl_add_u32 v30, v15, 8, v30
  ds_read_b64_tr_b16 v[120:121], v18 offset:16384
  ds_read_b64_tr_b16 v[122:123], v18 offset:17408
  v_mfma_f32_16x16x32_bf16 v[192:195], v[152:155], v[56:59], v[192:195]
  v_and_b32 v15, 4, v12
  ds_read_b64_tr_b16 v[124:125], v19 offset:16384
  v_mfma_f32_16x16x32_bf16 v[200:203], v[152:155], v[60:63], v[200:203]
  v_lshl_add_u32 v30, v15, 1, v30
  ds_read_b64_tr_b16 v[126:127], v19 offset:17408
  v_mfma_f32_16x16x32_bf16 v[196:199], v[156:159], v[56:59], v[196:199]
  v_cmp_gt_u32 vcc, 32, v1
  ds_read_b64_tr_b16 v[128:129], v20 offset:16384
  ds_read_b64_tr_b16 v[130:131], v20 offset:17408
  buffer_load_dwordx4 v[108:111], v2, s[36:39], s26 offen offset:3072 sc1
  s_add_u32 s26, s26, 4096
  v_mfma_f32_16x16x32_bf16 v[204:207], v[156:159], v[60:63], v[204:207]
  v_mov_b32 v12, 2146435072
  ds_read_b64_tr_b16 v[132:133], v21 offset:16384
  v_mfma_f32_16x16x32_bf16 v[208:211], v[160:163], v[56:59], v[208:211]
  s_and_b32 s82, s12, 1
  ds_read_b64_tr_b16 v[134:135], v21 offset:17408
  v_mfma_f32_16x16x32_bf16 v[216:219], v[160:163], v[60:63], v[216:219]
  v_cndmask_b32 v30, v12, v30, vcc
  ds_read_b64_tr_b16 v[136:137], v22 offset:16384
  ds_read_b64_tr_b16 v[138:139], v22 offset:17408
  v_mfma_f32_16x16x32_bf16 v[212:215], v[164:167], v[56:59], v[212:215]
  s_lshr_b32 s12, s12, 1
  ds_read_b64_tr_b16 v[140:141], v23 offset:16384
  buffer_store_dwordx4 v[244:247], v2, s[36:39], s97 offen sc1
  v_mfma_f32_16x16x32_bf16 v[220:223], v[164:167], v[60:63], v[220:223]
  s_mul_i32 s12, s12, 606208
  ds_read_b64_tr_b16 v[142:143], v23 offset:17408
  v_mfma_f32_16x16x32_bf16 v[224:227], v[168:171], v[56:59], v[224:227]
  s_lshl_b32 s82, s82, 11
  v_mfma_f32_16x16x32_bf16 v[232:235], v[168:171], v[60:63], v[232:235]
  s_add_u32 s12, s12, s82
  v_mfma_f32_16x16x32_bf16 v[228:231], v[172:175], v[56:59], v[228:231]
  s_add_u32 s12, s12, 50855936
  v_mfma_f32_16x16x32_bf16 v[236:239], v[172:175], v[60:63], v[236:239]
  s_waitcnt vmcnt(17) lgkmcnt(14)
  v_mfma_f32_16x16x32_bf16 v[176:179], v[112:115], v[64:67], v[176:179]
  ds_read_b64_tr_b16 v[144:145], v16 offset:24576
  ds_read_b64_tr_b16 v[146:147], v16 offset:25600
  s_waitcnt vmcnt(16)
  v_mfma_f32_16x16x32_bf16 v[184:187], v[112:115], v[68:71], v[184:187]
  ds_read_b64_tr_b16 v[148:149], v17 offset:24576
  s_waitcnt lgkmcnt(15)
  v_mfma_f32_16x16x32_bf16 v[180:183], v[116:119], v[64:67], v[180:183]
  ds_read_b64_tr_b16 v[150:151], v17 offset:25600
  s_add_u32 m0, s66, 131072
  s_nop 0
  buffer_load_dwordx4 v6, s[20:23], s24 offen lds
  s_add_u32 s24, s24, 524288
  v_mfma_f32_16x16x32_bf16 v[188:191], v[116:119], v[68:71], v[188:191]
  ds_read_b64_tr_b16 v[152:153], v18 offset:24576
  ds_read_b64_tr_b16 v[154:155], v18 offset:25600
  s_waitcnt lgkmcnt(15)
  v_mfma_f32_16x16x32_bf16 v[192:195], v[120:123], v[64:67], v[192:195]
  ds_read_b64_tr_b16 v[156:157], v19 offset:24576
  v_mfma_f32_16x16x32_bf16 v[200:203], v[120:123], v[68:71], v[200:203]
  ds_read_b64_tr_b16 v[158:159], v19 offset:25600
  buffer_load_dwordx4 v6, s[20:23], s25 offen offset:1024 lds
  s_add_u32 s25, s25, 524288
  s_waitcnt lgkmcnt(15)
  v_mfma_f32_16x16x32_bf16 v[196:199], v[124:127], v[64:67], v[196:199]
  ds_read_b64_tr_b16 v[160:161], v20 offset:24576
  ds_read_b64_tr_b16 v[162:163], v20 offset:25600
  v_mfma_f32_16x16x32_bf16 v[204:207], v[124:127], v[68:71], v[204:207]
  ds_read_b64_tr_b16 v[164:165], v21 offset:24576
  s_waitcnt lgkmcnt(15)
  v_mfma_f32_16x16x32_bf16 v[208:211], v[128:131], v[64:67], v[208:211]
  ds_read_b64_tr_b16 v[166:167], v21 offset:25600
  buffer_load_dwordx4 v[32:35], v2, s[36:39], s26 offen offset:0 sc1
  v_mfma_f32_16x16x32_bf16 v[216:219], v[128:131], v[68:71], v[216:219]
  ds_read_b64_tr_b16 v[168:169], v22 offset:24576
  ds_read_b64_tr_b16 v[170:171], v22 offset:25600
  v_mfma_f32_16x16x32_bf16 v[212:215], v[132:135], v[64:67], v[212:215]
  ds_read_b64_tr_b16 v[172:173], v23 offset:24576
  v_mfma_f32_16x16x32_bf16 v[220:223], v[132:135], v[68:71], v[220:223]
  ds_read_b64_tr_b16 v[174:175], v23 offset:25600
  buffer_load_dwordx4 v[36:39], v2, s[36:39], s26 offen offset:1024 sc1
  s_waitcnt lgkmcnt(15)
  v_mfma_f32_16x16x32_bf16 v[224:227], v[136:139], v[64:67], v[224:227]
  v_mfma_f32_16x16x32_bf16 v[232:235], v[136:139], v[68:71], v[232:235]
  v_mfma_f32_16x16x32_bf16 v[228:231], v[140:143], v[64:67], v[228:231]
  v_mfma_f32_16x16x32_bf16 v[236:239], v[140:143], v[68:71], v[236:239]
  s_waitcnt vmcnt(16) lgkmcnt(0)
  s_barrier
  v_mfma_f32_16x16x32_bf16 v[176:179], v[144:147], v[72:75], v[176:179]
  s_cmp_eq_u32 s3, 0
  s_cbranch_scc0 K2_PP
  v_cmp_ne_u32 s[18:19], 1, v11
  buffer_load_dword v9, v8, s[36:39], 0 offen sc1
K2_PP:
  ds_read_b64_tr_b16 v[112:113], v16 offset:32768
  ds_read_b64_tr_b16 v[114:115], v16 offset:33792
  v_mfma_f32_16x16x32_bf16 v[184:187], v[144:147], v[76:79], v[184:187]
  ds_read_b64_tr_b16 v[116:117], v17 offset:32768
  v_mfma_f32_16x16x32_bf16 v[180:183], v[148:151], v[72:75], v[180:183]
  ds_read_b64_tr_b16 v[118:119], v17 offset:33792
  buffer_load_dwordx4 v[40:43], v2, s[36:39], s26 offen offset:2048 sc1
  v_mfma_f32_16x16x32_bf16 v[188:191], v[148:151], v[76:79], v[188:191]
  ds_read_b64_tr_b16 v[120:121], v18 offset:32768
  ds_read_b64_tr_b16 v[122:123], v18 offset:33792
  v_mfma_f32_16x16x32_bf16 v[192:195], v[152:155], v[72:75], v[192:195]
  ds_read_b64_tr_b16 v[124:125], v19 offset:32768
  v_mfma_f32_16x16x32_bf16 v[200:203], v[152:155], v[76:79], v[200:203]
  ds_read_b64_tr_b16 v[126:127], v19 offset:33792
  v_mfma_f32_16x16x32_bf16 v[196:199], v[156:159], v[72:75], v[196:199]
  ds_read_b64_tr_b16 v[128:129], v20 offset:32768
  ds_read_b64_tr_b16 v[130:131], v20 offset:33792
  buffer_load_dwordx4 v[44:47], v2, s[36:39], s26 offen offset:3072 sc1
  s_add_u32 s26, s26, 4096
  v_mfma_f32_16x16x32_bf16 v[204:207], v[156:159], v[76:79], v[204:207]
  ds_read_b64_tr_b16 v[132:133], v21 offset:32768
  v_mfma_f32_16x16x32_bf16 v[208:211], v[160:163], v[72:75], v[208:211]
  ds_read_b64_tr_b16 v[134:135], v21 offset:33792
  v_mfma_f32_16x16x32_bf16 v[216:219], v[160:163], v[76:79], v[216:219]
  ds_read_b64_tr_b16 v[136:137], v22 offset:32768
  ds_read_b64_tr_b16 v[138:139], v22 offset:33792
  v_mfma_f32_16x16x32_bf16 v[212:215], v[164:167], v[72:75], v[212:215]
  ds_read_b64_tr_b16 v[140:141], v23 offset:32768
  buffer_store_dwordx4 v[248:251], v2, s[36:39], s98 offen sc1
  v_mfma_f32_16x16x32_bf16 v[220:223], v[164:167], v[76:79], v[220:223]
  ds_read_b64_tr_b16 v[142:143], v23 offset:33792
  v_mfma_f32_16x16x32_bf16 v[224:227], v[168:171], v[72:75], v[224:227]
  v_mfma_f32_16x16x32_bf16 v[232:235], v[168:171], v[76:79], v[232:235]
  v_mfma_f32_16x16x32_bf16 v[228:231], v[172:175], v[72:75], v[228:231]
  v_mfma_f32_16x16x32_bf16 v[236:239], v[172:175], v[76:79], v[236:239]
  s_waitcnt vmcnt(18) lgkmcnt(14)
  v_mfma_f32_16x16x32_bf16 v[176:179], v[112:115], v[80:83], v[176:179]
  ds_read_b64_tr_b16 v[144:145], v16 offset:40960
  ds_read_b64_tr_b16 v[146:147], v16 offset:41984
  s_waitcnt vmcnt(17)
  v_mfma_f32_16x16x32_bf16 v[184:187], v[112:115], v[84:87], v[184:187]
  ds_read_b64_tr_b16 v[148:149], v17 offset:40960
  s_waitcnt lgkmcnt(15)
  v_mfma_f32_16x16x32_bf16 v[180:183], v[116:119], v[80:83], v[180:183]
  ds_read_b64_tr_b16 v[150:151], v17 offset:41984
  s_add_u32 m0, s66, 147456
  s_nop 0
  buffer_load_dwordx4 v6, s[20:23], s24 offen lds
  s_add_u32 s24, s24, 524288
  v_mfma_f32_16x16x32_bf16 v[188:191], v[116:119], v[84:87], v[188:191]
  ds_read_b64_tr_b16 v[152:153], v18 offset:40960
  ds_read_b64_tr_b16 v[154:155], v18 offset:41984
  s_waitcnt lgkmcnt(15)
  v_mfma_f32_16x16x32_bf16 v[192:195], v[120:123], v[80:83], v[192:195]
  ds_read_b64_tr_b16 v[156:157], v19 offset:40960
  buffer_load_dwordx4 v6, s[20:23], s25 offen offset:1024 lds
  s_add_u32 s25, s25, 524288
  v_mfma_f32_16x16x32_bf16 v[200:203], v[120:123], v[84:87], v[200:203]
  ds_read_b64_tr_b16 v[158:159], v19 offset:41984
  s_waitcnt lgkmcnt(15)
  v_mfma_f32_16x16x32_bf16 v[196:199], v[124:127], v[80:83], v[196:199]
  ds_read_b64_tr_b16 v[160:161], v20 offset:40960
  ds_read_b64_tr_b16 v[162:163], v20 offset:41984
  buffer_load_dwordx4 v[48:51], v2, s[36:39], s26 offen offset:0 sc1
  v_mfma_f32_16x16x32_bf16 v[204:207], v[124:127], v[84:87], v[204:207]
  ds_read_b64_tr_b16 v[164:165], v21 offset:40960
  s_waitcnt lgkmcnt(15)
  v_mfma_f32_16x16x32_bf16 v[208:211], v[128:131], v[80:83], v[208:211]
  ds_read_b64_tr_b16 v[166:167], v21 offset:41984
  buffer_load_dwordx4 v[52:55], v2, s[36:39], s26 offen offset:1024 sc1
  v_mfma_f32_16x16x32_bf16 v[216:219], v[128:131], v[84:87], v[216:219]
  ds_read_b64_tr_b16 v[168:169], v22 offset:40960
  ds_read_b64_tr_b16 v[170:171], v22 offset:41984
  v_mfma_f32_16x16x32_bf16 v[212:215], v[132:135], v[80:83], v[212:215]
  ds_read_b64_tr_b16 v[172:173], v23 offset:40960
  buffer_load_dwordx4 v[56:59], v2, s[36:39], s26 offen offset:2048 sc1
  v_mfma_f32_16x16x32_bf16 v[220:223], v[132:135], v[84:87], v[220:223]
  ds_read_b64_tr_b16 v[174:175], v23 offset:41984
  s_waitcnt lgkmcnt(15)
  v_mfma_f32_16x16x32_bf16 v[224:227], v[136:139], v[80:83], v[224:227]
  buffer_load_dwordx4 v[60:63], v2, s[36:39], s26 offen offset:3072 sc1
  s_add_u32 s26, s26, 4096
  v_mfma_f32_16x16x32_bf16 v[232:235], v[136:139], v[84:87], v[232:235]
  v_mfma_f32_16x16x32_bf16 v[228:231], v[140:143], v[80:83], v[228:231]
  v_mfma_f32_16x16x32_bf16 v[236:239], v[140:143], v[84:87], v[236:239]
  s_cmp_eq_u32 s3, 0
  s_cbranch_scc0 K2_PC
  s_and_b32 s50, s89, 255
  s_cmp_eq_u32 s50, s2
  s_cbranch_scc0 K2_PFOR
  s_lshl_b32 s17, s16, 8
  s_add_u32 s17, s17, 93323264
K2_PCK:
  s_mov_b32 s50, -1
  s_waitcnt vmcnt(9)
  v_cmp_gt_u32 vcc, 2, v9
  s_nop 0
  s_or_b64 vcc, vcc, s[18:19]
  s_cbranch_scc1 K2_PSLOW
K2_PW:
  s_waitcnt vmcnt(10)
  v_mov_b32 v9, s50
  ds_write_b32 v2, v9 offset:61440
K2_PC:
  s_waitcnt vmcnt(18) lgkmcnt(0)
  s_barrier
  v_mfma_f32_16x16x32_bf16 v[176:179], v[144:147], v[88:91], v[176:179]
  ds_read_b32 v10, v2 offset:61440
  ds_read_b64_tr_b16 v[112:113], v16 offset:49152
  ds_read_b64_tr_b16 v[114:115], v16 offset:50176
  v_mfma_f32_16x16x32_bf16 v[184:187], v[144:147], v[92:95], v[184:187]
  ds_read_b64_tr_b16 v[116:117], v17 offset:49152
  v_mfma_f32_16x16x32_bf16 v[180:183], v[148:151], v[88:91], v[180:183]
  ds_read_b64_tr_b16 v[118:119], v17 offset:50176
  v_mfma_f32_16x16x32_bf16 v[188:191], v[148:151], v[92:95], v[188:191]
  s_waitcnt lgkmcnt(4)
  v_readfirstlane_b32 s50, v10
  s_nop 0
  s_cmp_lg_u32 s50, -1
  s_cbranch_scc1 K2_BAIL
  ds_read_b64_tr_b16 v[120:121], v18 offset:49152
  ds_read_b64_tr_b16 v[122:123], v18 offset:50176
  v_mfma_f32_16x16x32_bf16 v[192:195], v[152:155], v[88:91], v[192:195]
  ds_read_b64_tr_b16 v[124:125], v19 offset:49152
  s_and_b32 s80, s54, 0xc000
  s_add_u32 m0, s80, s66
  s_add_u32 s81, s54, 16384
  buffer_load_dwordx4 v3, s[40:43], s54 offen sc1 lds
  buffer_load_dwordx4 v3, s[40:43], s54 offen offset:1024 sc1 lds
  s_mov_b32 s54, s81
  v_mfma_f32_16x16x32_bf16 v[200:203], v[152:155], v[92:95], v[200:203]
  ds_read_b64_tr_b16 v[126:127], v19 offset:50176
  buffer_load_dwordx4 v[240:243], v24, s[36:39], s8 offen sc1
  s_add_u32 s8, s8, 8192
  v_mfma_f32_16x16x32_bf16 v[196:199], v[156:159], v[88:91], v[196:199]
  ds_read_b64_tr_b16 v[128:129], v20 offset:49152
  ds_read_b64_tr_b16 v[130:131], v20 offset:50176
  buffer_load_dwordx4 v[244:247], v24, s[36:39], s8 offen sc1
  s_add_u32 s8, s8, 8192
  v_mfma_f32_16x16x32_bf16 v[204:207], v[156:159], v[92:95], v[204:207]
  ds_read_b64_tr_b16 v[132:133], v21 offset:49152
  buffer_load_dwordx4 v[248:251], v24, s[36:39], s8 offen sc1
  s_add_u32 s8, s8, 8192
  v_mfma_f32_16x16x32_bf16 v[208:211], v[160:163], v[88:91], v[208:211]
  ds_read_b64_tr_b16 v[134:135], v21 offset:50176
  buffer_load_dwordx4 v[252:255], v24, s[36:39], s8 offen sc1
  s_add_u32 s8, s8, 8192
  v_mfma_f32_16x16x32_bf16 v[216:219], v[160:163], v[92:95], v[216:219]
  ds_read_b64_tr_b16 v[136:137], v22 offset:49152
  ds_read_b64_tr_b16 v[138:139], v22 offset:50176
  v_mfma_f32_16x16x32_bf16 v[212:215], v[164:167], v[88:91], v[212:215]
  ds_read_b64_tr_b16 v[140:141], v23 offset:49152
  buffer_load_dwordx4 v[64:67], v24, s[36:39], s8 offen sc1
  s_add_u32 s8, s8, 8192
  v_mfma_f32_16x16x32_bf16 v[220:223], v[164:167], v[92:95], v[220:223]
  ds_read_b64_tr_b16 v[142:143], v23 offset:50176
  buffer_load_dwordx4 v[68:71], v24, s[36:39], s8 offen sc1
  s_add_u32 s8, s8, 8192
  v_mfma_f32_16x16x32_bf16 v[224:227], v[168:171], v[88:91], v[224:227]
  buffer_load_dwordx4 v[72:75], v24, s[36:39], s8 offen sc1
  s_add_u32 s8, s8, 8192
  v_mfma_f32_16x16x32_bf16 v[232:235], v[168:171], v[92:95], v[232:235]
  buffer_load_dwordx4 v[76:79], v24, s[36:39], s8 offen sc1
  s_add_u32 s8, s8, 8192
  v_mfma_f32_16x16x32_bf16 v[228:231], v[172:175], v[88:91], v[228:231]
  v_mfma_f32_16x16x32_bf16 v[236:239], v[172:175], v[92:95], v[236:239]
  s_waitcnt vmcnt(27) lgkmcnt(14)
  v_mfma_f32_16x16x32_bf16 v[176:179], v[112:115], v[96:99], v[176:179]
  ds_read_b64_tr_b16 v[144:145], v16 offset:57344
  ds_read_b64_tr_b16 v[146:147], v16 offset:58368
  v_and_b32 v93, 31, v1
  s_waitcnt vmcnt(26)
  v_mfma_f32_16x16x32_bf16 v[184:187], v[112:115], v[100:103], v[184:187]
  ds_read_b64_tr_b16 v[148:149], v17 offset:57344
  ds_read_b64_tr_b16 v[150:151], v17 offset:58368
  s_waitcnt lgkmcnt(15)
  v_mfma_f32_16x16x32_bf16 v[180:183], v[116:119], v[96:99], v[180:183]
  ds_read_b64_tr_b16 v[152:153], v18 offset:57344
  v_lshl_add_u32 v93, v31, 11, v93
  s_and_b32 s80, s55, 0xc000
  s_add_u32 m0, s80, s67
  s_add_u32 s81, s55, 16384
  buffer_load_dwordx4 v3, s[44:47], s55 offen sc1 lds
  buffer_load_dwordx4 v3, s[44:47], s55 offen offset:1024 sc1 lds
  s_mov_b32 s55, s81
  v_mfma_f32_16x16x32_bf16 v[188:191], v[116:119], v[100:103], v[188:191]
  ds_read_b64_tr_b16 v[154:155], v18 offset:58368
  ds_read_b64_tr_b16 v[156:157], v19 offset:57344
  s_waitcnt lgkmcnt(15)
  v_mfma_f32_16x16x32_bf16 v[192:195], v[120:123], v[96:99], v[192:195]
  ds_read_b64_tr_b16 v[158:159], v19 offset:58368
  v_mfma_f32_16x16x32_bf16 v[200:203], v[120:123], v[100:103], v[200:203]
  ds_read_b64_tr_b16 v[160:161], v20 offset:57344
  ds_read_b64_tr_b16 v[162:163], v20 offset:58368
  v_lshlrev_b32 v92, 4, v93
  v_mfma_f32_16x16x32_bf16 v[196:199], v[124:127], v[96:99], v[196:199]
  ds_read_b64_tr_b16 v[164:165], v21 offset:57344
  ds_read_b64_tr_b16 v[166:167], v21 offset:58368
  v_mfma_f32_16x16x32_bf16 v[204:207], v[124:127], v[100:103], v[204:207]
  ds_read_b64_tr_b16 v[168:169], v22 offset:57344
  v_lshlrev_b32 v93, 3, v93
  s_waitcnt lgkmcnt(15)
  v_mfma_f32_16x16x32_bf16 v[208:211], v[128:131], v[96:99], v[208:211]
  ds_read_b64_tr_b16 v[170:171], v22 offset:58368
  ds_read_b64_tr_b16 v[172:173], v23 offset:57344
  s_and_b32 s80, s54, 0xc000
  s_add_u32 m0, s80, s66
  s_add_u32 s81, s54, 16384
  buffer_load_dwordx4 v3, s[40:43], s54 offen sc1 lds
  buffer_load_dwordx4 v3, s[40:43], s54 offen offset:1024 sc1 lds
  s_mov_b32 s54, s81
  v_mfma_f32_16x16x32_bf16 v[216:219], v[128:131], v[100:103], v[216:219]
  ds_read_b64_tr_b16 v[174:175], v23 offset:58368
  v_mfma_f32_16x16x32_bf16 v[212:215], v[132:135], v[96:99], v[212:215]
  v_add_u32 v16, 0x10000, v16
  v_add_u32 v17, 0x10000, v17
  v_mov_b32 v90, 0
  v_mfma_f32_16x16x32_bf16 v[220:223], v[132:135], v[100:103], v[220:223]
  v_add_u32 v18, 0x10000, v18
  v_add_u32 v19, 0x10000, v19
  v_mfma_f32_16x16x32_bf16 v[224:227], v[136:139], v[96:99], v[224:227]
  v_add_u32 v20, 0x10000, v20
  v_mov_b32 v91, 0
  v_mfma_f32_16x16x32_bf16 v[232:235], v[136:139], v[100:103], v[232:235]
  v_add_u32 v21, 0x10000, v21
  v_add_u32 v22, 0x10000, v22
  s_waitcnt lgkmcnt(15)
  v_mfma_f32_16x16x32_bf16 v[228:231], v[140:143], v[96:99], v[228:231]
  v_add_u32 v23, 0x10000, v23
  v_mfma_f32_16x16x32_bf16 v[236:239], v[140:143], v[100:103], v[236:239]
  s_waitcnt vmcnt(25) lgkmcnt(0)
  s_barrier
  v_mfma_f32_16x16x32_bf16 v[176:179], v[144:147], v[104:107], v[176:179]
  ds_read_b64_tr_b16 v[112:113], v16 offset:0
  ds_read_b64_tr_b16 v[114:115], v16 offset:1024
  v_mfma_f32_16x16x32_bf16 v[184:187], v[144:147], v[108:111], v[184:187]
  ds_read_b64_tr_b16 v[116:117], v17 offset:0
  v_mfma_f32_16x16x32_bf16 v[180:183], v[148:151], v[104:107], v[180:183]
  ds_read_b64_tr_b16 v[118:119], v17 offset:1024
  buffer_load_dwordx4 v[80:83], v92, s[36:39], s9 offen sc1
  v_mfma_f32_16x16x32_bf16 v[188:191], v[148:151], v[108:111], v[188:191]
  ds_read_b64_tr_b16 v[120:121], v18 offset:0
  ds_read_b64_tr_b16 v[122:123], v18 offset:1024
  v_mfma_f32_16x16x32_bf16 v[192:195], v[152:155], v[104:107], v[192:195]
  ds_read_b64_tr_b16 v[124:125], v19 offset:0
  v_mfma_f32_16x16x32_bf16 v[200:203], v[152:155], v[108:111], v[200:203]
  ds_read_b64_tr_b16 v[126:127], v19 offset:1024
  v_mfma_f32_16x16x32_bf16 v[196:199], v[156:159], v[104:107], v[196:199]
  ds_read_b64_tr_b16 v[128:129], v20 offset:0
  ds_read_b64_tr_b16 v[130:131], v20 offset:1024
  buffer_load_dwordx4 v[84:87], v92, s[36:39], s10 offen sc1
  v_mfma_f32_16x16x32_bf16 v[204:207], v[156:159], v[108:111], v[204:207]
  ds_read_b64_tr_b16 v[132:133], v21 offset:0
  v_mfma_f32_16x16x32_bf16 v[208:211], v[160:163], v[104:107], v[208:211]
  ds_read_b64_tr_b16 v[134:135], v21 offset:1024
  v_mfma_f32_16x16x32_bf16 v[216:219], v[160:163], v[108:111], v[216:219]
  ds_read_b64_tr_b16 v[136:137], v22 offset:0
  ds_read_b64_tr_b16 v[138:139], v22 offset:1024
  v_mfma_f32_16x16x32_bf16 v[212:215], v[164:167], v[104:107], v[212:215]
  ds_read_b64_tr_b16 v[140:141], v23 offset:0
  buffer_load_dwordx2 v[88:89], v93, s[36:39], s11 offen sc1
  v_mfma_f32_16x16x32_bf16 v[220:223], v[164:167], v[108:111], v[220:223]
  ds_read_b64_tr_b16 v[142:143], v23 offset:1024
  v_mfma_f32_16x16x32_bf16 v[224:227], v[168:171], v[104:107], v[224:227]
  v_mfma_f32_16x16x32_bf16 v[232:235], v[168:171], v[108:111], v[232:235]
  v_mfma_f32_16x16x32_bf16 v[228:231], v[172:175], v[104:107], v[228:231]
  v_mfma_f32_16x16x32_bf16 v[236:239], v[172:175], v[108:111], v[236:239]
  s_waitcnt vmcnt(27) lgkmcnt(14)
  v_mfma_f32_16x16x32_bf16 v[176:179], v[112:115], v[32:35], v[176:179]
  ds_read_b64_tr_b16 v[144:145], v16 offset:8192
  ds_read_b64_tr_b16 v[146:147], v16 offset:9216
  s_waitcnt vmcnt(13)
  v_add_f32 v240, v240, v244
  v_add_f32 v241, v241, v245
  v_add_f32 v242, v242, v246
  v_mfma_f32_16x16x32_bf16 v[184:187], v[112:115], v[36:39], v[184:187]
  ds_read_b64_tr_b16 v[148:149], v17 offset:8192
  v_add_f32 v243, v243, v247
  s_waitcnt vmcnt(11)
  v_add_f32 v248, v248, v252
  s_waitcnt lgkmcnt(15)
  v_mfma_f32_16x16x32_bf16 v[180:183], v[116:119], v[32:35], v[180:183]
  ds_read_b64_tr_b16 v[150:151], v17 offset:9216
  v_add_f32 v249, v249, v253
  v_add_f32 v250, v250, v254
  s_cmp_lt_u32 s54, s56
  s_cbranch_scc0 K2_TK2H
K2_TK2G:
  s_and_b32 s80, s54, 0xc000
  s_add_u32 m0, s80, s66
  s_add_u32 s81, s54, 16384
  buffer_load_dwordx4 v3, s[40:43], s54 offen sc1 lds
  buffer_load_dwordx4 v3, s[40:43], s54 offen offset:1024 sc1 lds
  s_mov_b32 s54, s81
  v_mfma_f32_16x16x32_bf16 v[188:191], v[116:119], v[36:39], v[188:191]
  ds_read_b64_tr_b16 v[152:153], v18 offset:8192
  ds_read_b64_tr_b16 v[154:155], v18 offset:9216
  v_add_f32 v251, v251, v255
  s_waitcnt vmcnt(11)
  v_add_f32 v64, v64, v68
  s_waitcnt lgkmcnt(15)
  v_mfma_f32_16x16x32_bf16 v[192:195], v[120:123], v[32:35], v[192:195]
  ds_read_b64_tr_b16 v[156:157], v19 offset:8192
  v_add_f32 v65, v65, v69
  v_add_f32 v66, v66, v70
  v_mfma_f32_16x16x32_bf16 v[200:203], v[120:123], v[36:39], v[200:203]
  ds_read_b64_tr_b16 v[158:159], v19 offset:9216
  v_add_f32 v67, v67, v71
  s_waitcnt vmcnt(9)
  v_add_f32 v72, v72, v76
  s_waitcnt lgkmcnt(15)
  v_mfma_f32_16x16x32_bf16 v[196:199], v[124:127], v[32:35], v[196:199]
  ds_read_b64_tr_b16 v[160:161], v20 offset:8192
  ds_read_b64_tr_b16 v[162:163], v20 offset:9216
  v_add_f32 v73, v73, v77
  v_add_f32 v74, v74, v78
  v_mfma_f32_16x16x32_bf16 v[204:207], v[124:127], v[36:39], v[204:207]
  ds_read_b64_tr_b16 v[164:165], v21 offset:8192
  v_add_f32 v75, v75, v79
  v_add_f32 v240, v240, v248
  s_waitcnt lgkmcnt(15)
  v_mfma_f32_16x16x32_bf16 v[208:211], v[128:131], v[32:35], v[208:211]
  ds_read_b64_tr_b16 v[166:167], v21 offset:9216
  v_add_f32 v241, v241, v249
  v_add_f32 v242, v242, v250
  v_mfma_f32_16x16x32_bf16 v[216:219], v[128:131], v[36:39], v[216:219]
  ds_read_b64_tr_b16 v[168:169], v22 offset:8192
  ds_read_b64_tr_b16 v[170:171], v22 offset:9216
  v_add_f32 v243, v243, v251
  v_add_f32 v64, v64, v72
  v_mfma_f32_16x16x32_bf16 v[212:215], v[132:135], v[32:35], v[212:215]
  ds_read_b64_tr_b16 v[172:173], v23 offset:8192
  v_add_f32 v65, v65, v73
  v_add_f32 v66, v66, v74
  v_mfma_f32_16x16x32_bf16 v[220:223], v[132:135], v[36:39], v[220:223]
  ds_read_b64_tr_b16 v[174:175], v23 offset:9216
  v_add_f32 v67, v67, v75
  v_add_f32 v8, v240, v64
  s_waitcnt lgkmcnt(15)
  v_mfma_f32_16x16x32_bf16 v[224:227], v[136:139], v[32:35], v[224:227]
  v_add_f32 v9, v241, v65
  v_add_f32 v10, v242, v66
  v_mfma_f32_16x16x32_bf16 v[232:235], v[136:139], v[36:39], v[232:235]
  v_add_f32 v11, v243, v67
  v_cvt_pk_bf16_f32 v8, v8, v9
  v_mfma_f32_16x16x32_bf16 v[228:231], v[140:143], v[32:35], v[228:231]
  v_cvt_pk_bf16_f32 v9, v10, v11
  ds_write_b64 v26, v[8:9]
  v_mfma_f32_16x16x32_bf16 v[236:239], v[140:143], v[36:39], v[236:239]
  s_waitcnt vmcnt(23) lgkmcnt(0)
  s_barrier
  v_mfma_f32_16x16x32_bf16 v[176:179], v[144:147], v[40:43], v[176:179]
  ds_read_b128 v[240:243], v27 offset:0
  ds_read_b64_tr_b16 v[112:113], v16 offset:16384
  ds_read_b64_tr_b16 v[114:115], v16 offset:17408
  v_mfma_f32_16x16x32_bf16 v[184:187], v[144:147], v[44:47], v[184:187]
  ds_read_b64_tr_b16 v[116:117], v17 offset:16384
  v_mfma_f32_16x16x32_bf16 v[180:183], v[148:151], v[40:43], v[180:183]
  ds_read_b128 v[244:247], v27 offset:16
  ds_read_b64_tr_b16 v[118:119], v17 offset:17408
  s_and_b32 s80, s55, 0xc000
  s_add_u32 m0, s80, s67
  s_add_u32 s81, s55, 16384
  buffer_load_dwordx4 v3, s[44:47], s55 offen sc1 lds
  buffer_load_dwordx4 v3, s[44:47], s55 offen offset:1024 sc1 lds
  s_mov_b32 s55, s81
  v_mfma_f32_16x16x32_bf16 v[188:191], v[148:151], v[44:47], v[188:191]
  ds_read_b64_tr_b16 v[120:121], v18 offset:16384
  ds_read_b64_tr_b16 v[122:123], v18 offset:17408
  v_mfma_f32_16x16x32_bf16 v[192:195], v[152:155], v[40:43], v[192:195]
  ds_read_b64_tr_b16 v[124:125], v19 offset:16384
  v_mfma_f32_16x16x32_bf16 v[200:203], v[152:155], v[44:47], v[200:203]
  ds_read_b128 v[248:251], v27 offset:32
  ds_read_b64_tr_b16 v[126:127], v19 offset:17408
  v_mfma_f32_16x16x32_bf16 v[196:199], v[156:159], v[40:43], v[196:199]
  ds_read_b64_tr_b16 v[128:129], v20 offset:16384
  ds_read_b64_tr_b16 v[130:131], v20 offset:17408
  v_mfma_f32_16x16x32_bf16 v[204:207], v[156:159], v[44:47], v[204:207]
  ds_read_b128 v[252:255], v27 offset:4096
  ds_read_b64_tr_b16 v[132:133], v21 offset:16384
  v_mfma_f32_16x16x32_bf16 v[208:211], v[160:163], v[40:43], v[208:211]
  ds_read_b64_tr_b16 v[134:135], v21 offset:17408
  v_mfma_f32_16x16x32_bf16 v[216:219], v[160:163], v[44:47], v[216:219]
  ds_read_b64_tr_b16 v[136:137], v22 offset:16384
  ds_read_b64_tr_b16 v[138:139], v22 offset:17408
  v_mfma_f32_16x16x32_bf16 v[212:215], v[164:167], v[40:43], v[212:215]
  ds_read_b128 v[8:11], v27 offset:4112
  ds_read_b64_tr_b16 v[140:141], v23 offset:16384
  v_mfma_f32_16x16x32_bf16 v[220:223], v[164:167], v[44:47], v[220:223]
  ds_read_b64_tr_b16 v[142:143], v23 offset:17408
  v_mfma_f32_16x16x32_bf16 v[224:227], v[168:171], v[40:43], v[224:227]
  ds_read_b128 v[12:15], v27 offset:4128
  v_mfma_f32_16x16x32_bf16 v[232:235], v[168:171], v[44:47], v[232:235]
  v_mfma_f32_16x16x32_bf16 v[228:231], v[172:175], v[40:43], v[228:231]
  v_mfma_f32_16x16x32_bf16 v[236:239], v[172:175], v[44:47], v[236:239]
  s_waitcnt lgkmcnt(15)
  v_mfma_f32_16x16x32_bf16 v[176:179], v[112:115], v[48:51], v[176:179]
  ds_read_b64_tr_b16 v[144:145], v16 offset:24576
  ds_read_b64_tr_b16 v[146:147], v16 offset:25600
  s_waitcnt vmcnt(6)
  v_mfma_f32_32x32x16_bf16 v[64:79], v[240:243], v[80:83], 0
  v_mfma_f32_16x16x32_bf16 v[184:187], v[112:115], v[52:55], v[184:187]
  ds_read_b64_tr_b16 v[148:149], v17 offset:24576
  ds_read_b64_tr_b16 v[150:151], v17 offset:25600
  v_mfma_f32_16x16x32_bf16 v[180:183], v[116:119], v[48:51], v[180:183]
  ds_read_b64_tr_b16 v[152:153], v18 offset:24576
  s_waitcnt vmcnt(5)
  v_mfma_f32_32x32x16_bf16 v[64:79], v[244:247], v[84:87], v[64:79]
  s_cmp_lt_u32 s54, s56
  s_cbranch_scc0 K2_TK3H
K2_TK3G:
  s_and_b32 s80, s54, 0xc000
  s_add_u32 m0, s80, s66
  s_add_u32 s81, s54, 16384
  buffer_load_dwordx4 v3, s[40:43], s54 offen sc1 lds
  buffer_load_dwordx4 v3, s[40:43], s54 offen offset:1024 sc1 lds
  s_mov_b32 s54, s81
  v_mfma_f32_16x16x32_bf16 v[188:191], v[116:119], v[52:55], v[188:191]
  ds_read_b64_tr_b16 v[154:155], v18 offset:25600
  ds_read_b64_tr_b16 v[156:157], v19 offset:24576
  s_waitcnt lgkmcnt(15)
  v_mfma_f32_16x16x32_bf16 v[192:195], v[120:123], v[48:51], v[192:195]
  ds_read_b64_tr_b16 v[158:159], v19 offset:25600
  v_mfma_f32_16x16x32_bf16 v[200:203], v[120:123], v[52:55], v[200:203]
  ds_read_b64_tr_b16 v[160:161], v20 offset:24576
  ds_read_b64_tr_b16 v[162:163], v20 offset:25600
  s_waitcnt vmcnt(6)
  v_mfma_f32_32x32x16_bf16 v[64:79], v[248:251], v[88:91], v[64:79]
  v_mfma_f32_16x16x32_bf16 v[196:199], v[124:127], v[48:51], v[196:199]
  ds_read_b64_tr_b16 v[164:165], v21 offset:24576
  ds_read_b64_tr_b16 v[166:167], v21 offset:25600
  v_mfma_f32_16x16x32_bf16 v[204:207], v[124:127], v[52:55], v[204:207]
  ds_read_b64_tr_b16 v[168:169], v22 offset:24576
  v_mfma_f32_32x32x16_bf16 v[64:79], v[252:255], v[80:83], v[64:79]
  v_mfma_f32_16x16x32_bf16 v[208:211], v[128:131], v[48:51], v[208:211]
  ds_read_b64_tr_b16 v[170:171], v22 offset:25600
  ds_read_b64_tr_b16 v[172:173], v23 offset:24576
  v_mfma_f32_16x16x32_bf16 v[216:219], v[128:131], v[52:55], v[216:219]
  ds_read_b64_tr_b16 v[174:175], v23 offset:25600
  s_waitcnt lgkmcnt(15)
  v_mfma_f32_16x16x32_bf16 v[212:215], v[132:135], v[48:51], v[212:215]
  v_mov_b32 v16, 0
  v_mov_b32 v17, 0
  v_mfma_f32_32x32x16_bf16 v[64:79], v[8:11], v[84:87], v[64:79]
  v_mfma_f32_16x16x32_bf16 v[220:223], v[132:135], v[52:55], v[220:223]
  v_mov_b32 v18, 0
  v_mov_b32 v19, 0
  v_mfma_f32_16x16x32_bf16 v[224:227], v[136:139], v[48:51], v[224:227]
  v_mov_b32 v20, 0
  v_mfma_f32_32x32x16_bf16 v[64:79], v[12:15], v[88:91], v[64:79]
  v_mfma_f32_16x16x32_bf16 v[232:235], v[136:139], v[52:55], v[232:235]
  v_mov_b32 v21, 0
  v_mov_b32 v22, 0
  v_mfma_f32_16x16x32_bf16 v[228:231], v[140:143], v[48:51], v[228:231]
  v_mov_b32 v23, 0
  v_mfma_f32_16x16x32_bf16 v[236:239], v[140:143], v[52:55], v[236:239]
  s_waitcnt vmcnt(21) lgkmcnt(0)
  s_barrier
  v_mfma_f32_16x16x32_bf16 v[176:179], v[144:147], v[56:59], v[176:179]
  ds_read_b128 v[112:115], v4 offset:0
  s_nop 1
  v_add_f32 v12, 0x358637bd, v76
  v_rcp_f32 v12, v12
  v_mov_b32 v10, 0
  v_mov_b32 v11, 0
  v_mfma_f32_16x16x32_bf16 v[184:187], v[144:147], v[60:63], v[184:187]
  ds_read_b128 v[116:119], v4 offset:1024
  v_mul_f32 v64, v64, v12
  v_mul_f32 v65, v65, v12
  v_mul_f32 v66, v66, v12
  v_mfma_f32_16x16x32_bf16 v[180:183], v[148:151], v[56:59], v[180:183]
  ds_read_b128 v[120:123], v4 offset:2048
  s_cmp_lt_u32 s55, s88
  s_cbranch_scc0 K2_TV2H
K2_TV2G:
  s_and_b32 s80, s55, 0xc000
  s_add_u32 m0, s80, s67
  s_add_u32 s81, s55, 16384
  buffer_load_dwordx4 v3, s[44:47], s55 offen sc1 lds
  buffer_load_dwordx4 v3, s[44:47], s55 offen offset:1024 sc1 lds
  s_mov_b32 s55, s81
  v_mul_f32 v67, v67, v12
  v_mul_f32 v68, v68, v12
  v_mul_f32 v69, v69, v12
  v_mfma_f32_16x16x32_bf16 v[188:191], v[148:151], v[60:63], v[188:191]
  ds_read_b128 v[124:127], v4 offset:3072
  v_mul_f32 v70, v70, v12
  v_mul_f32 v71, v71, v12
  v_mul_f32 v72, v72, v12
  v_mfma_f32_16x16x32_bf16 v[192:195], v[152:155], v[56:59], v[192:195]
  ds_read_b128 v[128:131], v4 offset:4096
  v_mul_f32 v73, v73, v12
  v_mul_f32 v74, v74, v12
  v_mul_f32 v75, v75, v12
  v_mfma_f32_16x16x32_bf16 v[200:203], v[152:155], v[60:63], v[200:203]
  ds_read_b128 v[132:135], v4 offset:5120
  v_cvt_pk_bf16_f32 v64, v64, v65
  v_cvt_pk_bf16_f32 v65, v66, v67
  v_cvt_pk_bf16_f32 v66, v68, v69
  v_mfma_f32_16x16x32_bf16 v[196:199], v[156:159], v[56:59], v[196:199]
  ds_read_b128 v[136:139], v4 offset:6144
  v_cvt_pk_bf16_f32 v67, v70, v71
  v_cvt_pk_bf16_f32 v68, v72, v73
  v_cvt_pk_bf16_f32 v69, v74, v75
  v_pk_mul_f32 v[176:177], v[176:177], s[86:87]
  v_pk_mul_f32 v[178:179], v[178:179], s[86:87]
  v_pk_mul_f32 v[180:181], v[180:181], s[86:87]
  v_pk_mul_f32 v[182:183], v[182:183], s[86:87]
  v_mfma_f32_16x16x32_bf16 v[204:207], v[156:159], v[60:63], v[204:207]
  ds_read_b128 v[140:143], v4 offset:7168
  v_cvt_pk_bf16_f32 v80, v176, v177
  v_cvt_pk_bf16_f32 v81, v178, v179
  v_cvt_pk_bf16_f32 v82, v180, v181
  v_mfma_f32_16x16x32_bf16 v[208:211], v[160:163], v[56:59], v[208:211]
  v_cvt_pk_bf16_f32 v83, v182, v183
  v_pk_mul_f32 v[184:185], v[184:185], s[86:87]
  v_pk_mul_f32 v[186:187], v[186:187], s[86:87]
  v_mfma_f32_16x16x32_bf16 v[216:219], v[160:163], v[60:63], v[216:219]
  v_pk_mul_f32 v[188:189], v[188:189], s[86:87]
  v_pk_mul_f32 v[190:191], v[190:191], s[86:87]
  v_cvt_pk_bf16_f32 v96, v184, v185
  buffer_store_dwordx2 v[64:65], v28, s[36:39], s12 offen sc1
  v_mfma_f32_16x16x32_bf16 v[212:215], v[164:167], v[56:59], v[212:215]
  v_cvt_pk_bf16_f32 v97, v186, v187
  v_cvt_pk_bf16_f32 v98, v188, v189
  v_cvt_pk_bf16_f32 v99, v190, v191
  v_mfma_f32_16x16x32_bf16 v[220:223], v[164:167], v[60:63], v[220:223]
  v_pk_mul_f32 v[192:193], v[192:193], s[86:87]
  v_pk_mul_f32 v[194:195], v[194:195], s[86:87]
  v_pk_mul_f32 v[196:197], v[196:197], s[86:87]
  v_pk_mul_f32 v[198:199], v[198:199], s[86:87]
  buffer_store_dwordx2 v[66:67], v29, s[36:39], s12 offen sc1
  v_mfma_f32_16x16x32_bf16 v[224:227], v[168:171], v[56:59], v[224:227]
  v_cvt_pk_bf16_f32 v84, v192, v193
  v_cvt_pk_bf16_f32 v85, v194, v195
  v_cvt_pk_bf16_f32 v86, v196, v197
  v_mfma_f32_16x16x32_bf16 v[232:235], v[168:171], v[60:63], v[232:235]
  v_cvt_pk_bf16_f32 v87, v198, v199
  v_pk_mul_f32 v[200:201], v[200:201], s[86:87]
  v_pk_mul_f32 v[202:203], v[202:203], s[86:87]
  buffer_store_dwordx2 v[68:69], v30, s[36:39], s12 offen sc1
  v_mfma_f32_16x16x32_bf16 v[228:231], v[172:175], v[56:59], v[228:231]
  v_pk_mul_f32 v[204:205], v[204:205], s[86:87]
  v_pk_mul_f32 v[206:207], v[206:207], s[86:87]
  v_cvt_pk_bf16_f32 v100, v200, v201
  v_mfma_f32_16x16x32_bf16 v[236:239], v[172:175], v[60:63], v[236:239]
  v_cvt_pk_bf16_f32 v101, v202, v203
  v_cvt_pk_bf16_f32 v102, v204, v205
  v_cvt_pk_bf16_f32 v103, v206, v207
  ds_read_b128 v[144:147], v4 offset:8192
  ds_read_b128 v[148:151], v4 offset:9216
  ds_read_b128 v[152:155], v4 offset:10240
  ds_read_b128 v[156:159], v4 offset:11264
  ds_read_b128 v[160:163], v4 offset:12288
  ds_read_b128 v[164:167], v4 offset:13312
  ds_read_b128 v[168:171], v4 offset:14336
  ds_read_b128 v[172:175], v4 offset:15360
  v_pk_mul_f32 v[208:209], v[208:209], s[86:87]
  v_pk_mul_f32 v[210:211], v[210:211], s[86:87]
  v_pk_mul_f32 v[212:213], v[212:213], s[86:87]
  v_pk_mul_f32 v[214:215], v[214:215], s[86:87]
  v_cvt_pk_bf16_f32 v88, v208, v209
  v_cvt_pk_bf16_f32 v89, v210, v211
  v_cvt_pk_bf16_f32 v90, v212, v213
  v_cvt_pk_bf16_f32 v91, v214, v215
  v_pk_mul_f32 v[216:217], v[216:217], s[86:87]
  v_pk_mul_f32 v[218:219], v[218:219], s[86:87]
  v_pk_mul_f32 v[220:221], v[220:221], s[86:87]
  v_pk_mul_f32 v[222:223], v[222:223], s[86:87]
  v_cvt_pk_bf16_f32 v104, v216, v217
  v_cvt_pk_bf16_f32 v105, v218, v219
  v_cvt_pk_bf16_f32 v106, v220, v221
  v_cvt_pk_bf16_f32 v107, v222, v223
  s_waitcnt lgkmcnt(15)
  v_mfma_f32_16x16x32_bf16 v[48:51], v[112:115], v[80:83], v[16:19]
  v_pk_mul_f32 v[224:225], v[224:225], s[86:87]
  v_pk_mul_f32 v[226:227], v[226:227], s[86:87]
  v_mfma_f32_16x16x32_bf16 v[52:55], v[112:115], v[96:99], v[20:23]
  v_pk_mul_f32 v[228:229], v[228:229], s[86:87]
  v_pk_mul_f32 v[230:231], v[230:231], s[86:87]
  s_waitcnt lgkmcnt(11)
  v_mfma_f32_16x16x32_bf16 v[56:59], v[128:131], v[80:83], v[16:19]
  v_cvt_pk_bf16_f32 v92, v224, v225
  v_cvt_pk_bf16_f32 v93, v226, v227
  v_mfma_f32_16x16x32_bf16 v[60:63], v[128:131], v[96:99], v[20:23]
  v_cvt_pk_bf16_f32 v94, v228, v229
  v_cvt_pk_bf16_f32 v95, v230, v231
  v_mfma_f32_16x16x32_bf16 v[48:51], v[116:119], v[84:87], v[48:51]
  v_pk_mul_f32 v[232:233], v[232:233], s[86:87]
  v_pk_mul_f32 v[234:235], v[234:235], s[86:87]
  v_mfma_f32_16x16x32_bf16 v[52:55], v[116:119], v[100:103], v[52:55]
  v_pk_mul_f32 v[236:237], v[236:237], s[86:87]
  v_pk_mul_f32 v[238:239], v[238:239], s[86:87]
  s_waitcnt lgkmcnt(10)
  v_mfma_f32_16x16x32_bf16 v[56:59], v[132:135], v[84:87], v[56:59]
  v_cvt_pk_bf16_f32 v108, v232, v233
  v_cvt_pk_bf16_f32 v109, v234, v235
  v_mfma_f32_16x16x32_bf16 v[60:63], v[132:135], v[100:103], v[60:63]
  v_cvt_pk_bf16_f32 v110, v236, v237
  v_cvt_pk_bf16_f32 v111, v238, v239
  v_mfma_f32_16x16x32_bf16 v[48:51], v[120:123], v[88:91], v[48:51]
  v_mov_b32 v176, 0
  v_mov_b32 v177, 0
  v_mov_b32 v178, 0
  v_mfma_f32_16x16x32_bf16 v[52:55], v[120:123], v[104:107], v[52:55]
  v_mov_b32 v179, 0
  v_mov_b32 v180, 0
  v_mov_b32 v181, 0
  s_waitcnt lgkmcnt(9)
  v_mfma_f32_16x16x32_bf16 v[56:59], v[136:139], v[88:91], v[56:59]
  v_mov_b32 v182, 0
  v_mov_b32 v183, 0
  v_mov_b32 v184, 0
  v_mfma_f32_16x16x32_bf16 v[60:63], v[136:139], v[104:107], v[60:63]
  v_mov_b32 v185, 0
  v_mov_b32 v186, 0
  v_mov_b32 v187, 0
  v_mfma_f32_16x16x32_bf16 v[48:51], v[124:127], v[92:95], v[48:51]
  v_mov_b32 v188, 0
  v_mov_b32 v189, 0
  v_mov_b32 v190, 0
  v_mfma_f32_16x16x32_bf16 v[52:55], v[124:127], v[108:111], v[52:55]
  v_mov_b32 v191, 0
  v_mov_b32 v192, 0
  v_mov_b32 v193, 0
  s_waitcnt lgkmcnt(8)
  v_mfma_f32_16x16x32_bf16 v[56:59], v[140:143], v[92:95], v[56:59]
  v_mov_b32 v194, 0
  v_mov_b32 v195, 0
  v_mov_b32 v196, 0
  v_mfma_f32_16x16x32_bf16 v[60:63], v[140:143], v[108:111], v[60:63]
  v_mov_b32 v197, 0
  v_mov_b32 v198, 0
  v_mov_b32 v199, 0
  s_waitcnt lgkmcnt(0)
  s_cmp_eq_u32 s6, 0
  s_cbranch_scc1 K2_NOQS
  s_lshl_b32 s82, s7, 13
  s_add_u32 s82, s82, 131072
  v_add_u32 v240, s82, v2
  ds_write_b128 v240, v[80:83] offset:0
  ds_write_b128 v240, v[84:87] offset:1024
  ds_write_b128 v240, v[88:91] offset:2048
  ds_write_b128 v240, v[92:95] offset:3072
  ds_write_b128 v240, v[96:99] offset:4096
  ds_write_b128 v240, v[100:103] offset:5120
  ds_write_b128 v240, v[104:107] offset:6144
  ds_write_b128 v240, v[108:111] offset:7168
K2_NOQS:
  v_mfma_f32_16x16x32_bf16 v[64:67], v[144:147], v[80:83], v[16:19]
  v_mov_b32 v200, 0
  v_mov_b32 v201, 0
  v_mov_b32 v202, 0
  v_mov_b32 v203, 0
  s_lshl_b32 s85, 2, s53
  s_or_b32 s85, s85, 4
  s_cmp_lg_u32 s17, 0
  s_cselect_b32 s85, s85, 0
  s_or_b32 s85, s85, 8192
  s_andn2_b32 s97, 1, s2
  s_bfe_u32 s98, s2, 65538
  v_mfma_f32_16x16x32_bf16 v[68:71], v[144:147], v[96:99], v[20:23]
  v_mov_b32 v204, 0
  v_mov_b32 v205, 0
  v_mov_b32 v206, 0
  s_lshl1_add_u32 s97, s97, s98
  s_bfe_u32 s98, s2, 0x20003
  s_lshl2_add_u32 s97, s97, s98
  s_lshr_b32 s98, s2, 5
  s_bfe_u32 s96, s2, 0x10001
  s_lshl1_add_u32 s99, s97, s96
  v_mfma_f32_16x16x32_bf16 v[64:67], v[148:151], v[84:87], v[64:67]
  v_mov_b32 v207, 0
  v_mov_b32 v208, 0
  v_mov_b32 v209, 0
  s_mul_i32 s15, s99, 163840
  s_mul_i32 s8, s98, 160
  s_add_u32 s15, s15, s8
  s_xor_b32 s99, s99, 1
  s_mul_i32 s10, s99, 606208
  s_add_u32 s10, s10, 50331648
  v_mfma_f32_16x16x32_bf16 v[68:71], v[148:151], v[100:103], v[68:71]
  v_mov_b32 v210, 0
  v_mov_b32 v211, 0
  v_mov_b32 v212, 0
  v_mov_b32 v213, 0
  s_mul_i32 s12, s98, 757760
  s_add_u32 s12, s12, 71303168
  s_mul_i32 s8, s96, 1212416
  s_sub_u32 s8, s8, 606208
  s_lshr_b32 s48, s97, 3
  v_mfma_f32_16x16x32_bf16 v[64:67], v[152:155], v[88:91], v[64:67]
  v_mov_b32 v214, 0
  v_mov_b32 v215, 0
  v_mov_b32 v216, 0
  s_add_u32 s48, s48, 4
  s_mul_i32 s13, s2, 24576
  s_xor_b32 s14, s2, 2
  s_mul_i32 s14, s14, 24576
  s_add_u32 s13, s13, 117440512
  s_add_u32 s14, s14, 117440512
  v_mfma_f32_16x16x32_bf16 v[68:71], v[152:155], v[104:107], v[68:71]
  v_mov_b32 v217, 0
  v_mov_b32 v218, 0
  v_mov_b32 v219, 0
  s_xor_b32 s98, s97, 15
  s_min_u32 s97, s97, s98
  s_and_b32 s98, s97, 6
  s_and_b32 s97, s97, 1
  s_lshl1_add_u32 s97, s98, s97
  s_lshl_b32 s97, s97, 2
  v_mfma_f32_16x16x32_bf16 v[64:67], v[156:159], v[92:95], v[64:67]
  v_mov_b32 v220, 0
  v_mov_b32 v221, 0
  v_mov_b32 v222, 0
  v_mov_b32 v223, 0
  s_lshl_b32 s98, s96, 7
  s_or_b32 s97, s97, s98
  s_mul_i32 s98, s3, 9
  s_sub_u32 s98, s98, 8
  s_cmp_lt_u32 s3, 2
  s_cselect_b32 s98, 0, s98
  s_cselect_b64 s[34:35], -1, 0
  s_cselect_b32 s99, 9, 8
  v_mfma_f32_16x16x32_bf16 v[68:71], v[156:159], v[108:111], v[68:71]
  v_mov_b32 v224, 0
  v_mov_b32 v225, 0
  v_mov_b32 v226, 0
  v_lshrrev_b32 v254, 2, v2
  v_min_u32 v254, s99, v254
  v_add_u32 v252, s98, v254
  v_bfe_u32 v254, v252, 2, 2
  v_or_b32 v254, s97, v254
  v_bfe_u32 v253, v252, 4, 1
  v_mfma_f32_16x16x32_bf16 v[72:75], v[160:163], v[80:83], v[16:19]
  v_mov_b32 v227, 0
  v_mov_b32 v228, 0
  v_mov_b32 v229, 0
  v_lshl_or_b32 v254, v253, 6, v254
  v_bfe_u32 v253, v252, 5, 1
  v_lshl_or_b32 v254, v253, 3, v254
  v_xor_b32 v254, 8, v254
  v_lshlrev_b32 v252, 8, v254
  v_add_u32 v252, 93323264, v252
  v_mfma_f32_16x16x32_bf16 v[76:79], v[160:163], v[96:99], v[20:23]
  v_mov_b32 v230, 0
  v_mov_b32 v231, 0
  v_mov_b32 v232, 0
  v_mov_b32 v233, 0
  s_and_b32 s97, s98, 31
  s_and_b32 s99, s97, 16
  s_add_u32 s99, s99, s97
  s_andn2_b32 s97, 32, s98
  s_lshr_b32 s97, s97, 1
  v_mfma_f32_16x16x32_bf16 v[72:75], v[164:167], v[84:87], v[72:75]
  v_mov_b32 v234, 0
  v_mov_b32 v235, 0
  v_mov_b32 v236, 0
  s_or_b32 s99, s99, s97
  s_add_u32 s98, s98, 16
  s_and_b32 s100, s98, 16
  s_lshl_b32 s100, s100, 1
  s_andn2_b32 s97, 32, s98
  s_lshr_b32 s97, s97, 1
  v_mfma_f32_16x16x32_bf16 v[76:79], v[164:167], v[100:103], v[76:79]
  v_mov_b32 v237, 0
  v_mov_b32 v238, 0
  v_mov_b32 v239, 0
  s_or_b32 s100, s100, s97
  s_lshl_b32 s97, s96, 6
  s_add_u32 s99, s99, s97
  s_add_u32 s100, s100, s97
  s_or_b32 s98, s99, 15
  s_add_u32 s98, s98, 1
  v_mfma_f32_16x16x32_bf16 v[72:75], v[168:171], v[88:91], v[72:75]
  s_mul_i32 s96, s96, 10
  s_add_u32 s96, s96, 128
  s_cmp_eq_u32 s3, 0
  s_cselect_b32 s99, s96, s99
  s_cselect_b32 s98, 0, s98
  s_cselect_b32 s48, 0, s48
  s_lshl_b32 s24, s99, 12
  s_lshl_b32 s9, s98, 12
  v_mfma_f32_16x16x32_bf16 v[76:79], v[168:171], v[104:107], v[76:79]
  s_lshl_b32 s96, s100, 12
  s_add_u32 s24, s24, s10
  s_add_u32 s9, s9, s10
  s_add_u32 s10, s10, s96
  s_add_u32 s27, s24, s8
  s_mul_i32 s25, s99, 5120
  v_mfma_f32_16x16x32_bf16 v[72:75], v[172:175], v[92:95], v[72:75]
  s_mul_i32 s11, s98, 5120
  s_mul_i32 s96, s100, 5120
  s_add_u32 s25, s25, s12
  s_add_u32 s11, s11, s12
  s_add_u32 s12, s12, s96
  s_add_u32 s26, s25, 4096
  v_mfma_f32_16x16x32_bf16 v[76:79], v[172:175], v[108:111], v[76:79]
  s_mov_b64 s[18:19], 0
  s_mov_b32 s86, 0
  s_mov_b32 s22, 5242880
  s_mov_b32 s23, 0x00020000
  s_load_dwordx2 s[20:21], s[0:1], 80
  s_mov_b32 s52, -1
  s_cmp_ge_i32 s57, 0
  s_cbranch_scc1 K2_MASKA
K2_PFORCED:
  s_mov_b32 s52, 0
  v_max3_f32 v12, v48, v49, v50
  v_max3_f32 v12, v12, v51, v56
  v_max3_f32 v12, v12, v57, v58
  v_max3_f32 v12, v12, v59, s65
  v_max3_f32 v13, v52, v53, v54
  v_max3_f32 v13, v13, v55, v60
  v_max3_f32 v13, v13, v61, v62
  v_max3_f32 v13, v13, v63, s65
  v_mov_b32 v14, v12
  v_mov_b32 v15, v13
  s_nop 0
  v_permlane16_swap_b32 v12, v14
  v_permlane16_swap_b32 v13, v15
  v_max_f32 v12, v12, v14
  v_max_f32 v13, v13, v15
  v_mov_b32 v14, v12
  v_mov_b32 v15, v13
  s_nop 0
  v_permlane32_swap_b32 v12, v14
  v_permlane32_swap_b32 v13, v15
  v_max_f32 v12, v12, v14
  v_max_f32 v13, v13, v15
  v_sub_f32 v16, v16, v12
  v_sub_f32 v17, v17, v12
  v_sub_f32 v18, v18, v12
  v_sub_f32 v19, v19, v12
  v_sub_f32 v48, v48, v12
  v_sub_f32 v49, v49, v12
  v_sub_f32 v50, v50, v12
  v_sub_f32 v51, v51, v12
  v_sub_f32 v56, v56, v12
  v_sub_f32 v57, v57, v12
  v_sub_f32 v58, v58, v12
  v_sub_f32 v59, v59, v12
  v_sub_f32 v64, v64, v12
  v_sub_f32 v65, v65, v12
  v_sub_f32 v66, v66, v12
  v_sub_f32 v67, v67, v12
  v_sub_f32 v72, v72, v12
  v_sub_f32 v73, v73, v12
  v_sub_f32 v74, v74, v12
  v_sub_f32 v75, v75, v12
  v_sub_f32 v20, v20, v13
  v_sub_f32 v21, v21, v13
  v_sub_f32 v22, v22, v13
  v_sub_f32 v23, v23, v13
  v_sub_f32 v52, v52, v13
  v_sub_f32 v53, v53, v13
  v_sub_f32 v54, v54, v13
  v_sub_f32 v55, v55, v13
  v_sub_f32 v60, v60, v13
  v_sub_f32 v61, v61, v13
  v_sub_f32 v62, v62, v13
  v_sub_f32 v63, v63, v13
  v_sub_f32 v68, v68, v13
  v_sub_f32 v69, v69, v13
  v_sub_f32 v70, v70, v13
  v_sub_f32 v71, v71, v13
  v_sub_f32 v76, v76, v13
  v_sub_f32 v77, v77, v13
  v_sub_f32 v78, v78, v13
  v_sub_f32 v79, v79, v13
  s_lshl_b32 s82, s7, 11
  s_add_u32 s82, s82, 114688
  v_add_u32 v250, s82, v2
  s_cmp_eq_u32 s6, 0
  s_cbranch_scc1 K2_NONM
  ds_write2_b32 v250, v16, v20 offset1:1
K2_NONM:
  s_waitcnt vmcnt(9) lgkmcnt(0)
  s_barrier
  ds_read_b64 v[248:249], v250
  ds_read_b128 v[112:115], v5 offset:0
  ds_read_b128 v[116:119], v5 offset:1024
  ds_read_b128 v[120:123], v5 offset:2048
  ds_read_b128 v[124:127], v5 offset:3072
  ds_read_b128 v[128:131], v5 offset:4096
  ds_read_b128 v[132:135], v5 offset:5120
  ds_read_b128 v[136:139], v5 offset:6144
  ds_read_b128 v[140:143], v5 offset:7168
  s_cmp_eq_u32 s62, 0
  s_cselect_b32 s82, 15, 14
  s_lshl_b32 s82, 1, s82
  v_add_u32 v4, s82, v2
  v_exp_f32 v24, v48
  v_exp_f32 v25, v49
  v_exp_f32 v26, v50
  v_exp_f32 v27, v51
  v_add_f32 v8, v10, v24
  v_exp_f32 v28, v52
  v_add_f32 v8, v8, v25
  v_cvt_pk_bf16_f32 v32, v24, v25
  v_exp_f32 v29, v53
  v_add_f32 v8, v8, v26
  v_exp_f32 v30, v54
  v_add_f32 v8, v8, v27
  v_cvt_pk_bf16_f32 v33, v26, v27
  v_exp_f32 v31, v55
  v_add_f32 v9, v11, v28
  v_exp_f32 v24, v56
  v_add_f32 v9, v9, v29
  v_cvt_pk_bf16_f32 v36, v28, v29
  v_exp_f32 v25, v57
  v_add_f32 v9, v9, v30
  v_exp_f32 v26, v58
  v_add_f32 v9, v9, v31
  v_cvt_pk_bf16_f32 v37, v30, v31
  v_exp_f32 v27, v59
  v_add_f32 v8, v8, v24
  v_exp_f32 v28, v60
  v_add_f32 v8, v8, v25
  v_cvt_pk_bf16_f32 v34, v24, v25
  v_exp_f32 v29, v61
  v_add_f32 v8, v8, v26
  v_exp_f32 v30, v62
  v_add_f32 v8, v8, v27
  v_cvt_pk_bf16_f32 v35, v26, v27
  v_exp_f32 v31, v63
  v_add_f32 v9, v9, v28
  v_add_f32 v9, v9, v29
  v_cvt_pk_bf16_f32 v38, v28, v29
  v_add_f32 v9, v9, v30
  v_add_f32 v9, v9, v31
  v_cvt_pk_bf16_f32 v39, v30, v31
  s_mov_b32 s65, 0
  s_cmp_lt_u32 s54, s56
  s_cbranch_scc0 K2_TK4H
K2_TK4G:
  s_and_b32 s80, s54, 0xc000
  s_add_u32 m0, s80, s66
  s_add_u32 s81, s54, 16384
  buffer_load_dwordx4 v3, s[40:43], s54 offen sc1 lds
  buffer_load_dwordx4 v3, s[40:43], s54 offen offset:1024 sc1 lds
  s_mov_b32 s54, s81
  v_mov_b32 v244, -1
  v_mov_b32 v245, -1
  v_mov_b32 v246, -1
  v_mov_b32 v247, -1
  s_mul_i32 s96, s3, 3072
  s_add_u32 s96, s96, s13
  s_and_b32 s97, s89, 255
  s_cmp_eq_u32 s97, s2
  s_cselect_b32 s96, s96, 92274688
  buffer_store_dwordx4 v[244:247], v2, s[36:39], s96 offen offset:0 sc1
  buffer_store_dwordx4 v[244:247], v2, s[36:39], s96 offen offset:1024 sc1
  buffer_store_dwordx4 v[244:247], v2, s[36:39], s96 offen offset:2048 sc1
  s_branch K2_RETE
K2_H2L:
  s_waitcnt lgkmcnt(7)
  v_mfma_f32_16x16x32_bf16 v[176:179], v[112:115], v[40:43], v[176:179]
  ds_read_b128 v[144:147], v4 offset:8192
  v_exp_f32 v24, v48
  v_mfma_f32_16x16x32_bf16 v[184:187], v[112:115], v[44:47], v[184:187]
  ds_read_b128 v[148:151], v4 offset:9216
  v_exp_f32 v25, v49
  s_waitcnt lgkmcnt(8)
  v_mfma_f32_16x16x32_bf16 v[180:183], v[116:119], v[40:43], v[180:183]
  ds_read_b128 v[152:155], v4 offset:10240
  v_exp_f32 v26, v50
  s_lshl1_add_u32 s82, s52, 4
  v_mfma_f32_16x16x32_bf16 v[188:191], v[116:119], v[44:47], v[188:191]
  ds_read_b128 v[156:159], v4 offset:11264
  v_exp_f32 v27, v51
  s_lshl1_add_u32 s83, s82, s59
  s_waitcnt lgkmcnt(9)
  v_mfma_f32_16x16x32_bf16 v[192:195], v[120:123], v[40:43], v[192:195]
  ds_read_b128 v[160:163], v4 offset:12288
  v_add_f32 v8, v10, v24
  s_cmp_ge_u32 s82, s84
  v_mfma_f32_16x16x32_bf16 v[200:203], v[120:123], v[44:47], v[200:203]
  ds_read_b128 v[164:167], v4 offset:13312
  v_exp_f32 v28, v52
  s_cselect_b32 s82, s83, s82
  s_waitcnt lgkmcnt(10)
  v_mfma_f32_16x16x32_bf16 v[196:199], v[124:127], v[40:43], v[196:199]
  ds_read_b128 v[168:171], v4 offset:14336
  v_add_f32 v8, v8, v25
  v_cvt_pk_bf16_f32 v32, v24, v25
  s_cselect_b32 s83, s61, s60
  v_mfma_f32_16x16x32_bf16 v[204:207], v[124:127], v[44:47], v[204:207]
  ds_read_b128 v[172:175], v4 offset:15360
  v_exp_f32 v29, v53
  s_sub_u32 s58, s82, s83
  s_waitcnt lgkmcnt(11)
  v_mfma_f32_16x16x32_bf16 v[208:211], v[128:131], v[40:43], v[208:211]
  v_add_f32 v8, v8, v26
  s_and_b32 s82, s82, 7
  v_mfma_f32_16x16x32_bf16 v[216:219], v[128:131], v[44:47], v[216:219]
  v_exp_f32 v30, v54
  v_add_f32 v8, v8, v27
  s_lshl_b32 s82, s82, 13
  s_waitcnt lgkmcnt(10)
  v_mfma_f32_16x16x32_bf16 v[212:215], v[132:135], v[40:43], v[212:215]
  v_cvt_pk_bf16_f32 v33, v26, v27
  v_mfma_f32_16x16x32_bf16 v[220:223], v[132:135], v[44:47], v[220:223]
  v_exp_f32 v31, v55
  v_add_u32 v5, 65536, v4
  s_waitcnt lgkmcnt(9)
  v_mfma_f32_16x16x32_bf16 v[224:227], v[136:139], v[40:43], v[224:227]
  v_add_f32 v9, v11, v28
  v_exp_f32 v24, v56
  v_add_u32 v4, s82, v2
  v_mfma_f32_16x16x32_bf16 v[232:235], v[136:139], v[44:47], v[232:235]
  v_add_f32 v9, v9, v29
  s_add_u32 s83, s52, 3
  s_waitcnt lgkmcnt(8)
  v_mfma_f32_16x16x32_bf16 v[228:231], v[140:143], v[40:43], v[228:231]
  v_cvt_pk_bf16_f32 v36, v28, v29
  v_exp_f32 v25, v57
  s_cmp_gt_u32 s83, s53
  v_mfma_f32_16x16x32_bf16 v[236:239], v[140:143], v[44:47], v[236:239]
  v_add_f32 v9, v9, v30
  s_cbranch_scc1 K2_W0
  s_waitcnt vmcnt(8) lgkmcnt(0)
  s_branch K2_W1
K2_W0:
  s_waitcnt vmcnt(0) lgkmcnt(0)
K2_W1:
  s_bitcmp1_b32 s85, s52
  s_barrier
  s_cbranch_scc1 K2_HOOK
K2_HRET:
  v_mfma_f32_16x16x32_bf16 v[64:67], v[144:147], v[80:83], v[16:19]
  ds_read_b128 v[112:115], v5 offset:0
  v_exp_f32 v26, v58
  s_add_u32 s52, s52, 1
  v_mfma_f32_16x16x32_bf16 v[68:71], v[144:147], v[96:99], v[20:23]
  ds_read_b128 v[116:119], v5 offset:1024
  v_add_f32 v9, v9, v31
  v_cvt_pk_bf16_f32 v37, v30, v31
  s_cmp_lt_u32 s54, s56
  s_cbranch_scc0 K2_D0H
K2_D0G:
  s_and_b32 s80, s54, 0xc000
  s_add_u32 m0, s80, s66
  s_nop 0
  buffer_load_dwordx4 v3, s[40:43], s54 offen sc1 lds
K2_D0_0:
  v_mfma_f32_16x16x32_bf16 v[64:67], v[148:151], v[84:87], v[64:67]
  v_exp_f32 v27, v59
  v_mfma_f32_16x16x32_bf16 v[68:71], v[148:151], v[100:103], v[68:71]
  ds_read_b128 v[120:123], v5 offset:2048
  v_add_f32 v8, v8, v24
  v_mfma_f32_16x16x32_bf16 v[64:67], v[152:155], v[88:91], v[64:67]
  ds_read_b128 v[124:127], v5 offset:3072
  v_exp_f32 v28, v60
  v_mfma_f32_16x16x32_bf16 v[68:71], v[152:155], v[104:107], v[68:71]
  v_add_f32 v8, v8, v25
  v_cvt_pk_bf16_f32 v34, v24, v25
  s_cmp_lt_u32 s54, s56
  s_cbranch_scc0 K2_D0_1
  buffer_load_dwordx4 v3, s[40:43], s54 offen offset:1024 sc1 lds
  s_add_u32 s54, s54, 16384
K2_D0_1:
  v_mfma_f32_16x16x32_bf16 v[64:67], v[156:159], v[92:95], v[64:67]
  ds_read_b128 v[128:131], v5 offset:4096
  v_exp_f32 v29, v61
  v_mfma_f32_16x16x32_bf16 v[68:71], v[156:159], v[108:111], v[68:71]
  ds_read_b128 v[132:135], v5 offset:5120
  v_add_f32 v8, v8, v26
  v_mfma_f32_16x16x32_bf16 v[72:75], v[160:163], v[80:83], v[16:19]
  v_exp_f32 v30, v62
  v_add_f32 v8, v8, v27
  v_mfma_f32_16x16x32_bf16 v[76:79], v[160:163], v[96:99], v[20:23]
  ds_read_b128 v[136:139], v5 offset:6144
  v_cvt_pk_bf16_f32 v35, v26, v27
  s_cmp_ge_u32 s52, s53
  s_cselect_b32 s68, s56, 0
  s_cmp_lt_u32 s54, s68
  s_cbranch_scc0 K2_D1_0
  s_and_b32 s80, s54, 0xc000
  s_add_u32 m0, s80, s66
  s_nop 0
  buffer_load_dwordx4 v3, s[40:43], s54 offen sc1 lds
K2_D1_0:
  v_mfma_f32_16x16x32_bf16 v[72:75], v[164:167], v[84:87], v[72:75]
  ds_read_b128 v[140:143], v5 offset:7168
  v_exp_f32 v31, v63
  v_add_f32 v9, v9, v28
  v_mfma_f32_16x16x32_bf16 v[76:79], v[164:167], v[100:103], v[76:79]
  v_add_f32 v9, v9, v29
  v_mfma_f32_16x16x32_bf16 v[72:75], v[168:171], v[88:91], v[72:75]
  v_cvt_pk_bf16_f32 v38, v28, v29
  v_add_f32 v9, v9, v30
  v_mfma_f32_16x16x32_bf16 v[76:79], v[168:171], v[104:107], v[76:79]
  v_add_f32 v9, v9, v31
  v_cvt_pk_bf16_f32 v39, v30, v31
  s_cmp_lt_u32 s54, s68
  s_cbranch_scc0 K2_D1_1
  buffer_load_dwordx4 v3, s[40:43], s54 offen offset:1024 sc1 lds
  s_add_u32 s54, s54, 16384
K2_D1_1:
  v_mfma_f32_16x16x32_bf16 v[72:75], v[172:175], v[92:95], v[72:75]
  v_max_f32 v12, v8, v9
  v_cmp_lt_f32 vcc, s64, v12
  v_mfma_f32_16x16x32_bf16 v[76:79], v[172:175], v[108:111], v[76:79]
  s_cbranch_vccnz K2_SLOWE
K2_RETE:
  s_cmp_ge_i32 s57, -1
  s_cbranch_scc1 K2_MASKB
K2_RETMB:
  s_mov_b32 s57, s58
K2_LOOP:
  s_cmp_eq_u32 s52, s62
  s_cbranch_scc1 K2_QSW
K2_QRET:
  s_waitcnt lgkmcnt(7)
  v_mfma_f32_16x16x32_bf16 v[176:179], v[112:115], v[32:35], v[176:179]
  ds_read_b128 v[144:147], v4 offset:0
  v_exp_f32 v24, v64
  v_mfma_f32_16x16x32_bf16 v[184:187], v[112:115], v[36:39], v[184:187]
  ds_read_b128 v[148:151], v4 offset:1024
  v_exp_f32 v25, v65
  s_cmp_lt_u32 s55, s88
  s_cbranch_scc0 K2_D2H
K2_D2G:
  s_and_b32 s80, s55, 0xc000
  s_add_u32 m0, s80, s67
  s_nop 0
  buffer_load_dwordx4 v3, s[44:47], s55 offen sc1 lds
K2_D2_0:
  s_waitcnt lgkmcnt(8)
  v_mfma_f32_16x16x32_bf16 v[180:183], v[116:119], v[32:35], v[180:183]
  v_exp_f32 v26, v66
  v_mfma_f32_16x16x32_bf16 v[188:191], v[116:119], v[36:39], v[188:191]
  ds_read_b128 v[152:155], v4 offset:2048
  v_exp_f32 v27, v67
  s_waitcnt lgkmcnt(8)
  v_mfma_f32_16x16x32_bf16 v[192:195], v[120:123], v[32:35], v[192:195]
  ds_read_b128 v[156:159], v4 offset:3072
  v_add_f32 v10, v8, v24
  v_mfma_f32_16x16x32_bf16 v[200:203], v[120:123], v[36:39], v[200:203]
  v_exp_f32 v28, v68
  s_cmp_lt_u32 s55, s88
  s_cbranch_scc0 K2_D2_1
  buffer_load_dwordx4 v3, s[44:47], s55 offen offset:1024 sc1 lds
  s_add_u32 s55, s55, 16384
K2_D2_1:
  s_waitcnt lgkmcnt(8)
  v_mfma_f32_16x16x32_bf16 v[196:199], v[124:127], v[32:35], v[196:199]
  ds_read_b128 v[160:163], v4 offset:4096
  v_add_f32 v10, v10, v25
  v_cvt_pk_bf16_f32 v40, v24, v25
  v_mfma_f32_16x16x32_bf16 v[204:207], v[124:127], v[36:39], v[204:207]
  ds_read_b128 v[164:167], v4 offset:5120
  v_exp_f32 v29, v69
  s_waitcnt lgkmcnt(9)
  v_mfma_f32_16x16x32_bf16 v[208:211], v[128:131], v[32:35], v[208:211]
  v_add_f32 v10, v10, v26
  v_mfma_f32_16x16x32_bf16 v[216:219], v[128:131], v[36:39], v[216:219]
  ds_read_b128 v[168:171], v4 offset:6144
  v_exp_f32 v30, v70
  v_add_f32 v10, v10, v27
  s_cmp_gt_u32 s52, s53
  s_cselect_b32 s68, s88, 0
  s_cmp_lt_u32 s55, s68
  s_cbranch_scc0 K2_D3_0
  s_and_b32 s80, s55, 0xc000
  s_add_u32 m0, s80, s67
  s_nop 0
  buffer_load_dwordx4 v3, s[44:47], s55 offen sc1 lds
K2_D3_0:
  s_waitcnt lgkmcnt(9)
  v_mfma_f32_16x16x32_bf16 v[212:215], v[132:135], v[32:35], v[212:215]
  ds_read_b128 v[172:175], v4 offset:7168
  v_cvt_pk_bf16_f32 v41, v26, v27
  v_mfma_f32_16x16x32_bf16 v[220:223], v[132:135], v[36:39], v[220:223]
  v_exp_f32 v31, v71
  s_waitcnt lgkmcnt(9)
  v_mfma_f32_16x16x32_bf16 v[224:227], v[136:139], v[32:35], v[224:227]
  v_add_f32 v11, v9, v28
  v_exp_f32 v24, v72
  v_mfma_f32_16x16x32_bf16 v[232:235], v[136:139], v[36:39], v[232:235]
  v_add_f32 v11, v11, v29
  s_cmp_lt_u32 s55, s68
  s_cbranch_scc0 K2_D3_1
  buffer_load_dwordx4 v3, s[44:47], s55 offen offset:1024 sc1 lds
  s_add_u32 s55, s55, 16384
K2_D3_1:
  s_waitcnt lgkmcnt(8)
  v_mfma_f32_16x16x32_bf16 v[228:231], v[140:143], v[32:35], v[228:231]
  v_cvt_pk_bf16_f32 v44, v28, v29
  v_exp_f32 v25, v73
  v_mfma_f32_16x16x32_bf16 v[236:239], v[140:143], v[36:39], v[236:239]
  v_add_f32 v11, v11, v30
  s_waitcnt lgkmcnt(7)
  v_mfma_f32_16x16x32_bf16 v[48:51], v[144:147], v[80:83], v[16:19]
  ds_read_b128 v[112:115], v5 offset:8192
  v_exp_f32 v26, v74
  v_mfma_f32_16x16x32_bf16 v[52:55], v[144:147], v[96:99], v[20:23]
  ds_read_b128 v[116:119], v5 offset:9216
  v_add_f32 v11, v11, v31
  v_cvt_pk_bf16_f32 v45, v30, v31
  s_waitcnt lgkmcnt(8)
  v_mfma_f32_16x16x32_bf16 v[48:51], v[148:151], v[84:87], v[48:51]
  v_exp_f32 v27, v75
  v_mfma_f32_16x16x32_bf16 v[52:55], v[148:151], v[100:103], v[52:55]
  ds_read_b128 v[120:123], v5 offset:10240
  v_add_f32 v10, v10, v24
  s_waitcnt lgkmcnt(8)
  v_mfma_f32_16x16x32_bf16 v[48:51], v[152:155], v[88:91], v[48:51]
  ds_read_b128 v[124:127], v5 offset:11264
  v_exp_f32 v28, v76
  v_mfma_f32_16x16x32_bf16 v[52:55], v[152:155], v[104:107], v[52:55]
  v_add_f32 v10, v10, v25
  v_cvt_pk_bf16_f32 v42, v24, v25
  s_waitcnt lgkmcnt(8)
  v_mfma_f32_16x16x32_bf16 v[48:51], v[156:159], v[92:95], v[48:51]
  ds_read_b128 v[128:131], v5 offset:12288
  v_exp_f32 v29, v77
  v_mfma_f32_16x16x32_bf16 v[52:55], v[156:159], v[108:111], v[52:55]
  ds_read_b128 v[132:135], v5 offset:13312
  v_add_f32 v10, v10, v26
  s_waitcnt lgkmcnt(9)
  v_mfma_f32_16x16x32_bf16 v[56:59], v[160:163], v[80:83], v[16:19]
  v_exp_f32 v30, v78
  v_add_f32 v10, v10, v27
  v_mfma_f32_16x16x32_bf16 v[60:63], v[160:163], v[96:99], v[20:23]
  ds_read_b128 v[136:139], v5 offset:14336
  v_cvt_pk_bf16_f32 v43, v26, v27
  s_waitcnt lgkmcnt(9)
  v_mfma_f32_16x16x32_bf16 v[56:59], v[164:167], v[84:87], v[56:59]
  ds_read_b128 v[140:143], v5 offset:15360
  v_exp_f32 v31, v79
  v_add_f32 v11, v11, v28
  v_mfma_f32_16x16x32_bf16 v[60:63], v[164:167], v[100:103], v[60:63]
  v_add_f32 v11, v11, v29
  s_waitcnt lgkmcnt(9)
  v_mfma_f32_16x16x32_bf16 v[56:59], v[168:171], v[88:91], v[56:59]
  v_cvt_pk_bf16_f32 v46, v28, v29
  v_add_f32 v11, v11, v30
  v_mfma_f32_16x16x32_bf16 v[60:63], v[168:171], v[104:107], v[60:63]
  v_add_f32 v11, v11, v31
  v_cvt_pk_bf16_f32 v47, v30, v31
  s_waitcnt lgkmcnt(8)
  v_mfma_f32_16x16x32_bf16 v[56:59], v[172:175], v[92:95], v[56:59]
  v_max_f32 v12, v10, v11
  v_cmp_lt_f32 vcc, s63, v12
  v_mfma_f32_16x16x32_bf16 v[60:63], v[172:175], v[108:111], v[60:63]
  s_cmp_ge_i32 s57, 0
  s_cbranch_vccnz K2_SLOWM
K2_RETM:
  s_cbranch_scc1 K2_MASKA
K2_RETMA:
  s_cmp_lt_u32 s52, 15
  s_cbranch_scc1 K2_H2L
  v_and_b32 v253, 0x10101010, v255
  v_cmp_ne_u32 vcc, 0x10101010, v253
  s_nop 0
  s_cbranch_vccnz K2_SA
K2_SAR:
  s_mov_b32 s52, 16
  v_add_u32 v5, 65536, v4
  s_waitcnt lgkmcnt(7)
  v_mfma_f32_16x16x32_bf16 v[176:179], v[112:115], v[40:43], v[176:179]
  v_exp_f32 v24, v48
  v_exp_f32 v25, v49
  buffer_load_dword v253, v252, s[36:39], 0 offen sc1
  v_mfma_f32_16x16x32_bf16 v[184:187], v[112:115], v[44:47], v[184:187]
  v_exp_f32 v26, v50
  v_exp_f32 v27, v51
  buffer_load_dwordx4 v[80:83], v2, s[36:39], s25 offen offset:0 sc1
  s_waitcnt lgkmcnt(6)
  v_mfma_f32_16x16x32_bf16 v[180:183], v[116:119], v[40:43], v[180:183]
  v_add_f32 v8, v10, v24
  v_exp_f32 v28, v52
  buffer_load_dwordx4 v[84:87], v2, s[36:39], s25 offen offset:1024 sc1
  v_mfma_f32_16x16x32_bf16 v[188:191], v[116:119], v[44:47], v[188:191]
  v_add_f32 v8, v8, v25
  v_cvt_pk_bf16_f32 v32, v24, v25
  v_exp_f32 v29, v53
  s_waitcnt lgkmcnt(5)
  v_mfma_f32_16x16x32_bf16 v[192:195], v[120:123], v[40:43], v[192:195]
  v_add_f32 v8, v8, v26
  v_exp_f32 v30, v54
  buffer_load_dwordx4 v[88:91], v2, s[36:39], s25 offen offset:2048 sc1
  v_mfma_f32_16x16x32_bf16 v[200:203], v[120:123], v[44:47], v[200:203]
  v_add_f32 v8, v8, v27
  v_cvt_pk_bf16_f32 v33, v26, v27
  v_exp_f32 v31, v55
  buffer_load_dwordx4 v[92:95], v2, s[36:39], s25 offen offset:3072 sc1
  s_waitcnt lgkmcnt(4)
  v_mfma_f32_16x16x32_bf16 v[196:199], v[124:127], v[40:43], v[196:199]
  v_add_f32 v9, v11, v28
  v_exp_f32 v24, v56
  v_mfma_f32_16x16x32_bf16 v[204:207], v[124:127], v[44:47], v[204:207]
  v_add_f32 v9, v9, v29
  v_cvt_pk_bf16_f32 v36, v28, v29
  v_exp_f32 v25, v57
  buffer_load_dwordx4 v[96:99], v2, s[36:39], s26 offen offset:0 sc1
  s_add_u32 s25, s25, 5120
  s_cmp_eq_u32 s25, s11
  s_cselect_b32 s25, s12, s25
  s_add_u32 s26, s25, 4096
  s_waitcnt lgkmcnt(3)
  v_mfma_f32_16x16x32_bf16 v[208:211], v[128:131], v[40:43], v[208:211]
  v_add_f32 v9, v9, v30
  v_exp_f32 v26, v58
  v_add_f32 v9, v9, v31
  buffer_load_dwordx4 v[100:103], v2, s[36:39], s25 offen offset:0 sc1
  v_mfma_f32_16x16x32_bf16 v[216:219], v[128:131], v[44:47], v[216:219]
  v_cvt_pk_bf16_f32 v37, v30, v31
  v_exp_f32 v27, v59
  s_waitcnt lgkmcnt(2)
  v_mfma_f32_16x16x32_bf16 v[212:215], v[132:135], v[40:43], v[212:215]
  v_add_f32 v8, v8, v24
  v_exp_f32 v28, v60
  v_add_f32 v8, v8, v25
  buffer_load_dwordx4 v[104:107], v2, s[36:39], s25 offen offset:1024 sc1
  v_mfma_f32_16x16x32_bf16 v[220:223], v[132:135], v[44:47], v[220:223]
  v_cvt_pk_bf16_f32 v34, v24, v25
  v_exp_f32 v29, v61
  buffer_load_dwordx4 v[108:111], v2, s[36:39], s25 offen offset:2048 sc1
  s_waitcnt lgkmcnt(1)
  v_mfma_f32_16x16x32_bf16 v[224:227], v[136:139], v[40:43], v[224:227]
  s_waitcnt vmcnt(9)
  s_barrier
  ds_read_b128 v[144:147], v5 offset:0
  ds_read_b128 v[148:151], v5 offset:1024
  ds_read_b128 v[152:155], v5 offset:2048
  ds_read_b128 v[156:159], v5 offset:3072
  ds_read_b128 v[160:163], v5 offset:4096
  ds_read_b128 v[164:167], v5 offset:5120
  ds_read_b128 v[168:171], v5 offset:6144
  ds_read_b128 v[172:175], v5 offset:7168
  v_add_f32 v8, v8, v26
  v_exp_f32 v30, v62
  v_add_f32 v8, v8, v27
  v_mfma_f32_16x16x32_bf16 v[232:235], v[136:139], v[44:47], v[232:235]
  v_cvt_pk_bf16_f32 v35, v26, v27
  v_exp_f32 v31, v63
  v_add_f32 v9, v9, v28
  buffer_load_dwordx4 v[240:243], v2, s[36:39], s25 offen offset:3072 sc1
  s_waitcnt lgkmcnt(8)
  v_mfma_f32_16x16x32_bf16 v[228:231], v[140:143], v[40:43], v[228:231]
  v_add_f32 v9, v9, v29
  v_cvt_pk_bf16_f32 v38, v28, v29
  v_add_f32 v9, v9, v30
  buffer_load_dwordx4 v[244:247], v2, s[36:39], s26 offen offset:0 sc1
  s_add_u32 s25, s25, 5120
  s_cmp_eq_u32 s25, s11
  s_cselect_b32 s25, s12, s25
  s_add_u32 s26, s25, 4096
  v_mfma_f32_16x16x32_bf16 v[236:239], v[140:143], v[44:47], v[236:239]
  v_add_f32 v9, v9, v31
  v_cvt_pk_bf16_f32 v39, v30, v31
  v_max_f32 v12, v8, v9
  v_cmp_lt_f32 vcc, s64, v12
  s_nop 0
  s_cbranch_vccnz K2_SLOWE
K2_RETT:
  v_mov_b32 v10, v8
  v_mov_b32 v11, v9
  v_mov_b32 v12, v10
  v_mov_b32 v13, v11
  s_nop 0
  v_permlane16_swap_b32 v10, v12
  v_permlane16_swap_b32 v11, v13
  v_add_f32 v10, v10, v12
  v_add_f32 v11, v11, v13
  v_mov_b32 v12, v10
  v_mov_b32 v13, v11
  s_nop 0
  v_permlane32_swap_b32 v10, v12
  v_permlane32_swap_b32 v11, v13
  v_add_f32 v10, v10, v12
  v_add_f32 v11, v11, v13
  s_waitcnt lgkmcnt(7)
  v_mfma_f32_16x16x32_bf16 v[176:179], v[144:147], v[32:35], v[176:179]
  v_mfma_f32_16x16x32_bf16 v[184:187], v[144:147], v[36:39], v[184:187]
  s_waitcnt lgkmcnt(6)
  v_mfma_f32_16x16x32_bf16 v[180:183], v[148:151], v[32:35], v[180:183]
  v_mfma_f32_16x16x32_bf16 v[188:191], v[148:151], v[36:39], v[188:191]
  s_waitcnt lgkmcnt(5)
  v_mfma_f32_16x16x32_bf16 v[192:195], v[152:155], v[32:35], v[192:195]
  v_mfma_f32_16x16x32_bf16 v[200:203], v[152:155], v[36:39], v[200:203]
  s_waitcnt lgkmcnt(4)
  v_mfma_f32_16x16x32_bf16 v[196:199], v[156:159], v[32:35], v[196:199]
  v_mfma_f32_16x16x32_bf16 v[204:207], v[156:159], v[36:39], v[204:207]
  s_waitcnt lgkmcnt(3)
  v_mfma_f32_16x16x32_bf16 v[208:211], v[160:163], v[32:35], v[208:211]
  v_mfma_f32_16x16x32_bf16 v[216:219], v[160:163], v[36:39], v[216:219]
  s_waitcnt lgkmcnt(2)
  v_mfma_f32_16x16x32_bf16 v[212:215], v[164:167], v[32:35], v[212:215]
  v_mfma_f32_16x16x32_bf16 v[220:223], v[164:167], v[36:39], v[220:223]
  s_waitcnt lgkmcnt(1)
  v_mfma_f32_16x16x32_bf16 v[224:227], v[168:171], v[32:35], v[224:227]
  v_mfma_f32_16x16x32_bf16 v[232:235], v[168:171], v[36:39], v[232:235]
  s_waitcnt lgkmcnt(0)
  v_mfma_f32_16x16x32_bf16 v[228:231], v[172:175], v[32:35], v[228:231]
  v_mfma_f32_16x16x32_bf16 v[236:239], v[172:175], v[36:39], v[236:239]
  s_waitcnt vmcnt(10)
  v_cmp_gt_u32 vcc, s48, v253
  s_nop 0
  s_or_b64 vcc, vcc, s[18:19]
  s_cselect_b32 s49, 1, 0
  s_cbranch_scc1 K2_NOC
  buffer_load_dwordx4 v[64:67], v2, s[36:39], s24 offen offset:0 sc1
  buffer_load_dwordx4 v[68:71], v2, s[36:39], s24 offen offset:1024 sc1
  buffer_load_dwordx4 v[72:75], v2, s[36:39], s24 offen offset:2048 sc1
  buffer_load_dwordx4 v[76:79], v2, s[36:39], s24 offen offset:3072 sc1
  s_add_u32 s24, s24, 4096
  s_cmp_eq_u32 s24, s9
  s_cselect_b32 s24, s10, s24
  buffer_load_dwordx4 v[32:35], v2, s[36:39], s27 offen offset:0 sc1
  buffer_load_dwordx4 v[36:39], v2, s[36:39], s27 offen offset:1024 sc1
  buffer_load_dwordx4 v[40:43], v2, s[36:39], s27 offen offset:2048 sc1
  buffer_load_dwordx4 v[44:47], v2, s[36:39], s27 offen offset:3072 sc1
  s_add_u32 s27, s24, s8
  buffer_load_dwordx4 v[52:55], v2, s[36:39], s24 offen offset:0 sc1
  buffer_load_dwordx4 v[56:59], v2, s[36:39], s24 offen offset:1024 sc1
  buffer_load_dwordx4 v[60:63], v2, s[36:39], s24 offen offset:2048 sc1
K2_NOC:
  v_mov_b32 v8, v16
  v_mov_b32 v9, v20
  s_lshl_b32 s80, s3, 10
  s_add_u32 s80, s80, 131072
  v_add_u32 v5, s80, v2
  s_lshl_b32 s80, s3, 13
  v_add_u32 v4, s80, v2
  ds_write_b128 v5, v[8:11]
  s_lshl_b32 s80, s6, 13
  s_add_u32 s70, s70, s80
  s_add_u32 s69, s70, 4096
  s_cmp_eq_u32 s6, 0
  s_cbranch_scc0 K2_FIN1
  ds_write_b128 v4, v[208:211] offset:0
  ds_write_b128 v4, v[212:215] offset:1024
  ds_write_b128 v4, v[216:219] offset:2048
  ds_write_b128 v4, v[220:223] offset:3072
  ds_write_b128 v4, v[224:227] offset:4096
  ds_write_b128 v4, v[228:231] offset:5120
  ds_write_b128 v4, v[232:235] offset:6144
  ds_write_b128 v4, v[236:239] offset:7168
  v_xor_b32 v5, 4096, v5
  v_xor_b32 v4, 32768, v4
  s_waitcnt lgkmcnt(0)
  s_barrier
  ds_read_b128 v[24:27], v5
  ds_read_b128 v[112:115], v4 offset:0
  ds_read_b128 v[116:119], v4 offset:1024
  ds_read_b128 v[120:123], v4 offset:2048
  ds_read_b128 v[124:127], v4 offset:3072
  ds_read_b128 v[128:131], v4 offset:4096
  ds_read_b128 v[132:135], v4 offset:5120
  ds_read_b128 v[136:139], v4 offset:6144
  ds_read_b128 v[140:143], v4 offset:7168
  s_waitcnt lgkmcnt(8)
  v_min_f32 v12, v8, v24
  v_sub_f32 v48, v12, v8
  v_sub_f32 v50, v12, v24
  v_exp_f32 v48, v48
  v_exp_f32 v50, v50
  v_mul_f32 v12, v48, v10
  v_fmac_f32 v12, v50, v26
  v_rcp_f32 v12, v12
  s_nop 0
  v_mul_f32 v48, v48, v12
  v_mul_f32 v50, v50, v12
  v_min_f32 v13, v9, v25
  v_sub_f32 v49, v13, v9
  v_sub_f32 v51, v13, v25
  v_exp_f32 v49, v49
  v_exp_f32 v51, v51
  v_mul_f32 v13, v49, v11
  v_fmac_f32 v13, v51, v27
  v_rcp_f32 v13, v13
  s_nop 0
  v_mul_f32 v49, v49, v13
  v_mul_f32 v51, v51, v13
  v_mul_f32 v176, v176, v48
  v_mul_f32 v177, v177, v48
  v_mul_f32 v178, v178, v48
  v_mul_f32 v179, v179, v48
  v_mul_f32 v180, v180, v48
  v_mul_f32 v181, v181, v48
  v_mul_f32 v182, v182, v48
  v_mul_f32 v183, v183, v48
  s_waitcnt lgkmcnt(7)
  v_fmac_f32 v176, v112, v50
  v_fmac_f32 v177, v113, v50
  v_fmac_f32 v178, v114, v50
  v_fmac_f32 v179, v115, v50
  s_waitcnt lgkmcnt(6)
  v_fmac_f32 v180, v116, v50
  v_fmac_f32 v181, v117, v50
  v_fmac_f32 v182, v118, v50
  v_fmac_f32 v183, v119, v50
  v_cvt_pk_bf16_f32 v144, v176, v177
  v_cvt_pk_bf16_f32 v145, v178, v179
  v_cvt_pk_bf16_f32 v146, v180, v181
  v_cvt_pk_bf16_f32 v147, v182, v183
  buffer_store_dwordx4 v[144:147], v2, s[36:39], s70 offen offset:0 sc1
  v_mul_f32 v184, v184, v49
  v_mul_f32 v185, v185, v49
  v_mul_f32 v186, v186, v49
  v_mul_f32 v187, v187, v49
  v_mul_f32 v188, v188, v49
  v_mul_f32 v189, v189, v49
  v_mul_f32 v190, v190, v49
  v_mul_f32 v191, v191, v49
  s_waitcnt lgkmcnt(5)
  v_fmac_f32 v184, v120, v51
  v_fmac_f32 v185, v121, v51
  v_fmac_f32 v186, v122, v51
  v_fmac_f32 v187, v123, v51
  s_waitcnt lgkmcnt(4)
  v_fmac_f32 v188, v124, v51
  v_fmac_f32 v189, v125, v51
  v_fmac_f32 v190, v126, v51
  v_fmac_f32 v191, v127, v51
  v_cvt_pk_bf16_f32 v148, v184, v185
  v_cvt_pk_bf16_f32 v149, v186, v187
  v_cvt_pk_bf16_f32 v150, v188, v189
  v_cvt_pk_bf16_f32 v151, v190, v191
  buffer_store_dwordx4 v[148:151], v2, s[36:39], s70 offen offset:1024 sc1
  v_mul_f32 v192, v192, v48
  v_mul_f32 v193, v193, v48
  v_mul_f32 v194, v194, v48
  v_mul_f32 v195, v195, v48
  v_mul_f32 v196, v196, v48
  v_mul_f32 v197, v197, v48
  v_mul_f32 v198, v198, v48
  v_mul_f32 v199, v199, v48
  s_waitcnt lgkmcnt(3)
  v_fmac_f32 v192, v128, v50
  v_fmac_f32 v193, v129, v50
  v_fmac_f32 v194, v130, v50
  v_fmac_f32 v195, v131, v50
  s_waitcnt lgkmcnt(2)
  v_fmac_f32 v196, v132, v50
  v_fmac_f32 v197, v133, v50
  v_fmac_f32 v198, v134, v50
  v_fmac_f32 v199, v135, v50
  v_cvt_pk_bf16_f32 v152, v192, v193
  v_cvt_pk_bf16_f32 v153, v194, v195
  v_cvt_pk_bf16_f32 v154, v196, v197
  v_cvt_pk_bf16_f32 v155, v198, v199
  buffer_store_dwordx4 v[152:155], v2, s[36:39], s69 offen offset:0 sc1
  v_mul_f32 v200, v200, v49
  v_mul_f32 v201, v201, v49
  v_mul_f32 v202, v202, v49
  v_mul_f32 v203, v203, v49
  v_mul_f32 v204, v204, v49
  v_mul_f32 v205, v205, v49
  v_mul_f32 v206, v206, v49
  v_mul_f32 v207, v207, v49
  s_waitcnt lgkmcnt(1)
  v_fmac_f32 v200, v136, v51
  v_fmac_f32 v201, v137, v51
  v_fmac_f32 v202, v138, v51
  v_fmac_f32 v203, v139, v51
  s_waitcnt lgkmcnt(0)
  v_fmac_f32 v204, v140, v51
  v_fmac_f32 v205, v141, v51
  v_fmac_f32 v206, v142, v51
  v_fmac_f32 v207, v143, v51
  v_cvt_pk_bf16_f32 v156, v200, v201
  v_cvt_pk_bf16_f32 v157, v202, v203
  v_cvt_pk_bf16_f32 v158, v204, v205
  v_cvt_pk_bf16_f32 v159, v206, v207
  buffer_store_dwordx4 v[156:159], v2, s[36:39], s69 offen offset:1024 sc1
  s_branch K2_FIN
K2_FIN1:
  ds_write_b128 v4, v[176:179] offset:0
  ds_write_b128 v4, v[180:183] offset:1024
  ds_write_b128 v4, v[184:187] offset:2048
  ds_write_b128 v4, v[188:191] offset:3072
  ds_write_b128 v4, v[192:195] offset:4096
  ds_write_b128 v4, v[196:199] offset:5120
  ds_write_b128 v4, v[200:203] offset:6144
  ds_write_b128 v4, v[204:207] offset:7168
  v_xor_b32 v5, 4096, v5
  v_xor_b32 v4, 32768, v4
  s_waitcnt lgkmcnt(0)
  s_barrier
  ds_read_b128 v[24:27], v5
  ds_read_b128 v[112:115], v4 offset:0
  ds_read_b128 v[116:119], v4 offset:1024
  ds_read_b128 v[120:123], v4 offset:2048
  ds_read_b128 v[124:127], v4 offset:3072
  ds_read_b128 v[128:131], v4 offset:4096
  ds_read_b128 v[132:135], v4 offset:5120
  ds_read_b128 v[136:139], v4 offset:6144
  ds_read_b128 v[140:143], v4 offset:7168
  s_waitcnt lgkmcnt(8)
  v_min_f32 v12, v8, v24
  v_sub_f32 v48, v12, v8
  v_sub_f32 v50, v12, v24
  v_exp_f32 v48, v48
  v_exp_f32 v50, v50
  v_mul_f32 v12, v48, v10
  v_fmac_f32 v12, v50, v26
  v_rcp_f32 v12, v12
  s_nop 0
  v_mul_f32 v48, v48, v12
  v_mul_f32 v50, v50, v12
  v_min_f32 v13, v9, v25
  v_sub_f32 v49, v13, v9
  v_sub_f32 v51, v13, v25
  v_exp_f32 v49, v49
  v_exp_f32 v51, v51
  v_mul_f32 v13, v49, v11
  v_fmac_f32 v13, v51, v27
  v_rcp_f32 v13, v13
  s_nop 0
  v_mul_f32 v49, v49, v13
  v_mul_f32 v51, v51, v13
  v_mul_f32 v208, v208, v48
  v_mul_f32 v209, v209, v48
  v_mul_f32 v210, v210, v48
  v_mul_f32 v211, v211, v48
  v_mul_f32 v212, v212, v48
  v_mul_f32 v213, v213, v48
  v_mul_f32 v214, v214, v48
  v_mul_f32 v215, v215, v48
  s_waitcnt lgkmcnt(7)
  v_fmac_f32 v208, v112, v50
  v_fmac_f32 v209, v113, v50
  v_fmac_f32 v210, v114, v50
  v_fmac_f32 v211, v115, v50
  s_waitcnt lgkmcnt(6)
  v_fmac_f32 v212, v116, v50
  v_fmac_f32 v213, v117, v50
  v_fmac_f32 v214, v118, v50
  v_fmac_f32 v215, v119, v50
  v_cvt_pk_bf16_f32 v144, v208, v209
  v_cvt_pk_bf16_f32 v145, v210, v211
  v_cvt_pk_bf16_f32 v146, v212, v213
  v_cvt_pk_bf16_f32 v147, v214, v215
  buffer_store_dwordx4 v[144:147], v2, s[36:39], s70 offen offset:0 sc1
  v_mul_f32 v216, v216, v49
  v_mul_f32 v217, v217, v49
  v_mul_f32 v218, v218, v49
  v_mul_f32 v219, v219, v49
  v_mul_f32 v220, v220, v49
  v_mul_f32 v221, v221, v49
  v_mul_f32 v222, v222, v49
  v_mul_f32 v223, v223, v49
  s_waitcnt lgkmcnt(5)
  v_fmac_f32 v216, v120, v51
  v_fmac_f32 v217, v121, v51
  v_fmac_f32 v218, v122, v51
  v_fmac_f32 v219, v123, v51
  s_waitcnt lgkmcnt(4)
  v_fmac_f32 v220, v124, v51
  v_fmac_f32 v221, v125, v51
  v_fmac_f32 v222, v126, v51
  v_fmac_f32 v223, v127, v51
  v_cvt_pk_bf16_f32 v148, v216, v217
  v_cvt_pk_bf16_f32 v149, v218, v219
  v_cvt_pk_bf16_f32 v150, v220, v221
  v_cvt_pk_bf16_f32 v151, v222, v223
  buffer_store_dwordx4 v[148:151], v2, s[36:39], s70 offen offset:1024 sc1
  v_mul_f32 v224, v224, v48
  v_mul_f32 v225, v225, v48
  v_mul_f32 v226, v226, v48
  v_mul_f32 v227, v227, v48
  v_mul_f32 v228, v228, v48
  v_mul_f32 v229, v229, v48
  v_mul_f32 v230, v230, v48
  v_mul_f32 v231, v231, v48
  s_waitcnt lgkmcnt(3)
  v_fmac_f32 v224, v128, v50
  v_fmac_f32 v225, v129, v50
  v_fmac_f32 v226, v130, v50
  v_fmac_f32 v227, v131, v50
  s_waitcnt lgkmcnt(2)
  v_fmac_f32 v228, v132, v50
  v_fmac_f32 v229, v133, v50
  v_fmac_f32 v230, v134, v50
  v_fmac_f32 v231, v135, v50
  v_cvt_pk_bf16_f32 v152, v224, v225
  v_cvt_pk_bf16_f32 v153, v226, v227
  v_cvt_pk_bf16_f32 v154, v228, v229
  v_cvt_pk_bf16_f32 v155, v230, v231
  buffer_store_dwordx4 v[152:155], v2, s[36:39], s69 offen offset:0 sc1
  v_mul_f32 v232, v232, v49
  v_mul_f32 v233, v233, v49
  v_mul_f32 v234, v234, v49
  v_mul_f32 v235, v235, v49
  v_mul_f32 v236, v236, v49
  v_mul_f32 v237, v237, v49
  v_mul_f32 v238, v238, v49
  v_mul_f32 v239, v239, v49
  s_waitcnt lgkmcnt(1)
  v_fmac_f32 v232, v136, v51
  v_fmac_f32 v233, v137, v51
  v_fmac_f32 v234, v138, v51
  v_fmac_f32 v235, v139, v51
  s_waitcnt lgkmcnt(0)
  v_fmac_f32 v236, v140, v51
  v_fmac_f32 v237, v141, v51
  v_fmac_f32 v238, v142, v51
  v_fmac_f32 v239, v143, v51
  v_cvt_pk_bf16_f32 v156, v232, v233
  v_cvt_pk_bf16_f32 v157, v234, v235
  v_cvt_pk_bf16_f32 v158, v236, v237
  v_cvt_pk_bf16_f32 v159, v238, v239
  buffer_store_dwordx4 v[156:159], v2, s[36:39], s69 offen offset:1024 sc1
  s_branch K2_FIN
K2_QSW:
  s_lshl_b32 s80, s7, 13
  s_add_u32 s80, s80, 131072
  v_add_u32 v12, s80, v2
  ds_read_b128 v[80:83], v12 offset:0
  ds_read_b128 v[84:87], v12 offset:1024
  ds_read_b128 v[88:91], v12 offset:2048
  ds_read_b128 v[92:95], v12 offset:3072
  ds_read_b128 v[96:99], v12 offset:4096
  ds_read_b128 v[100:103], v12 offset:5120
  ds_read_b128 v[104:107], v12 offset:6144
  ds_read_b128 v[108:111], v12 offset:7168
  s_mov_b32 s64, -1.0
  s_waitcnt lgkmcnt(15)
  v_mov_b32 v16, v248
  v_mov_b32 v17, v248
  v_mov_b32 v18, v248
  v_mov_b32 v19, v248
  v_mov_b32 v20, v249
  v_mov_b32 v21, v249
  v_mov_b32 v22, v249
  v_mov_b32 v23, v249
  s_add_u32 s57, s57, 256
  s_branch K2_QRET
K2_TL:
  s_sub_u32 s57, s57, 256
  v_mov_b32 v250, v10
  v_mov_b32 v10, 0
  v_mov_b32 v251, v11
  v_mov_b32 v11, 0
  s_cmp_ge_i32 s57, 0
  s_cbranch_scc0 K2_MA_RET
K2_MASKA:
  s_cmp_ge_i32 s57, 128
  s_cbranch_scc1 K2_TL
K2_MASKA1:
  s_cmp_eq_i32 s57, 0
  s_cbranch_scc1 K2_MASKA1_DG
  v_mov_b32 v48, s71
  v_mov_b32 v49, s71
  v_mov_b32 v50, s71
  v_mov_b32 v51, s71
  v_mov_b32 v52, s71
  v_mov_b32 v53, s71
  v_mov_b32 v54, s71
  v_mov_b32 v55, s71
  v_mov_b32 v56, s71
  v_mov_b32 v57, s71
  v_mov_b32 v58, s71
  v_mov_b32 v59, s71
  v_mov_b32 v60, s71
  v_mov_b32 v61, s71
  v_mov_b32 v62, s71
  v_mov_b32 v63, s71
  s_branch K2_MA_RET
K2_MASKA1_DG:
  v_mov_b32 v12, s71
  v_cndmask_b32 v48, v48, v12, s[72:73]
  v_cndmask_b32 v49, v49, v12, s[74:75]
  v_cndmask_b32 v50, v50, v12, s[76:77]
  v_cndmask_b32 v51, v51, v12, s[78:79]
  v_mov_b32 v56, s71
  v_mov_b32 v57, s71
  v_mov_b32 v58, s71
  v_mov_b32 v59, s71
  v_cndmask_b32 v60, v60, v12, s[72:73]
  v_cndmask_b32 v61, v61, v12, s[74:75]
  v_cndmask_b32 v62, v62, v12, s[76:77]
  v_cndmask_b32 v63, v63, v12, s[78:79]
  s_branch K2_MA_RET
K2_MA_RET:
  s_waitcnt lgkmcnt(0)
  s_cmp_ge_i32 s52, 0
  s_cbranch_scc1 K2_RETMA
  s_mov_b32 s52, 0
  s_branch K2_PFORCED
K2_MASKB:
  s_cmp_eq_i32 s57, -1
  s_cbranch_scc1 K2_MASKB_DG
  v_mov_b32 v64, s71
  v_mov_b32 v65, s71
  v_mov_b32 v66, s71
  v_mov_b32 v67, s71
  v_mov_b32 v68, s71
  v_mov_b32 v69, s71
  v_mov_b32 v70, s71
  v_mov_b32 v71, s71
  v_mov_b32 v72, s71
  v_mov_b32 v73, s71
  v_mov_b32 v74, s71
  v_mov_b32 v75, s71
  v_mov_b32 v76, s71
  v_mov_b32 v77, s71
  v_mov_b32 v78, s71
  v_mov_b32 v79, s71
  s_branch K2_RETMB
K2_MASKB_DG:
  v_mov_b32 v12, s71
  v_cndmask_b32 v64, v64, v12, s[72:73]
  v_cndmask_b32 v65, v65, v12, s[74:75]
  v_cndmask_b32 v66, v66, v12, s[76:77]
  v_cndmask_b32 v67, v67, v12, s[78:79]
  v_mov_b32 v72, s71
  v_mov_b32 v73, s71
  v_mov_b32 v74, s71
  v_mov_b32 v75, s71
  v_cndmask_b32 v76, v76, v12, s[72:73]
  v_cndmask_b32 v77, v77, v12, s[74:75]
  v_cndmask_b32 v78, v78, v12, s[76:77]
  v_cndmask_b32 v79, v79, v12, s[78:79]
  s_branch K2_RETMB
K2_SLOWM:
  v_max3_f32 v12, v64, v65, v66
  v_max3_f32 v12, v12, v67, v72
  v_max3_f32 v12, v12, v73, v74
  v_max3_f32 v12, v12, v75, s65
  v_max3_f32 v13, v68, v69, v70
  v_max3_f32 v13, v13, v71, v76
  v_max3_f32 v13, v13, v77, v78
  v_max3_f32 v13, v13, v79, s65
  v_mov_b32 v14, v12
  v_mov_b32 v15, v13
  s_nop 0
  v_permlane16_swap_b32 v12, v14
  v_permlane16_swap_b32 v13, v15
  v_max_f32 v12, v12, v14
  v_max_f32 v13, v13, v15
  v_mov_b32 v14, v12
  v_mov_b32 v15, v13
  s_nop 0
  v_permlane32_swap_b32 v12, v14
  v_permlane32_swap_b32 v13, v15
  v_max_f32 v12, v12, v14
  v_max_f32 v13, v13, v15
  v_sub_f32 v16, v16, v12
  v_sub_f32 v17, v17, v12
  v_sub_f32 v18, v18, v12
  v_sub_f32 v19, v19, v12
  v_sub_f32 v64, v64, v12
  v_sub_f32 v65, v65, v12
  v_sub_f32 v66, v66, v12
  v_sub_f32 v67, v67, v12
  v_sub_f32 v72, v72, v12
  v_sub_f32 v73, v73, v12
  v_sub_f32 v74, v74, v12
  v_sub_f32 v75, v75, v12
  v_sub_f32 v48, v48, v12
  v_sub_f32 v49, v49, v12
  v_sub_f32 v50, v50, v12
  v_sub_f32 v51, v51, v12
  v_sub_f32 v56, v56, v12
  v_sub_f32 v57, v57, v12
  v_sub_f32 v58, v58, v12
  v_sub_f32 v59, v59, v12
  v_sub_f32 v20, v20, v13
  v_sub_f32 v21, v21, v13
  v_sub_f32 v22, v22, v13
  v_sub_f32 v23, v23, v13
  v_sub_f32 v68, v68, v13
  v_sub_f32 v69, v69, v13
  v_sub_f32 v70, v70, v13
  v_sub_f32 v71, v71, v13
  v_sub_f32 v76, v76, v13
  v_sub_f32 v77, v77, v13
  v_sub_f32 v78, v78, v13
  v_sub_f32 v79, v79, v13
  v_sub_f32 v52, v52, v13
  v_sub_f32 v53, v53, v13
  v_sub_f32 v54, v54, v13
  v_sub_f32 v55, v55, v13
  v_sub_f32 v60, v60, v13
  v_sub_f32 v61, v61, v13
  v_sub_f32 v62, v62, v13
  v_sub_f32 v63, v63, v13
  s_cmp_lg_u32 s65, 0
  s_cbranch_scc1 K2_SLOWM_NR
  v_exp_f32 v14, -v12
  v_exp_f32 v15, -v13
  v_mul_f32 v8, v8, v14
  v_mul_f32 v176, v176, v14
  v_mul_f32 v177, v177, v14
  v_mul_f32 v178, v178, v14
  v_mul_f32 v179, v179, v14
  v_mul_f32 v180, v180, v14
  v_mul_f32 v181, v181, v14
  v_mul_f32 v182, v182, v14
  v_mul_f32 v183, v183, v14
  v_mul_f32 v192, v192, v14
  v_mul_f32 v193, v193, v14
  v_mul_f32 v194, v194, v14
  v_mul_f32 v195, v195, v14
  v_mul_f32 v196, v196, v14
  v_mul_f32 v197, v197, v14
  v_mul_f32 v198, v198, v14
  v_mul_f32 v199, v199, v14
  v_mul_f32 v208, v208, v14
  v_mul_f32 v209, v209, v14
  v_mul_f32 v210, v210, v14
  v_mul_f32 v211, v211, v14
  v_mul_f32 v212, v212, v14
  v_mul_f32 v213, v213, v14
  v_mul_f32 v214, v214, v14
  v_mul_f32 v215, v215, v14
  v_mul_f32 v224, v224, v14
  v_mul_f32 v225, v225, v14
  v_mul_f32 v226, v226, v14
  v_mul_f32 v227, v227, v14
  v_mul_f32 v228, v228, v14
  v_mul_f32 v229, v229, v14
  v_mul_f32 v230, v230, v14
  v_mul_f32 v231, v231, v14
  v_mul_f32 v9, v9, v15
  v_mul_f32 v184, v184, v15
  v_mul_f32 v185, v185, v15
  v_mul_f32 v186, v186, v15
  v_mul_f32 v187, v187, v15
  v_mul_f32 v188, v188, v15
  v_mul_f32 v189, v189, v15
  v_mul_f32 v190, v190, v15
  v_mul_f32 v191, v191, v15
  v_mul_f32 v200, v200, v15
  v_mul_f32 v201, v201, v15
  v_mul_f32 v202, v202, v15
  v_mul_f32 v203, v203, v15
  v_mul_f32 v204, v204, v15
  v_mul_f32 v205, v205, v15
  v_mul_f32 v206, v206, v15
  v_mul_f32 v207, v207, v15
  v_mul_f32 v216, v216, v15
  v_mul_f32 v217, v217, v15
  v_mul_f32 v218, v218, v15
  v_mul_f32 v219, v219, v15
  v_mul_f32 v220, v220, v15
  v_mul_f32 v221, v221, v15
  v_mul_f32 v222, v222, v15
  v_mul_f32 v223, v223, v15
  v_mul_f32 v232, v232, v15
  v_mul_f32 v233, v233, v15
  v_mul_f32 v234, v234, v15
  v_mul_f32 v235, v235, v15
  v_mul_f32 v236, v236, v15
  v_mul_f32 v237, v237, v15
  v_mul_f32 v238, v238, v15
  v_mul_f32 v239, v239, v15
K2_SLOWM_NR:
  v_exp_f32 v24, v64
  v_exp_f32 v25, v65
  v_exp_f32 v26, v66
  v_exp_f32 v27, v67
  v_add_f32 v10, v8, v24
  v_exp_f32 v28, v68
  v_add_f32 v10, v10, v25
  v_cvt_pk_bf16_f32 v40, v24, v25
  v_exp_f32 v29, v69
  v_add_f32 v10, v10, v26
  v_exp_f32 v30, v70
  v_add_f32 v10, v10, v27
  v_cvt_pk_bf16_f32 v41, v26, v27
  v_exp_f32 v31, v71
  v_add_f32 v11, v9, v28
  v_exp_f32 v24, v72
  v_add_f32 v11, v11, v29
  v_cvt_pk_bf16_f32 v44, v28, v29
  v_exp_f32 v25, v73
  v_add_f32 v11, v11, v30
  v_exp_f32 v26, v74
  v_add_f32 v11, v11, v31
  v_cvt_pk_bf16_f32 v45, v30, v31
  v_exp_f32 v27, v75
  v_add_f32 v10, v10, v24
  v_exp_f32 v28, v76
  v_add_f32 v10, v10, v25
  v_cvt_pk_bf16_f32 v42, v24, v25
  v_exp_f32 v29, v77
  v_add_f32 v10, v10, v26
  v_exp_f32 v30, v78
  v_add_f32 v10, v10, v27
  v_cvt_pk_bf16_f32 v43, v26, v27
  v_exp_f32 v31, v79
  v_add_f32 v11, v11, v28
  v_add_f32 v11, v11, v29
  v_cvt_pk_bf16_f32 v46, v28, v29
  v_add_f32 v11, v11, v30
  v_add_f32 v11, v11, v31
  v_cvt_pk_bf16_f32 v47, v30, v31
  s_mov_b32 s65, 0
  s_cmp_eq_u32 s64, s63
  s_cselect_b32 s64, s64, -2.0
  s_cmp_ge_i32 s57, 0
  s_branch K2_RETM
K2_SLOWE:
  s_cmp_eq_u32 s64, s63
  s_cbranch_scc1 K2_FORCED
  v_mov_b32 v12, v250
  v_mov_b32 v13, v251
  s_nop 0
  v_permlane16_swap_b32 v250, v12
  v_permlane16_swap_b32 v251, v13
  v_add_f32 v250, v250, v12
  v_add_f32 v251, v251, v13
  v_mov_b32 v12, v250
  v_mov_b32 v13, v251
  s_nop 0
  v_permlane32_swap_b32 v250, v12
  v_permlane32_swap_b32 v251, v13
  v_add_f32 v250, v250, v12
  v_add_f32 v251, v251, v13
  v_rcp_f32 v12, v250
  v_rcp_f32 v14, v251
  v_mov_b32 v248, 0
  v_mov_b32 v249, 0
  v_mov_b32 v250, 0
  v_mov_b32 v251, 0
  v_mul_f32 v176, v176, v12
  v_mul_f32 v177, v177, v12
  v_mul_f32 v178, v178, v12
  v_mul_f32 v179, v179, v12
  v_mul_f32 v180, v180, v12
  v_mul_f32 v181, v181, v12
  v_mul_f32 v182, v182, v12
  v_mul_f32 v183, v183, v12
  v_cvt_pk_bf16_f32 v24, v176, v177
  v_cvt_pk_bf16_f32 v25, v178, v179
  v_cvt_pk_bf16_f32 v26, v180, v181
  v_cvt_pk_bf16_f32 v27, v182, v183
  buffer_store_dwordx4 v[24:27], v2, s[36:39], s69 offen offset:0 sc1
  v_mul_f32 v184, v184, v14
  v_mul_f32 v185, v185, v14
  v_mul_f32 v186, v186, v14
  v_mul_f32 v187, v187, v14
  v_mul_f32 v188, v188, v14
  v_mul_f32 v189, v189, v14
  v_mul_f32 v190, v190, v14
  v_mul_f32 v191, v191, v14
  v_cvt_pk_bf16_f32 v28, v184, v185
  v_cvt_pk_bf16_f32 v29, v186, v187
  v_cvt_pk_bf16_f32 v30, v188, v189
  v_cvt_pk_bf16_f32 v31, v190, v191
  buffer_store_dwordx4 v[28:31], v2, s[36:39], s69 offen offset:1024 sc1
  s_add_u32 s69, s69, 4096
  v_mfma_f32_32x32x16_bf16 v[176:191], v[248:251], v[248:251], 0
  v_mul_f32 v192, v192, v12
  v_mul_f32 v193, v193, v12
  v_mul_f32 v194, v194, v12
  v_mul_f32 v195, v195, v12
  v_mul_f32 v196, v196, v12
  v_mul_f32 v197, v197, v12
  v_mul_f32 v198, v198, v12
  v_mul_f32 v199, v199, v12
  v_cvt_pk_bf16_f32 v24, v192, v193
  v_cvt_pk_bf16_f32 v25, v194, v195
  v_cvt_pk_bf16_f32 v26, v196, v197
  v_cvt_pk_bf16_f32 v27, v198, v199
  buffer_store_dwordx4 v[24:27], v2, s[36:39], s69 offen offset:0 sc1
  v_mul_f32 v200, v200, v14
  v_mul_f32 v201, v201, v14
  v_mul_f32 v202, v202, v14
  v_mul_f32 v203, v203, v14
  v_mul_f32 v204, v204, v14
  v_mul_f32 v205, v205, v14
  v_mul_f32 v206, v206, v14
  v_mul_f32 v207, v207, v14
  v_cvt_pk_bf16_f32 v28, v200, v201
  v_cvt_pk_bf16_f32 v29, v202, v203
  v_cvt_pk_bf16_f32 v30, v204, v205
  v_cvt_pk_bf16_f32 v31, v206, v207
  buffer_store_dwordx4 v[28:31], v2, s[36:39], s69 offen offset:1024 sc1
  s_add_u32 s69, s69, 4096
  v_mfma_f32_32x32x16_bf16 v[192:207], v[248:251], v[248:251], 0
  v_mul_f32 v208, v208, v12
  v_mul_f32 v209, v209, v12
  v_mul_f32 v210, v210, v12
  v_mul_f32 v211, v211, v12
  v_mul_f32 v212, v212, v12
  v_mul_f32 v213, v213, v12
  v_mul_f32 v214, v214, v12
  v_mul_f32 v215, v215, v12
  v_cvt_pk_bf16_f32 v24, v208, v209
  v_cvt_pk_bf16_f32 v25, v210, v211
  v_cvt_pk_bf16_f32 v26, v212, v213
  v_cvt_pk_bf16_f32 v27, v214, v215
  buffer_store_dwordx4 v[24:27], v2, s[36:39], s69 offen offset:0 sc1
  v_mul_f32 v216, v216, v14
  v_mul_f32 v217, v217, v14
  v_mul_f32 v218, v218, v14
  v_mul_f32 v219, v219, v14
  v_mul_f32 v220, v220, v14
  v_mul_f32 v221, v221, v14
  v_mul_f32 v222, v222, v14
  v_mul_f32 v223, v223, v14
  v_cvt_pk_bf16_f32 v28, v216, v217
  v_cvt_pk_bf16_f32 v29, v218, v219
  v_cvt_pk_bf16_f32 v30, v220, v221
  v_cvt_pk_bf16_f32 v31, v222, v223
  buffer_store_dwordx4 v[28:31], v2, s[36:39], s69 offen offset:1024 sc1
  s_add_u32 s69, s69, 4096
  v_mfma_f32_32x32x16_bf16 v[208:223], v[248:251], v[248:251], 0
  v_mul_f32 v224, v224, v12
  v_mul_f32 v225, v225, v12
  v_mul_f32 v226, v226, v12
  v_mul_f32 v227, v227, v12
  v_mul_f32 v228, v228, v12
  v_mul_f32 v229, v229, v12
  v_mul_f32 v230, v230, v12
  v_mul_f32 v231, v231, v12
  v_cvt_pk_bf16_f32 v24, v224, v225
  v_cvt_pk_bf16_f32 v25, v226, v227
  v_cvt_pk_bf16_f32 v26, v228, v229
  v_cvt_pk_bf16_f32 v27, v230, v231
  buffer_store_dwordx4 v[24:27], v2, s[36:39], s69 offen offset:0 sc1
  v_mul_f32 v232, v232, v14
  v_mul_f32 v233, v233, v14
  v_mul_f32 v234, v234, v14
  v_mul_f32 v235, v235, v14
  v_mul_f32 v236, v236, v14
  v_mul_f32 v237, v237, v14
  v_mul_f32 v238, v238, v14
  v_mul_f32 v239, v239, v14
  v_cvt_pk_bf16_f32 v28, v232, v233
  v_cvt_pk_bf16_f32 v29, v234, v235
  v_cvt_pk_bf16_f32 v30, v236, v237
  v_cvt_pk_bf16_f32 v31, v238, v239
  buffer_store_dwordx4 v[28:31], v2, s[36:39], s69 offen offset:1024 sc1
  s_add_u32 s69, s69, 4096
  v_mfma_f32_32x32x16_bf16 v[224:239], v[248:251], v[248:251], 0
  v_max_f32 v12, v8, v9
  v_cmp_lt_f32 vcc, s63, v12
  s_cmp_eq_u32 s64, -2.0
  s_mov_b32 s64, s63
  s_cbranch_scc1 K2_FORC2
  s_cbranch_vccz K2_SERET
K2_FORC2:
  s_mov_b32 s64, s63
  s_mov_b32 s65, 0xff800000
K2_FORCED:
  v_max3_f32 v12, v48, v49, v50
  v_max3_f32 v12, v12, v51, v56
  v_max3_f32 v12, v12, v57, v58
  v_max3_f32 v12, v12, v59, s65
  v_max3_f32 v13, v52, v53, v54
  v_max3_f32 v13, v13, v55, v60
  v_max3_f32 v13, v13, v61, v62
  v_max3_f32 v13, v13, v63, s65
  v_mov_b32 v14, v12
  v_mov_b32 v15, v13
  s_nop 0
  v_permlane16_swap_b32 v12, v14
  v_permlane16_swap_b32 v13, v15
  v_max_f32 v12, v12, v14
  v_max_f32 v13, v13, v15
  v_mov_b32 v14, v12
  v_mov_b32 v15, v13
  s_nop 0
  v_permlane32_swap_b32 v12, v14
  v_permlane32_swap_b32 v13, v15
  v_max_f32 v12, v12, v14
  v_max_f32 v13, v13, v15
  v_sub_f32 v16, v16, v12
  v_sub_f32 v17, v17, v12
  v_sub_f32 v18, v18, v12
  v_sub_f32 v19, v19, v12
  v_sub_f32 v48, v48, v12
  v_sub_f32 v49, v49, v12
  v_sub_f32 v50, v50, v12
  v_sub_f32 v51, v51, v12
  v_sub_f32 v56, v56, v12
  v_sub_f32 v57, v57, v12
  v_sub_f32 v58, v58, v12
  v_sub_f32 v59, v59, v12
  v_sub_f32 v64, v64, v12
  v_sub_f32 v65, v65, v12
  v_sub_f32 v66, v66, v12
  v_sub_f32 v67, v67, v12
  v_sub_f32 v72, v72, v12
  v_sub_f32 v73, v73, v12
  v_sub_f32 v74, v74, v12
  v_sub_f32 v75, v75, v12
  v_sub_f32 v20, v20, v13
  v_sub_f32 v21, v21, v13
  v_sub_f32 v22, v22, v13
  v_sub_f32 v23, v23, v13
  v_sub_f32 v52, v52, v13
  v_sub_f32 v53, v53, v13
  v_sub_f32 v54, v54, v13
  v_sub_f32 v55, v55, v13
  v_sub_f32 v60, v60, v13
  v_sub_f32 v61, v61, v13
  v_sub_f32 v62, v62, v13
  v_sub_f32 v63, v63, v13
  v_sub_f32 v68, v68, v13
  v_sub_f32 v69, v69, v13
  v_sub_f32 v70, v70, v13
  v_sub_f32 v71, v71, v13
  v_sub_f32 v76, v76, v13
  v_sub_f32 v77, v77, v13
  v_sub_f32 v78, v78, v13
  v_sub_f32 v79, v79, v13
  s_cmp_lg_u32 s65, 0
  s_cbranch_scc1 K2_SLOWE_NR
  v_exp_f32 v14, -v12
  v_exp_f32 v15, -v13
  v_mul_f32 v10, v10, v14
  v_mul_f32 v176, v176, v14
  v_mul_f32 v177, v177, v14
  v_mul_f32 v178, v178, v14
  v_mul_f32 v179, v179, v14
  v_mul_f32 v180, v180, v14
  v_mul_f32 v181, v181, v14
  v_mul_f32 v182, v182, v14
  v_mul_f32 v183, v183, v14
  v_mul_f32 v192, v192, v14
  v_mul_f32 v193, v193, v14
  v_mul_f32 v194, v194, v14
  v_mul_f32 v195, v195, v14
  v_mul_f32 v196, v196, v14
  v_mul_f32 v197, v197, v14
  v_mul_f32 v198, v198, v14
  v_mul_f32 v199, v199, v14
  v_mul_f32 v208, v208, v14
  v_mul_f32 v209, v209, v14
  v_mul_f32 v210, v210, v14
  v_mul_f32 v211, v211, v14
  v_mul_f32 v212, v212, v14
  v_mul_f32 v213, v213, v14
  v_mul_f32 v214, v214, v14
  v_mul_f32 v215, v215, v14
  v_mul_f32 v224, v224, v14
  v_mul_f32 v225, v225, v14
  v_mul_f32 v226, v226, v14
  v_mul_f32 v227, v227, v14
  v_mul_f32 v228, v228, v14
  v_mul_f32 v229, v229, v14
  v_mul_f32 v230, v230, v14
  v_mul_f32 v231, v231, v14
  v_mul_f32 v11, v11, v15
  v_mul_f32 v184, v184, v15
  v_mul_f32 v185, v185, v15
  v_mul_f32 v186, v186, v15
  v_mul_f32 v187, v187, v15
  v_mul_f32 v188, v188, v15
  v_mul_f32 v189, v189, v15
  v_mul_f32 v190, v190, v15
  v_mul_f32 v191, v191, v15
  v_mul_f32 v200, v200, v15
  v_mul_f32 v201, v201, v15
  v_mul_f32 v202, v202, v15
  v_mul_f32 v203, v203, v15
  v_mul_f32 v204, v204, v15
  v_mul_f32 v205, v205, v15
  v_mul_f32 v206, v206, v15
  v_mul_f32 v207, v207, v15
  v_mul_f32 v216, v216, v15
  v_mul_f32 v217, v217, v15
  v_mul_f32 v218, v218, v15
  v_mul_f32 v219, v219, v15
  v_mul_f32 v220, v220, v15
  v_mul_f32 v221, v221, v15
  v_mul_f32 v222, v222, v15
  v_mul_f32 v223, v223, v15
  v_mul_f32 v232, v232, v15
  v_mul_f32 v233, v233, v15
  v_mul_f32 v234, v234, v15
  v_mul_f32 v235, v235, v15
  v_mul_f32 v236, v236, v15
  v_mul_f32 v237, v237, v15
  v_mul_f32 v238, v238, v15
  v_mul_f32 v239, v239, v15
K2_SLOWE_NR:
  v_exp_f32 v24, v48
  v_exp_f32 v25, v49
  v_exp_f32 v26, v50
  v_exp_f32 v27, v51
  v_add_f32 v8, v10, v24
  v_exp_f32 v28, v52
  v_add_f32 v8, v8, v25
  v_cvt_pk_bf16_f32 v32, v24, v25
  v_exp_f32 v29, v53
  v_add_f32 v8, v8, v26
  v_exp_f32 v30, v54
  v_add_f32 v8, v8, v27
  v_cvt_pk_bf16_f32 v33, v26, v27
  v_exp_f32 v31, v55
  v_add_f32 v9, v11, v28
  v_exp_f32 v24, v56
  v_add_f32 v9, v9, v29
  v_cvt_pk_bf16_f32 v36, v28, v29
  v_exp_f32 v25, v57
  v_add_f32 v9, v9, v30
  v_exp_f32 v26, v58
  v_add_f32 v9, v9, v31
  v_cvt_pk_bf16_f32 v37, v30, v31
  v_exp_f32 v27, v59
  v_add_f32 v8, v8, v24
  v_exp_f32 v28, v60
  v_add_f32 v8, v8, v25
  v_cvt_pk_bf16_f32 v34, v24, v25
  v_exp_f32 v29, v61
  v_add_f32 v8, v8, v26
  v_exp_f32 v30, v62
  v_add_f32 v8, v8, v27
  v_cvt_pk_bf16_f32 v35, v26, v27
  v_exp_f32 v31, v63
  v_add_f32 v9, v9, v28
  v_add_f32 v9, v9, v29
  v_cvt_pk_bf16_f32 v38, v28, v29
  v_add_f32 v9, v9, v30
  v_add_f32 v9, v9, v31
  v_cvt_pk_bf16_f32 v39, v30, v31
  s_mov_b32 s65, 0
K2_SERET:
  s_cmp_eq_u32 s52, 16
  s_cbranch_scc1 K2_RETT
  s_branch K2_RETE
K2_TK2H:
  s_lshr_b32 s80, s54, 14
  s_sub_u32 s80, s80, s53
  s_cmp_gt_u32 s80, 2
  s_cbranch_scc1 K2_TK2G
  s_lshl_b32 s81, s54, 1
  s_sub_u32 s81, 0x80000, s81
  s_cmp_eq_u32 s80, 1
  s_cbranch_scc0 K2_TK2I
  s_add_u32 s40, s40, s81
  s_addc_u32 s41, s41, 0
  s_add_u32 s56, s54, 16384
  s_branch K2_TK2G
K2_TK2I:
  s_add_u32 s81, s81, 49152
  s_sub_u32 s40, s40, s81
  s_subb_u32 s41, s41, 0
  s_sub_u32 s56, 0x90000, s54
  s_branch K2_TK2G
K2_TK3H:
  s_lshr_b32 s80, s54, 14
  s_sub_u32 s80, s80, s53
  s_cmp_gt_u32 s80, 2
  s_cbranch_scc1 K2_TK3G
  s_lshl_b32 s81, s54, 1
  s_sub_u32 s81, 0x80000, s81
  s_cmp_eq_u32 s80, 1
  s_cbranch_scc0 K2_TK3I
  s_add_u32 s40, s40, s81
  s_addc_u32 s41, s41, 0
  s_add_u32 s56, s54, 16384
  s_branch K2_TK3G
K2_TK3I:
  s_add_u32 s81, s81, 49152
  s_sub_u32 s40, s40, s81
  s_subb_u32 s41, s41, 0
  s_sub_u32 s56, 0x90000, s54
  s_branch K2_TK3G
K2_TV2H:
  s_lshr_b32 s80, s55, 14
  s_sub_u32 s80, s80, s53
  s_cmp_gt_u32 s80, 2
  s_cbranch_scc1 K2_TV2G
  s_lshl_b32 s81, s55, 1
  s_sub_u32 s81, 0x80000, s81
  s_cmp_eq_u32 s80, 1
  s_cbranch_scc0 K2_TV2I
  s_add_u32 s44, s44, s81
  s_addc_u32 s45, s45, 0
  s_add_u32 s88, s55, 16384
  s_branch K2_TV2G
K2_TV2I:
  s_add_u32 s81, s81, 49152
  s_sub_u32 s44, s44, s81
  s_subb_u32 s45, s45, 0
  s_sub_u32 s88, 0x90000, s55
  s_branch K2_TV2G
K2_TK4H:
  s_lshr_b32 s80, s54, 14
  s_sub_u32 s80, s80, s53
  s_cmp_gt_u32 s80, 2
  s_cbranch_scc1 K2_TK4G
  s_lshl_b32 s81, s54, 1
  s_sub_u32 s81, 0x80000, s81
  s_cmp_eq_u32 s80, 1
  s_cbranch_scc0 K2_TK4I
  s_add_u32 s40, s40, s81
  s_addc_u32 s41, s41, 0
  s_add_u32 s56, s54, 16384
  s_branch K2_TK4G
K2_TK4I:
  s_add_u32 s81, s81, 49152
  s_sub_u32 s40, s40, s81
  s_subb_u32 s41, s41, 0
  s_sub_u32 s56, 0x90000, s54
  s_branch K2_TK4G
K2_D0H:
  s_lshr_b32 s80, s54, 14
  s_sub_u32 s80, s80, s53
  s_cmp_gt_u32 s80, 2
  s_cbranch_scc1 K2_D0_0
  s_lshl_b32 s81, s54, 1
  s_sub_u32 s81, 0x80000, s81
  s_cmp_eq_u32 s80, 1
  s_cbranch_scc0 K2_D0I
  s_add_u32 s40, s40, s81
  s_addc_u32 s41, s41, 0
  s_add_u32 s56, s54, 16384
  s_branch K2_D0G
K2_D0I:
  s_add_u32 s81, s81, 49152
  s_sub_u32 s40, s40, s81
  s_subb_u32 s41, s41, 0
  s_sub_u32 s56, 0x90000, s54
  s_branch K2_D0G
K2_D2H:
  s_lshr_b32 s80, s55, 14
  s_sub_u32 s80, s80, s53
  s_cmp_gt_u32 s80, 2
  s_cbranch_scc1 K2_D2_0
  s_lshl_b32 s81, s55, 1
  s_sub_u32 s81, 0x80000, s81
  s_cmp_eq_u32 s80, 1
  s_cbranch_scc0 K2_D2I
  s_add_u32 s44, s44, s81
  s_addc_u32 s45, s45, 0
  s_add_u32 s88, s55, 16384
  s_branch K2_D2G
K2_D2I:
  s_add_u32 s81, s81, 49152
  s_sub_u32 s44, s44, s81
  s_subb_u32 s45, s45, 0
  s_sub_u32 s88, 0x90000, s55
  s_branch K2_D2G
K2_PFOR:
  s_lshl_b32 s51, s16, 3
  s_lshl_b32 s51, 6, s51
  v_mov_b32 v10, s51
  s_and_b32 s51, s16, 0xfc
  s_mov_b64 exec, 1
  buffer_atomic_or v10, off, s[28:31], s51 sc1
  s_mov_b64 exec, -1
  s_bitcmp1_b32 s89, 17
  s_cbranch_scc1 K2_PCK
  s_branch K2_PW
K2_PSLOW:
  s_cmp_lt_u32 s89, 524288
  s_cselect_b32 s51, 0, 52
  s_branch K2_PPOLL
K2_PSPIN:
  s_cmp_ge_u32 s51, 60
  s_cbranch_scc1 K2_PDO
  s_sleep 4
  s_add_u32 s51, s51, 1
K2_PPOLL:
  buffer_load_ubyte v11, v25, s[28:31], 0 offen sc1
  s_waitcnt vmcnt(0)
  v_and_b32 v10, 4, v11
  v_and_b32 v11, 1, v11
  v_cmp_ne_u32 s[18:19], 1, v11
  buffer_load_dword v9, v8, s[36:39], 0 offen sc1
  s_waitcnt vmcnt(0)
  v_cmp_gt_u32 vcc, 2, v9
  s_nop 0
  s_or_b64 vcc, vcc, s[18:19]
  v_cmp_eq_u32 s[18:19], 0, v10
  s_nop 0
  s_and_b64 vcc, vcc, s[18:19]
  s_cbranch_scc1 K2_PSPIN
  s_branch K2_PW
K2_PDO:
  s_add_u32 s89, s89, 1048576
  s_cmp_ge_u32 s89, 4194304000
  s_cbranch_scc1 K2_PW
  s_ff1_i32_b64 s51, vcc
  v_readlane_b32 s51, v25, s51
  s_nop 0
  s_bfe_u32 s50, s51, 0x20004
  s_and_b32 s49, s51, 7
  s_lshl3_add_u32 s50, s50, s49
  s_bfe_u32 s49, s51, 0x20006
  s_lshl2_add_u32 s50, s50, s49
  s_bfe_u32 s49, s51, 0x10003
  s_lshl1_add_u32 s50, s50, s49
  s_branch K2_PW
K2_BAIL:
  s_waitcnt vmcnt(0) lgkmcnt(0)
  s_barrier
  s_and_b32 s2, s50, 255
  s_or_b32 s89, s89, 524288
  s_andn2_b32 s89, s89, 131072
  s_and_b32 s50, s50, 256
  s_lshl_b32 s50, s50, 9
  s_or_b32 s89, s89, s50
  s_add_u32 s89, s89, 1048576
  s_cmp_ge_u32 s89, 4194304000
  s_cbranch_scc1 K1_END
  s_and_b32 s50, s89, 262399
  s_or_b32 s51, s2, 262144
  s_cmp_eq_u32 s50, s51
  s_cbranch_scc1 K3_RE
  s_branch K1_AGAIN
K2_HOOK:
  s_cmp_eq_u32 s52, 13
  s_cbranch_scc0 K2_H0
  v_lshrrev_b32 v253, 2, v2
  buffer_load_dword v255, v253, s[28:31], 0 offen sc1
  s_cmp_lt_u32 s7, 2
  s_cselect_b32 s80, 3, -1
  s_mul_i32 s80, s80, s6
  s_add_u32 s59, s59, s80
K2_H0:
  s_cmp_lg_u32 s17, 0
  s_cbranch_scc0 K2_HRET
  s_cmp_eq_u32 s52, 2
  s_cbranch_scc0 K2_H2
  v_mov_b32 v6, 17
  s_mov_b64 exec, 1
  buffer_store_byte v6, off, s[28:31], s16 sc1
  s_mov_b64 exec, -1
K2_H2:
  s_sub_u32 s96, s52, 1
  s_cmp_eq_u32 s96, s53
  s_cbranch_scc0 K2_HRET
  v_mov_b32 v6, 4
  s_mov_b64 exec, 1
  buffer_store_dword v6, off, s[36:39], s17 sc1
  s_mov_b64 exec, -1
  s_branch K2_HRET
K2_SA:
  s_cmp_lt_u32 s89, 524288
  s_cselect_b32 s51, 120, 16
K2_SAL:
  v_lshrrev_b32 v253, 2, v2
  buffer_load_dword v255, v253, s[28:31], 0 offen sc1
  s_waitcnt vmcnt(0)
  v_and_b32 v253, 0x10101010, v255
  v_cmp_ne_u32 vcc, 0x10101010, v253
  s_nop 0
  s_cbranch_vccz K2_SAR
  v_lshl_or_b32 v255, v255, 1, v255
  v_and_b32 v253, 0x10101010, v255
  v_cmp_ne_u32 vcc, 0x10101010, v253
  s_nop 0
  s_cbranch_vccz K2_SAT
  s_sleep 4
  s_sub_u32 s51, s51, 1
  s_cbranch_scc0 K2_SAL
  v_xor_b32 v253, 0x10101010, v253
  v_ffbl_b32 v253, v253
  v_lshrrev_b32 v255, 2, v2
  v_bfe_u32 v253, v253, 3, 2
  v_or_b32 v253, v253, v255
  s_ff1_i32_b64 s51, vcc
  v_readlane_b32 s51, v253, s51
  s_nop 0
  s_bfe_u32 s50, s51, 0x20004
  s_and_b32 s18, s51, 7
  s_lshl3_add_u32 s50, s50, s18
  s_bfe_u32 s18, s51, 0x20006
  s_lshl2_add_u32 s50, s50, s18
  s_bfe_u32 s18, s51, 0x10003
  s_lshl1_add_u32 s50, s50, s18
  s_or_b32 s50, s50, 256
  s_mov_b64 s[18:19], 0
  s_branch K2_SAR
K2_SAT:
  s_and_b32 s50, s89, 255
  s_mov_b64 s[18:19], 0
  s_branch K2_SAR
K2_FIN:
  s_and_b32 s96, s89, 255
  s_cmp_eq_u32 s96, s2
  s_cbranch_scc0 K3_FOR
  s_or_b32 s89, s89, 262144
  s_cmp_lg_u32 s49, 0
  s_cbranch_scc1 K3_LATE
K3_GO:
  s_waitcnt vmcnt(10)
  v_mfma_f32_16x16x32_bf16 v[8:11], v[80:83], v[64:67], 0
  s_waitcnt vmcnt(12)
  v_mfma_f32_16x16x32_bf16 v[24:27], v[84:87], v[64:67], 0
  s_waitcnt vmcnt(11)
  v_mfma_f32_16x16x32_bf16 v[116:119], v[88:91], v[64:67], 0
  s_waitcnt vmcnt(10)
  v_mfma_f32_16x16x32_bf16 v[132:135], v[92:95], v[64:67], 0
  s_waitcnt vmcnt(9)
  v_mfma_f32_16x16x32_bf16 v[148:151], v[96:99], v[64:67], 0
  v_mfma_f32_16x16x32_bf16 v[12:15], v[80:83], v[68:71], 0
  buffer_load_dwordx4 v[64:67], v2, s[36:39], s24 offen offset:3072 sc1
  s_add_u32 s24, s24, 4096
  s_cmp_eq_u32 s24, s9
  s_cselect_b32 s24, s10, s24
  v_mfma_f32_16x16x32_bf16 v[28:31], v[84:87], v[68:71], 0
  v_mfma_f32_16x16x32_bf16 v[120:123], v[88:91], v[68:71], 0
  v_mfma_f32_16x16x32_bf16 v[136:139], v[92:95], v[68:71], 0
  v_mfma_f32_16x16x32_bf16 v[152:155], v[96:99], v[68:71], 0
  s_waitcnt vmcnt(9)
  v_mfma_f32_16x16x32_bf16 v[16:19], v[80:83], v[72:75], 0
  buffer_load_dwordx4 v[68:71], v2, s[36:39], s27 offen offset:0 sc1
  v_mfma_f32_16x16x32_bf16 v[48:51], v[84:87], v[72:75], 0
  v_mfma_f32_16x16x32_bf16 v[124:127], v[88:91], v[72:75], 0
  v_mfma_f32_16x16x32_bf16 v[140:143], v[92:95], v[72:75], 0
  v_mfma_f32_16x16x32_bf16 v[156:159], v[96:99], v[72:75], 0
  s_waitcnt vmcnt(9)
  v_mfma_f32_16x16x32_bf16 v[20:23], v[80:83], v[76:79], 0
  buffer_load_dwordx4 v[72:75], v2, s[36:39], s27 offen offset:1024 sc1
  v_mfma_f32_16x16x32_bf16 v[112:115], v[84:87], v[76:79], 0
  v_mfma_f32_16x16x32_bf16 v[128:131], v[88:91], v[76:79], 0
  v_mfma_f32_16x16x32_bf16 v[144:147], v[92:95], v[76:79], 0
  v_mfma_f32_16x16x32_bf16 v[160:163], v[96:99], v[76:79], 0
  s_cmp_lg_u32 s49, 0
  s_cbranch_scc1 K3_PUB
  s_waitcnt vmcnt(3)
  s_barrier
  s_cmp_lg_u32 s17, 0
  s_cbranch_scc0 K3_PUB
  v_mov_b32 v6, 5
  s_mov_b64 exec, 1
  buffer_store_dword v6, off, s[36:39], s17 sc1
  s_mov_b64 exec, -1
K3_PUB:
  s_waitcnt vmcnt(9)
  v_mfma_f32_16x16x32_bf16 v[164:167], v[80:83], v[32:35], 0
  buffer_load_dwordx4 v[76:79], v2, s[36:39], s27 offen offset:2048 sc1
  v_mfma_f32_16x16x32_bf16 v[180:183], v[84:87], v[32:35], 0
  v_mfma_f32_16x16x32_bf16 v[196:199], v[88:91], v[32:35], 0
  v_mfma_f32_16x16x32_bf16 v[212:215], v[92:95], v[32:35], 0
  v_mfma_f32_16x16x32_bf16 v[228:231], v[96:99], v[32:35], 0
  s_waitcnt vmcnt(9)
  v_mfma_f32_16x16x32_bf16 v[168:171], v[80:83], v[36:39], 0
  buffer_load_dwordx4 v[32:35], v2, s[36:39], s27 offen offset:3072 sc1
  s_add_u32 s27, s24, s8
  v_mfma_f32_16x16x32_bf16 v[184:187], v[84:87], v[36:39], 0
  v_mfma_f32_16x16x32_bf16 v[200:203], v[88:91], v[36:39], 0
  v_mfma_f32_16x16x32_bf16 v[216:219], v[92:95], v[36:39], 0
  v_mfma_f32_16x16x32_bf16 v[232:235], v[96:99], v[36:39], 0
  s_waitcnt vmcnt(9)
  v_mfma_f32_16x16x32_bf16 v[172:175], v[80:83], v[40:43], 0
  buffer_load_dwordx4 v[36:39], v2, s[36:39], s24 offen offset:0 sc1
  v_mfma_f32_16x16x32_bf16 v[188:191], v[84:87], v[40:43], 0
  v_mfma_f32_16x16x32_bf16 v[204:207], v[88:91], v[40:43], 0
  v_mfma_f32_16x16x32_bf16 v[220:223], v[92:95], v[40:43], 0
  v_mfma_f32_16x16x32_bf16 v[236:239], v[96:99], v[40:43], 0
  s_waitcnt vmcnt(9)
  v_mfma_f32_16x16x32_bf16 v[176:179], v[80:83], v[44:47], 0
  buffer_load_dwordx4 v[40:43], v2, s[36:39], s24 offen offset:1024 sc1
  v_mfma_f32_16x16x32_bf16 v[192:195], v[84:87], v[44:47], 0
  v_mfma_f32_16x16x32_bf16 v[208:211], v[88:91], v[44:47], 0
  v_mfma_f32_16x16x32_bf16 v[224:227], v[92:95], v[44:47], 0
  v_mfma_f32_16x16x32_bf16 v[248:251], v[96:99], v[44:47], 0
  s_waitcnt vmcnt(9)
  v_mfma_f32_16x16x32_bf16 v[8:11], v[100:103], v[52:55], v[8:11]
  buffer_load_dwordx4 v[44:47], v2, s[36:39], s24 offen offset:2048 sc1
  v_mfma_f32_16x16x32_bf16 v[24:27], v[104:107], v[52:55], v[24:27]
  buffer_load_dwordx4 v[80:83], v2, s[36:39], s25 offen offset:0 sc1
  v_mfma_f32_16x16x32_bf16 v[116:119], v[108:111], v[52:55], v[116:119]
  buffer_load_dwordx4 v[84:87], v2, s[36:39], s25 offen offset:1024 sc1
  s_waitcnt vmcnt(15)
  v_mfma_f32_16x16x32_bf16 v[132:135], v[240:243], v[52:55], v[132:135]
  buffer_load_dwordx4 v[88:91], v2, s[36:39], s25 offen offset:2048 sc1
  s_waitcnt vmcnt(15)
  v_mfma_f32_16x16x32_bf16 v[148:151], v[244:247], v[52:55], v[148:151]
  buffer_load_dwordx4 v[92:95], v2, s[36:39], s25 offen offset:3072 sc1
  s_waitcnt vmcnt(13)
  v_mfma_f32_16x16x32_bf16 v[12:15], v[100:103], v[56:59], v[12:15]
  buffer_load_dwordx4 v[52:55], v2, s[36:39], s24 offen offset:3072 sc1
  s_add_u32 s24, s24, 4096
  s_cmp_eq_u32 s24, s9
  s_cselect_b32 s24, s10, s24
  buffer_load_dwordx4 v[96:99], v2, s[36:39], s26 offen offset:0 sc1
  s_add_u32 s25, s25, 5120
  s_cmp_eq_u32 s25, s11
  s_cselect_b32 s25, s12, s25
  s_add_u32 s26, s25, 4096
  v_mfma_f32_16x16x32_bf16 v[28:31], v[104:107], v[56:59], v[28:31]
  v_mfma_f32_16x16x32_bf16 v[120:123], v[108:111], v[56:59], v[120:123]
  v_mfma_f32_16x16x32_bf16 v[136:139], v[240:243], v[56:59], v[136:139]
  v_mfma_f32_16x16x32_bf16 v[152:155], v[244:247], v[56:59], v[152:155]
  s_waitcnt vmcnt(14)
  v_mfma_f32_16x16x32_bf16 v[16:19], v[100:103], v[60:63], v[16:19]
  buffer_load_dwordx4 v[56:59], v2, s[36:39], s27 offen offset:0 sc1
  v_mfma_f32_16x16x32_bf16 v[48:51], v[104:107], v[60:63], v[48:51]
  v_mfma_f32_16x16x32_bf16 v[124:127], v[108:111], v[60:63], v[124:127]
  v_mfma_f32_16x16x32_bf16 v[140:143], v[240:243], v[60:63], v[140:143]
  v_mfma_f32_16x16x32_bf16 v[156:159], v[244:247], v[60:63], v[156:159]
  s_waitcnt vmcnt(14)
  v_mfma_f32_16x16x32_bf16 v[20:23], v[100:103], v[64:67], v[20:23]
  buffer_load_dwordx4 v[60:63], v2, s[36:39], s27 offen offset:1024 sc1
  v_mfma_f32_16x16x32_bf16 v[112:115], v[104:107], v[64:67], v[112:115]
  v_mfma_f32_16x16x32_bf16 v[128:131], v[108:111], v[64:67], v[128:131]
  v_mfma_f32_16x16x32_bf16 v[144:147], v[240:243], v[64:67], v[144:147]
  v_mfma_f32_16x16x32_bf16 v[160:163], v[244:247], v[64:67], v[160:163]
  s_waitcnt vmcnt(14)
  v_mfma_f32_16x16x32_bf16 v[164:167], v[100:103], v[68:71], v[164:167]
  buffer_load_dwordx4 v[64:67], v2, s[36:39], s27 offen offset:2048 sc1
  v_mfma_f32_16x16x32_bf16 v[180:183], v[104:107], v[68:71], v[180:183]
  v_mfma_f32_16x16x32_bf16 v[196:199], v[108:111], v[68:71], v[196:199]
  v_mfma_f32_16x16x32_bf16 v[212:215], v[240:243], v[68:71], v[212:215]
  v_mfma_f32_16x16x32_bf16 v[228:231], v[244:247], v[68:71], v[228:231]
  s_waitcnt vmcnt(14)
  v_mfma_f32_16x16x32_bf16 v[168:171], v[100:103], v[72:75], v[168:171]
  buffer_load_dwordx4 v[68:71], v2, s[36:39], s27 offen offset:3072 sc1
  s_add_u32 s27, s24, s8
  v_mfma_f32_16x16x32_bf16 v[184:187], v[104:107], v[72:75], v[184:187]
  v_mfma_f32_16x16x32_bf16 v[200:203], v[108:111], v[72:75], v[200:203]
  v_mfma_f32_16x16x32_bf16 v[216:219], v[240:243], v[72:75], v[216:219]
  v_mfma_f32_16x16x32_bf16 v[232:235], v[244:247], v[72:75], v[232:235]
  s_waitcnt vmcnt(14)
  v_mfma_f32_16x16x32_bf16 v[172:175], v[100:103], v[76:79], v[172:175]
  buffer_load_dwordx4 v[72:75], v2, s[36:39], s24 offen offset:0 sc1
  v_mfma_f32_16x16x32_bf16 v[188:191], v[104:107], v[76:79], v[188:191]
  v_mfma_f32_16x16x32_bf16 v[204:207], v[108:111], v[76:79], v[204:207]
  v_mfma_f32_16x16x32_bf16 v[220:223], v[240:243], v[76:79], v[220:223]
  v_mfma_f32_16x16x32_bf16 v[236:239], v[244:247], v[76:79], v[236:239]
  s_waitcnt vmcnt(14)
  v_mfma_f32_16x16x32_bf16 v[176:179], v[100:103], v[32:35], v[176:179]
  buffer_load_dwordx4 v[76:79], v2, s[36:39], s24 offen offset:1024 sc1
  v_mfma_f32_16x16x32_bf16 v[192:195], v[104:107], v[32:35], v[192:195]
  v_mfma_f32_16x16x32_bf16 v[208:211], v[108:111], v[32:35], v[208:211]
  v_mfma_f32_16x16x32_bf16 v[224:227], v[240:243], v[32:35], v[224:227]
  v_mfma_f32_16x16x32_bf16 v[248:251], v[244:247], v[32:35], v[248:251]
  s_waitcnt vmcnt(11)
  v_mfma_f32_16x16x32_bf16 v[8:11], v[80:83], v[36:39], v[8:11]
  buffer_load_dwordx4 v[32:35], v2, s[36:39], s24 offen offset:2048 sc1
  s_waitcnt vmcnt(11)
  v_mfma_f32_16x16x32_bf16 v[24:27], v[84:87], v[36:39], v[24:27]
  buffer_load_dwordx4 v[100:103], v2, s[36:39], s25 offen offset:0 sc1
  s_waitcnt vmcnt(11)
  v_mfma_f32_16x16x32_bf16 v[116:119], v[88:91], v[36:39], v[116:119]
  buffer_load_dwordx4 v[104:107], v2, s[36:39], s25 offen offset:1024 sc1
  s_waitcnt vmcnt(11)
  v_mfma_f32_16x16x32_bf16 v[132:135], v[92:95], v[36:39], v[132:135]
  buffer_load_dwordx4 v[108:111], v2, s[36:39], s25 offen offset:2048 sc1
  s_waitcnt vmcnt(10)
  v_mfma_f32_16x16x32_bf16 v[148:151], v[96:99], v[36:39], v[148:151]
  buffer_load_dwordx4 v[240:243], v2, s[36:39], s25 offen offset:3072 sc1
  v_mfma_f32_16x16x32_bf16 v[12:15], v[80:83], v[40:43], v[12:15]
  buffer_load_dwordx4 v[36:39], v2, s[36:39], s24 offen offset:3072 sc1
  s_add_u32 s24, s24, 4096
  s_cmp_eq_u32 s24, s9
  s_cselect_b32 s24, s10, s24
  buffer_load_dwordx4 v[244:247], v2, s[36:39], s26 offen offset:0 sc1
  s_add_u32 s25, s25, 5120
  s_cmp_eq_u32 s25, s11
  s_cselect_b32 s25, s12, s25
  s_add_u32 s26, s25, 4096
  v_mfma_f32_16x16x32_bf16 v[28:31], v[84:87], v[40:43], v[28:31]
  v_mfma_f32_16x16x32_bf16 v[120:123], v[88:91], v[40:43], v[120:123]
  v_mfma_f32_16x16x32_bf16 v[136:139], v[92:95], v[40:43], v[136:139]
  v_mfma_f32_16x16x32_bf16 v[152:155], v[96:99], v[40:43], v[152:155]
  v_mfma_f32_16x16x32_bf16 v[16:19], v[80:83], v[44:47], v[16:19]
  buffer_load_dwordx4 v[40:43], v2, s[36:39], s27 offen offset:0 sc1
  v_mfma_f32_16x16x32_bf16 v[48:51], v[84:87], v[44:47], v[48:51]
  v_mfma_f32_16x16x32_bf16 v[124:127], v[88:91], v[44:47], v[124:127]
  v_mfma_f32_16x16x32_bf16 v[140:143], v[92:95], v[44:47], v[140:143]
  v_mfma_f32_16x16x32_bf16 v[156:159], v[96:99], v[44:47], v[156:159]
  v_mfma_f32_16x16x32_bf16 v[20:23], v[80:83], v[52:55], v[20:23]
  buffer_load_dwordx4 v[44:47], v2, s[36:39], s27 offen offset:1024 sc1
  v_mfma_f32_16x16x32_bf16 v[112:115], v[84:87], v[52:55], v[112:115]
  v_mfma_f32_16x16x32_bf16 v[128:131], v[88:91], v[52:55], v[128:131]
  v_mfma_f32_16x16x32_bf16 v[144:147], v[92:95], v[52:55], v[144:147]
  v_mfma_f32_16x16x32_bf16 v[160:163], v[96:99], v[52:55], v[160:163]
  s_waitcnt vmcnt(14)
  v_mfma_f32_16x16x32_bf16 v[164:167], v[80:83], v[56:59], v[164:167]
  buffer_load_dwordx4 v[52:55], v2, s[36:39], s27 offen offset:2048 sc1
  v_mfma_f32_16x16x32_bf16 v[180:183], v[84:87], v[56:59], v[180:183]
  v_mfma_f32_16x16x32_bf16 v[196:199], v[88:91], v[56:59], v[196:199]
  v_mfma_f32_16x16x32_bf16 v[212:215], v[92:95], v[56:59], v[212:215]
  v_mfma_f32_16x16x32_bf16 v[228:231], v[96:99], v[56:59], v[228:231]
  s_waitcnt vmcnt(14)
  v_mfma_f32_16x16x32_bf16 v[168:171], v[80:83], v[60:63], v[168:171]
  buffer_load_dwordx4 v[56:59], v2, s[36:39], s27 offen offset:3072 sc1
  s_add_u32 s27, s24, s8
  v_mfma_f32_16x16x32_bf16 v[184:187], v[84:87], v[60:63], v[184:187]
  v_mfma_f32_16x16x32_bf16 v[200:203], v[88:91], v[60:63], v[200:203]
  v_mfma_f32_16x16x32_bf16 v[216:219], v[92:95], v[60:63], v[216:219]
  v_mfma_f32_16x16x32_bf16 v[232:235], v[96:99], v[60:63], v[232:235]
  s_waitcnt vmcnt(14)
  v_mfma_f32_16x16x32_bf16 v[172:175], v[80:83], v[64:67], v[172:175]
  buffer_load_dwordx4 v[60:63], v2, s[36:39], s24 offen offset:0 sc1
  v_mfma_f32_16x16x32_bf16 v[188:191], v[84:87], v[64:67], v[188:191]
  v_mfma_f32_16x16x32_bf16 v[204:207], v[88:91], v[64:67], v[204:207]
  v_mfma_f32_16x16x32_bf16 v[220:223], v[92:95], v[64:67], v[220:223]
  v_mfma_f32_16x16x32_bf16 v[236:239], v[96:99], v[64:67], v[236:239]
  s_waitcnt vmcnt(14)
  v_mfma_f32_16x16x32_bf16 v[176:179], v[80:83], v[68:71], v[176:179]
  buffer_load_dwordx4 v[64:67], v2, s[36:39], s24 offen offset:1024 sc1
  v_mfma_f32_16x16x32_bf16 v[192:195], v[84:87], v[68:71], v[192:195]
  v_mfma_f32_16x16x32_bf16 v[208:211], v[88:91], v[68:71], v[208:211]
  v_mfma_f32_16x16x32_bf16 v[224:227], v[92:95], v[68:71], v[224:227]
  v_mfma_f32_16x16x32_bf16 v[248:251], v[96:99], v[68:71], v[248:251]
  s_waitcnt vmcnt(11)
  v_mfma_f32_16x16x32_bf16 v[8:11], v[100:103], v[72:75], v[8:11]
  buffer_load_dwordx4 v[68:71], v2, s[36:39], s24 offen offset:2048 sc1
  s_waitcnt vmcnt(11)
  v_mfma_f32_16x16x32_bf16 v[24:27], v[104:107], v[72:75], v[24:27]
  buffer_load_dwordx4 v[80:83], v2, s[36:39], s25 offen offset:0 sc1
  s_waitcnt vmcnt(11)
  v_mfma_f32_16x16x32_bf16 v[116:119], v[108:111], v[72:75], v[116:119]
  buffer_load_dwordx4 v[84:87], v2, s[36:39], s25 offen offset:1024 sc1
  s_waitcnt vmcnt(11)
  v_mfma_f32_16x16x32_bf16 v[132:135], v[240:243], v[72:75], v[132:135]
  buffer_load_dwordx4 v[88:91], v2, s[36:39], s25 offen offset:2048 sc1
  s_waitcnt vmcnt(10)
  v_mfma_f32_16x16x32_bf16 v[148:151], v[244:247], v[72:75], v[148:151]
  buffer_load_dwordx4 v[92:95], v2, s[36:39], s25 offen offset:3072 sc1
  v_mfma_f32_16x16x32_bf16 v[12:15], v[100:103], v[76:79], v[12:15]
  buffer_load_dwordx4 v[72:75], v2, s[36:39], s24 offen offset:3072 sc1
  s_add_u32 s24, s24, 4096
  s_cmp_eq_u32 s24, s9
  s_cselect_b32 s24, s10, s24
  buffer_load_dwordx4 v[96:99], v2, s[36:39], s26 offen offset:0 sc1
  s_add_u32 s25, s25, 5120
  s_cmp_eq_u32 s25, s11
  s_cselect_b32 s25, s12, s25
  s_add_u32 s26, s25, 4096
  v_mfma_f32_16x16x32_bf16 v[28:31], v[104:107], v[76:79], v[28:31]
  v_mfma_f32_16x16x32_bf16 v[120:123], v[108:111], v[76:79], v[120:123]
  v_mfma_f32_16x16x32_bf16 v[136:139], v[240:243], v[76:79], v[136:139]
  v_mfma_f32_16x16x32_bf16 v[152:155], v[244:247], v[76:79], v[152:155]
  v_mfma_f32_16x16x32_bf16 v[16:19], v[100:103], v[32:35], v[16:19]
  buffer_load_dwordx4 v[76:79], v2, s[36:39], s27 offen offset:0 sc1
  v_mfma_f32_16x16x32_bf16 v[48:51], v[104:107], v[32:35], v[48:51]
  v_mfma_f32_16x16x32_bf16 v[124:127], v[108:111], v[32:35], v[124:127]
  v_mfma_f32_16x16x32_bf16 v[140:143], v[240:243], v[32:35], v[140:143]
  v_mfma_f32_16x16x32_bf16 v[156:159], v[244:247], v[32:35], v[156:159]
  v_mfma_f32_16x16x32_bf16 v[20:23], v[100:103], v[36:39], v[20:23]
  buffer_load_dwordx4 v[32:35], v2, s[36:39], s27 offen offset:1024 sc1
  v_mfma_f32_16x16x32_bf16 v[112:115], v[104:107], v[36:39], v[112:115]
  v_mfma_f32_16x16x32_bf16 v[128:131], v[108:111], v[36:39], v[128:131]
  v_mfma_f32_16x16x32_bf16 v[144:147], v[240:243], v[36:39], v[144:147]
  v_mfma_f32_16x16x32_bf16 v[160:163], v[244:247], v[36:39], v[160:163]
  s_waitcnt vmcnt(14)
  v_mfma_f32_16x16x32_bf16 v[164:167], v[100:103], v[40:43], v[164:167]
  buffer_load_dwordx4 v[36:39], v2, s[36:39], s27 offen offset:2048 sc1
  v_mfma_f32_16x16x32_bf16 v[180:183], v[104:107], v[40:43], v[180:183]
  v_mfma_f32_16x16x32_bf16 v[196:199], v[108:111], v[40:43], v[196:199]
  v_mfma_f32_16x16x32_bf16 v[212:215], v[240:243], v[40:43], v[212:215]
  v_mfma_f32_16x16x32_bf16 v[228:231], v[244:247], v[40:43], v[228:231]
  s_waitcnt vmcnt(14)
  v_mfma_f32_16x16x32_bf16 v[168:171], v[100:103], v[44:47], v[168:171]
  buffer_load_dwordx4 v[40:43], v2, s[36:39], s27 offen offset:3072 sc1
  s_add_u32 s27, s24, s8
  v_mfma_f32_16x16x32_bf16 v[184:187], v[104:107], v[44:47], v[184:187]
  v_mfma_f32_16x16x32_bf16 v[200:203], v[108:111], v[44:47], v[200:203]
  v_mfma_f32_16x16x32_bf16 v[216:219], v[240:243], v[44:47], v[216:219]
  v_mfma_f32_16x16x32_bf16 v[232:235], v[244:247], v[44:47], v[232:235]
  s_waitcnt vmcnt(14)
  v_mfma_f32_16x16x32_bf16 v[172:175], v[100:103], v[52:55], v[172:175]
  buffer_load_dwordx4 v[44:47], v2, s[36:39], s24 offen offset:0 sc1
  v_mfma_f32_16x16x32_bf16 v[188:191], v[104:107], v[52:55], v[188:191]
  v_mfma_f32_16x16x32_bf16 v[204:207], v[108:111], v[52:55], v[204:207]
  v_mfma_f32_16x16x32_bf16 v[220:223], v[240:243], v[52:55], v[220:223]
  v_mfma_f32_16x16x32_bf16 v[236:239], v[244:247], v[52:55], v[236:239]
  s_waitcnt vmcnt(14)
  v_mfma_f32_16x16x32_bf16 v[176:179], v[100:103], v[56:59], v[176:179]
  buffer_load_dwordx4 v[52:55], v2, s[36:39], s24 offen offset:1024 sc1
  v_mfma_f32_16x16x32_bf16 v[192:195], v[104:107], v[56:59], v[192:195]
  v_mfma_f32_16x16x32_bf16 v[208:211], v[108:111], v[56:59], v[208:211]
  v_mfma_f32_16x16x32_bf16 v[224:227], v[240:243], v[56:59], v[224:227]
  v_mfma_f32_16x16x32_bf16 v[248:251], v[244:247], v[56:59], v[248:251]
  s_waitcnt vmcnt(11)
  v_mfma_f32_16x16x32_bf16 v[8:11], v[80:83], v[60:63], v[8:11]
  buffer_load_dwordx4 v[56:59], v2, s[36:39], s24 offen offset:2048 sc1
  s_waitcnt vmcnt(11)
  v_mfma_f32_16x16x32_bf16 v[24:27], v[84:87], v[60:63], v[24:27]
  buffer_load_dwordx4 v[100:103], v2, s[36:39], s25 offen offset:0 sc1
  s_waitcnt vmcnt(11)
  v_mfma_f32_16x16x32_bf16 v[116:119], v[88:91], v[60:63], v[116:119]
  buffer_load_dwordx4 v[104:107], v2, s[36:39], s25 offen offset:1024 sc1
  s_waitcnt vmcnt(11)
  v_mfma_f32_16x16x32_bf16 v[132:135], v[92:95], v[60:63], v[132:135]
  buffer_load_dwordx4 v[108:111], v2, s[36:39], s25 offen offset:2048 sc1
  s_waitcnt vmcnt(10)
  v_mfma_f32_16x16x32_bf16 v[148:151], v[96:99], v[60:63], v[148:151]
  buffer_load_dwordx4 v[240:243], v2, s[36:39], s25 offen offset:3072 sc1
  v_mfma_f32_16x16x32_bf16 v[12:15], v[80:83], v[64:67], v[12:15]
  buffer_load_dwordx4 v[60:63], v2, s[36:39], s24 offen offset:3072 sc1
  s_add_u32 s24, s24, 4096
  s_cmp_eq_u32 s24, s9
  s_cselect_b32 s24, s10, s24
  buffer_load_dwordx4 v[244:247], v2, s[36:39], s26 offen offset:0 sc1
  s_add_u32 s25, s25, 5120
  s_cmp_eq_u32 s25, s11
  s_cselect_b32 s25, s12, s25
  s_add_u32 s26, s25, 4096
  v_mfma_f32_16x16x32_bf16 v[28:31], v[84:87], v[64:67], v[28:31]
  v_mfma_f32_16x16x32_bf16 v[120:123], v[88:91], v[64:67], v[120:123]
  v_mfma_f32_16x16x32_bf16 v[136:139], v[92:95], v[64:67], v[136:139]
  v_mfma_f32_16x16x32_bf16 v[152:155], v[96:99], v[64:67], v[152:155]
  v_mfma_f32_16x16x32_bf16 v[16:19], v[80:83], v[68:71], v[16:19]
  buffer_load_dwordx4 v[64:67], v2, s[36:39], s27 offen offset:0 sc1
  v_mfma_f32_16x16x32_bf16 v[48:51], v[84:87], v[68:71], v[48:51]
  v_mfma_f32_16x16x32_bf16 v[124:127], v[88:91], v[68:71], v[124:127]
  v_mfma_f32_16x16x32_bf16 v[140:143], v[92:95], v[68:71], v[140:143]
  v_mfma_f32_16x16x32_bf16 v[156:159], v[96:99], v[68:71], v[156:159]
  v_mfma_f32_16x16x32_bf16 v[20:23], v[80:83], v[72:75], v[20:23]
  buffer_load_dwordx4 v[68:71], v2, s[36:39], s27 offen offset:1024 sc1
  v_mfma_f32_16x16x32_bf16 v[112:115], v[84:87], v[72:75], v[112:115]
  v_mfma_f32_16x16x32_bf16 v[128:131], v[88:91], v[72:75], v[128:131]
  v_mfma_f32_16x16x32_bf16 v[144:147], v[92:95], v[72:75], v[144:147]
  v_mfma_f32_16x16x32_bf16 v[160:163], v[96:99], v[72:75], v[160:163]
  s_waitcnt vmcnt(14)
  v_mfma_f32_16x16x32_bf16 v[164:167], v[80:83], v[76:79], v[164:167]
  buffer_load_dwordx4 v[72:75], v2, s[36:39], s27 offen offset:2048 sc1
  v_mfma_f32_16x16x32_bf16 v[180:183], v[84:87], v[76:79], v[180:183]
  v_mfma_f32_16x16x32_bf16 v[196:199], v[88:91], v[76:79], v[196:199]
  v_mfma_f32_16x16x32_bf16 v[212:215], v[92:95], v[76:79], v[212:215]
  v_mfma_f32_16x16x32_bf16 v[228:231], v[96:99], v[76:79], v[228:231]
  s_waitcnt vmcnt(14)
  v_mfma_f32_16x16x32_bf16 v[168:171], v[80:83], v[32:35], v[168:171]
  buffer_load_dwordx4 v[76:79], v2, s[36:39], s27 offen offset:3072 sc1
  s_add_u32 s27, s24, s8
  v_mfma_f32_16x16x32_bf16 v[184:187], v[84:87], v[32:35], v[184:187]
  v_mfma_f32_16x16x32_bf16 v[200:203], v[88:91], v[32:35], v[200:203]
  v_mfma_f32_16x16x32_bf16 v[216:219], v[92:95], v[32:35], v[216:219]
  v_mfma_f32_16x16x32_bf16 v[232:235], v[96:99], v[32:35], v[232:235]
  s_waitcnt vmcnt(14)
  v_mfma_f32_16x16x32_bf16 v[172:175], v[80:83], v[36:39], v[172:175]
  buffer_load_dwordx4 v[32:35], v2, s[36:39], s24 offen offset:0 sc1
  v_mfma_f32_16x16x32_bf16 v[188:191], v[84:87], v[36:39], v[188:191]
  v_mfma_f32_16x16x32_bf16 v[204:207], v[88:91], v[36:39], v[204:207]
  v_mfma_f32_16x16x32_bf16 v[220:223], v[92:95], v[36:39], v[220:223]
  v_mfma_f32_16x16x32_bf16 v[236:239], v[96:99], v[36:39], v[236:239]
  s_waitcnt vmcnt(14)
  v_mfma_f32_16x16x32_bf16 v[176:179], v[80:83], v[40:43], v[176:179]
  buffer_load_dwordx4 v[36:39], v2, s[36:39], s24 offen offset:1024 sc1
  v_mfma_f32_16x16x32_bf16 v[192:195], v[84:87], v[40:43], v[192:195]
  v_mfma_f32_16x16x32_bf16 v[208:211], v[88:91], v[40:43], v[208:211]
  v_mfma_f32_16x16x32_bf16 v[224:227], v[92:95], v[40:43], v[224:227]
  v_mfma_f32_16x16x32_bf16 v[248:251], v[96:99], v[40:43], v[248:251]
  s_waitcnt vmcnt(11)
  v_mfma_f32_16x16x32_bf16 v[8:11], v[100:103], v[44:47], v[8:11]
  buffer_load_dwordx4 v[40:43], v2, s[36:39], s24 offen offset:2048 sc1
  s_waitcnt vmcnt(11)
  v_mfma_f32_16x16x32_bf16 v[24:27], v[104:107], v[44:47], v[24:27]
  buffer_load_dwordx4 v[80:83], v2, s[36:39], s25 offen offset:0 sc1
  s_waitcnt vmcnt(11)
  v_mfma_f32_16x16x32_bf16 v[116:119], v[108:111], v[44:47], v[116:119]
  buffer_load_dwordx4 v[84:87], v2, s[36:39], s25 offen offset:1024 sc1
  s_waitcnt vmcnt(11)
  v_mfma_f32_16x16x32_bf16 v[132:135], v[240:243], v[44:47], v[132:135]
  buffer_load_dwordx4 v[88:91], v2, s[36:39], s25 offen offset:2048 sc1
  s_waitcnt vmcnt(10)
  v_mfma_f32_16x16x32_bf16 v[148:151], v[244:247], v[44:47], v[148:151]
  buffer_load_dwordx4 v[92:95], v2, s[36:39], s25 offen offset:3072 sc1
  v_mfma_f32_16x16x32_bf16 v[12:15], v[100:103], v[52:55], v[12:15]
  buffer_load_dwordx4 v[44:47], v2, s[36:39], s24 offen offset:3072 sc1
  s_add_u32 s24, s24, 4096
  s_cmp_eq_u32 s24, s9
  s_cselect_b32 s24, s10, s24
  buffer_load_dwordx4 v[96:99], v2, s[36:39], s26 offen offset:0 sc1
  s_add_u32 s25, s25, 5120
  s_cmp_eq_u32 s25, s11
  s_cselect_b32 s25, s12, s25
  s_add_u32 s26, s25, 4096
  v_mfma_f32_16x16x32_bf16 v[28:31], v[104:107], v[52:55], v[28:31]
  v_mfma_f32_16x16x32_bf16 v[120:123], v[108:111], v[52:55], v[120:123]
  v_mfma_f32_16x16x32_bf16 v[136:139], v[240:243], v[52:55], v[136:139]
  v_mfma_f32_16x16x32_bf16 v[152:155], v[244:247], v[52:55], v[152:155]
  v_mfma_f32_16x16x32_bf16 v[16:19], v[100:103], v[56:59], v[16:19]
  buffer_load_dwordx4 v[52:55], v2, s[36:39], s27 offen offset:0 sc1
  v_mfma_f32_16x16x32_bf16 v[48:51], v[104:107], v[56:59], v[48:51]
  v_mfma_f32_16x16x32_bf16 v[124:127], v[108:111], v[56:59], v[124:127]
  v_mfma_f32_16x16x32_bf16 v[140:143], v[240:243], v[56:59], v[140:143]
  v_mfma_f32_16x16x32_bf16 v[156:159], v[244:247], v[56:59], v[156:159]
  v_mfma_f32_16x16x32_bf16 v[20:23], v[100:103], v[60:63], v[20:23]
  buffer_load_dwordx4 v[56:59], v2, s[36:39], s27 offen offset:1024 sc1
  v_mfma_f32_16x16x32_bf16 v[112:115], v[104:107], v[60:63], v[112:115]
  v_mfma_f32_16x16x32_bf16 v[128:131], v[108:111], v[60:63], v[128:131]
  v_mfma_f32_16x16x32_bf16 v[144:147], v[240:243], v[60:63], v[144:147]
  v_mfma_f32_16x16x32_bf16 v[160:163], v[244:247], v[60:63], v[160:163]
  s_waitcnt vmcnt(14)
  v_mfma_f32_16x16x32_bf16 v[164:167], v[100:103], v[64:67], v[164:167]
  buffer_load_dwordx4 v[60:63], v2, s[36:39], s27 offen offset:2048 sc1
  v_mfma_f32_16x16x32_bf16 v[180:183], v[104:107], v[64:67], v[180:183]
  v_mfma_f32_16x16x32_bf16 v[196:199], v[108:111], v[64:67], v[196:199]
  v_mfma_f32_16x16x32_bf16 v[212:215], v[240:243], v[64:67], v[212:215]
  v_mfma_f32_16x16x32_bf16 v[228:231], v[244:247], v[64:67], v[228:231]
  s_waitcnt vmcnt(14)
  v_mfma_f32_16x16x32_bf16 v[168:171], v[100:103], v[68:71], v[168:171]
  buffer_load_dwordx4 v[64:67], v2, s[36:39], s27 offen offset:3072 sc1
  s_add_u32 s27, s24, s8
  v_mfma_f32_16x16x32_bf16 v[184:187], v[104:107], v[68:71], v[184:187]
  v_mfma_f32_16x16x32_bf16 v[200:203], v[108:111], v[68:71], v[200:203]
  v_mfma_f32_16x16x32_bf16 v[216:219], v[240:243], v[68:71], v[216:219]
  v_mfma_f32_16x16x32_bf16 v[232:235], v[244:247], v[68:71], v[232:235]
  s_waitcnt vmcnt(14)
  v_mfma_f32_16x16x32_bf16 v[172:175], v[100:103], v[72:75], v[172:175]
  buffer_load_dwordx4 v[68:71], v2, s[36:39], s24 offen offset:0 sc1
  v_mfma_f32_16x16x32_bf16 v[188:191], v[104:107], v[72:75], v[188:191]
  v_mfma_f32_16x16x32_bf16 v[204:207], v[108:111], v[72:75], v[204:207]
  v_mfma_f32_16x16x32_bf16 v[220:223], v[240:243], v[72:75], v[220:223]
  v_mfma_f32_16x16x32_bf16 v[236:239], v[244:247], v[72:75], v[236:239]
  s_waitcnt vmcnt(14)
  v_mfma_f32_16x16x32_bf16 v[176:179], v[100:103], v[76:79], v[176:179]
  buffer_load_dwordx4 v[72:75], v2, s[36:39], s24 offen offset:1024 sc1
  v_mfma_f32_16x16x32_bf16 v[192:195], v[104:107], v[76:79], v[192:195]
  v_mfma_f32_16x16x32_bf16 v[208:211], v[108:111], v[76:79], v[208:211]
  v_mfma_f32_16x16x32_bf16 v[224:227], v[240:243], v[76:79], v[224:227]
  v_mfma_f32_16x16x32_bf16 v[248:251], v[244:247], v[76:79], v[248:251]
  s_waitcnt vmcnt(11)
  v_mfma_f32_16x16x32_bf16 v[8:11], v[80:83], v[32:35], v[8:11]
  buffer_load_dwordx4 v[76:79], v2, s[36:39], s24 offen offset:2048 sc1
  s_waitcnt vmcnt(11)
  v_mfma_f32_16x16x32_bf16 v[24:27], v[84:87], v[32:35], v[24:27]
  buffer_load_dwordx4 v[100:103], v2, s[36:39], s25 offen offset:0 sc1
  s_waitcnt vmcnt(11)
  v_mfma_f32_16x16x32_bf16 v[116:119], v[88:91], v[32:35], v[116:119]
  buffer_load_dwordx4 v[104:107], v2, s[36:39], s25 offen offset:1024 sc1
  s_waitcnt vmcnt(11)
  v_mfma_f32_16x16x32_bf16 v[132:135], v[92:95], v[32:35], v[132:135]
  buffer_load_dwordx4 v[108:111], v2, s[36:39], s25 offen offset:2048 sc1
  s_waitcnt vmcnt(10)
  v_mfma_f32_16x16x32_bf16 v[148:151], v[96:99], v[32:35], v[148:151]
  buffer_load_dwordx4 v[240:243], v2, s[36:39], s25 offen offset:3072 sc1
  v_mfma_f32_16x16x32_bf16 v[12:15], v[80:83], v[36:39], v[12:15]
  buffer_load_dwordx4 v[32:35], v2, s[36:39], s24 offen offset:3072 sc1
  s_add_u32 s24, s24, 4096
  s_cmp_eq_u32 s24, s9
  s_cselect_b32 s24, s10, s24
  buffer_load_dwordx4 v[244:247], v2, s[36:39], s26 offen offset:0 sc1
  s_add_u32 s25, s25, 5120
  s_cmp_eq_u32 s25, s11
  s_cselect_b32 s25, s12, s25
  s_add_u32 s26, s25, 4096
  v_mfma_f32_16x16x32_bf16 v[28:31], v[84:87], v[36:39], v[28:31]
  v_mfma_f32_16x16x32_bf16 v[120:123], v[88:91], v[36:39], v[120:123]
  v_mfma_f32_16x16x32_bf16 v[136:139], v[92:95], v[36:39], v[136:139]
  v_mfma_f32_16x16x32_bf16 v[152:155], v[96:99], v[36:39], v[152:155]
  v_mfma_f32_16x16x32_bf16 v[16:19], v[80:83], v[40:43], v[16:19]
  buffer_load_dwordx4 v[36:39], v2, s[36:39], s27 offen offset:0 sc1
  v_mfma_f32_16x16x32_bf16 v[48:51], v[84:87], v[40:43], v[48:51]
  v_mfma_f32_16x16x32_bf16 v[124:127], v[88:91], v[40:43], v[124:127]
  v_mfma_f32_16x16x32_bf16 v[140:143], v[92:95], v[40:43], v[140:143]
  v_mfma_f32_16x16x32_bf16 v[156:159], v[96:99], v[40:43], v[156:159]
  v_mfma_f32_16x16x32_bf16 v[20:23], v[80:83], v[44:47], v[20:23]
  buffer_load_dwordx4 v[40:43], v2, s[36:39], s27 offen offset:1024 sc1
  v_mfma_f32_16x16x32_bf16 v[112:115], v[84:87], v[44:47], v[112:115]
  v_mfma_f32_16x16x32_bf16 v[128:131], v[88:91], v[44:47], v[128:131]
  v_mfma_f32_16x16x32_bf16 v[144:147], v[92:95], v[44:47], v[144:147]
  v_mfma_f32_16x16x32_bf16 v[160:163], v[96:99], v[44:47], v[160:163]
  s_waitcnt vmcnt(14)
  v_mfma_f32_16x16x32_bf16 v[164:167], v[80:83], v[52:55], v[164:167]
  buffer_load_dwordx4 v[44:47], v2, s[36:39], s27 offen offset:2048 sc1
  v_mfma_f32_16x16x32_bf16 v[180:183], v[84:87], v[52:55], v[180:183]
  v_mfma_f32_16x16x32_bf16 v[196:199], v[88:91], v[52:55], v[196:199]
  v_mfma_f32_16x16x32_bf16 v[212:215], v[92:95], v[52:55], v[212:215]
  v_mfma_f32_16x16x32_bf16 v[228:231], v[96:99], v[52:55], v[228:231]
  s_waitcnt vmcnt(14)
  v_mfma_f32_16x16x32_bf16 v[168:171], v[80:83], v[56:59], v[168:171]
  buffer_load_dwordx4 v[52:55], v2, s[36:39], s27 offen offset:3072 sc1
  s_add_u32 s27, s24, s8
  v_mfma_f32_16x16x32_bf16 v[184:187], v[84:87], v[56:59], v[184:187]
  v_mfma_f32_16x16x32_bf16 v[200:203], v[88:91], v[56:59], v[200:203]
  v_mfma_f32_16x16x32_bf16 v[216:219], v[92:95], v[56:59], v[216:219]
  v_mfma_f32_16x16x32_bf16 v[232:235], v[96:99], v[56:59], v[232:235]
  s_waitcnt vmcnt(14)
  v_mfma_f32_16x16x32_bf16 v[172:175], v[80:83], v[60:63], v[172:175]
  buffer_load_dwordx4 v[56:59], v2, s[36:39], s24 offen offset:0 sc1
  v_mfma_f32_16x16x32_bf16 v[188:191], v[84:87], v[60:63], v[188:191]
  v_mfma_f32_16x16x32_bf16 v[204:207], v[88:91], v[60:63], v[204:207]
  v_mfma_f32_16x16x32_bf16 v[220:223], v[92:95], v[60:63], v[220:223]
  v_mfma_f32_16x16x32_bf16 v[236:239], v[96:99], v[60:63], v[236:239]
  s_waitcnt vmcnt(14)
  v_mfma_f32_16x16x32_bf16 v[176:179], v[80:83], v[64:67], v[176:179]
  buffer_load_dwordx4 v[60:63], v2, s[36:39], s24 offen offset:1024 sc1
  v_mfma_f32_16x16x32_bf16 v[192:195], v[84:87], v[64:67], v[192:195]
  v_mfma_f32_16x16x32_bf16 v[208:211], v[88:91], v[64:67], v[208:211]
  v_mfma_f32_16x16x32_bf16 v[224:227], v[92:95], v[64:67], v[224:227]
  v_mfma_f32_16x16x32_bf16 v[248:251], v[96:99], v[64:67], v[248:251]
  s_waitcnt vmcnt(11)
  v_mfma_f32_16x16x32_bf16 v[8:11], v[100:103], v[68:71], v[8:11]
  buffer_load_dwordx4 v[64:67], v2, s[36:39], s24 offen offset:2048 sc1
  s_waitcnt vmcnt(11)
  v_mfma_f32_16x16x32_bf16 v[24:27], v[104:107], v[68:71], v[24:27]
  buffer_load_dwordx4 v[80:83], v2, s[36:39], s25 offen offset:0 sc1
  s_waitcnt vmcnt(11)
  v_mfma_f32_16x16x32_bf16 v[116:119], v[108:111], v[68:71], v[116:119]
  buffer_load_dwordx4 v[84:87], v2, s[36:39], s25 offen offset:1024 sc1
  s_waitcnt vmcnt(11)
  v_mfma_f32_16x16x32_bf16 v[132:135], v[240:243], v[68:71], v[132:135]
  buffer_load_dwordx4 v[88:91], v2, s[36:39], s25 offen offset:2048 sc1
  s_waitcnt vmcnt(10)
  v_mfma_f32_16x16x32_bf16 v[148:151], v[244:247], v[68:71], v[148:151]
  buffer_load_dwordx4 v[92:95], v2, s[36:39], s25 offen offset:3072 sc1
  v_mfma_f32_16x16x32_bf16 v[12:15], v[100:103], v[72:75], v[12:15]
  buffer_load_dwordx4 v[68:71], v2, s[36:39], s24 offen offset:3072 sc1
  s_add_u32 s24, s24, 4096
  s_cmp_eq_u32 s24, s9
  s_cselect_b32 s24, s10, s24
  buffer_load_dwordx4 v[96:99], v2, s[36:39], s26 offen offset:0 sc1
  s_add_u32 s25, s25, 5120
  s_cmp_eq_u32 s25, s11
  s_cselect_b32 s25, s12, s25
  s_add_u32 s26, s25, 4096
  v_mfma_f32_16x16x32_bf16 v[28:31], v[104:107], v[72:75], v[28:31]
  v_mfma_f32_16x16x32_bf16 v[120:123], v[108:111], v[72:75], v[120:123]
  v_mfma_f32_16x16x32_bf16 v[136:139], v[240:243], v[72:75], v[136:139]
  v_mfma_f32_16x16x32_bf16 v[152:155], v[244:247], v[72:75], v[152:155]
  v_mfma_f32_16x16x32_bf16 v[16:19], v[100:103], v[76:79], v[16:19]
  buffer_load_dwordx4 v[72:75], v2, s[36:39], s27 offen offset:0 sc1
  v_mfma_f32_16x16x32_bf16 v[48:51], v[104:107], v[76:79], v[48:51]
  v_mfma_f32_16x16x32_bf16 v[124:127], v[108:111], v[76:79], v[124:127]
  v_mfma_f32_16x16x32_bf16 v[140:143], v[240:243], v[76:79], v[140:143]
  v_mfma_f32_16x16x32_bf16 v[156:159], v[244:247], v[76:79], v[156:159]
  v_mfma_f32_16x16x32_bf16 v[20:23], v[100:103], v[32:35], v[20:23]
  buffer_load_dwordx4 v[76:79], v2, s[36:39], s27 offen offset:1024 sc1
  v_mfma_f32_16x16x32_bf16 v[112:115], v[104:107], v[32:35], v[112:115]
  v_mfma_f32_16x16x32_bf16 v[128:131], v[108:111], v[32:35], v[128:131]
  v_mfma_f32_16x16x32_bf16 v[144:147], v[240:243], v[32:35], v[144:147]
  v_mfma_f32_16x16x32_bf16 v[160:163], v[244:247], v[32:35], v[160:163]
  s_waitcnt vmcnt(14)
  v_mfma_f32_16x16x32_bf16 v[164:167], v[100:103], v[36:39], v[164:167]
  buffer_load_dwordx4 v[32:35], v2, s[36:39], s27 offen offset:2048 sc1
  v_mfma_f32_16x16x32_bf16 v[180:183], v[104:107], v[36:39], v[180:183]
  v_mfma_f32_16x16x32_bf16 v[196:199], v[108:111], v[36:39], v[196:199]
  v_mfma_f32_16x16x32_bf16 v[212:215], v[240:243], v[36:39], v[212:215]
  v_mfma_f32_16x16x32_bf16 v[228:231], v[244:247], v[36:39], v[228:231]
  s_waitcnt vmcnt(14)
  v_mfma_f32_16x16x32_bf16 v[168:171], v[100:103], v[40:43], v[168:171]
  buffer_load_dwordx4 v[36:39], v2, s[36:39], s27 offen offset:3072 sc1
  s_add_u32 s27, s24, s8
  v_mfma_f32_16x16x32_bf16 v[184:187], v[104:107], v[40:43], v[184:187]
  v_mfma_f32_16x16x32_bf16 v[200:203], v[108:111], v[40:43], v[200:203]
  v_mfma_f32_16x16x32_bf16 v[216:219], v[240:243], v[40:43], v[216:219]
  v_mfma_f32_16x16x32_bf16 v[232:235], v[244:247], v[40:43], v[232:235]
  s_waitcnt vmcnt(14)
  v_mfma_f32_16x16x32_bf16 v[172:175], v[100:103], v[44:47], v[172:175]
  s_mov_b64 exec, s[34:35]
  buffer_load_dwordx4 v[40:43], v2, s[36:39], s24 offen offset:0 sc1
  s_mov_b64 exec, -1
  v_mfma_f32_16x16x32_bf16 v[188:191], v[104:107], v[44:47], v[188:191]
  v_mfma_f32_16x16x32_bf16 v[204:207], v[108:111], v[44:47], v[204:207]
  v_mfma_f32_16x16x32_bf16 v[220:223], v[240:243], v[44:47], v[220:223]
  v_mfma_f32_16x16x32_bf16 v[236:239], v[244:247], v[44:47], v[236:239]
  s_waitcnt vmcnt(14)
  v_mfma_f32_16x16x32_bf16 v[176:179], v[100:103], v[52:55], v[176:179]
  s_mov_b64 exec, s[34:35]
  buffer_load_dwordx4 v[44:47], v2, s[36:39], s24 offen offset:1024 sc1
  s_mov_b64 exec, -1
  v_mfma_f32_16x16x32_bf16 v[192:195], v[104:107], v[52:55], v[192:195]
  v_mfma_f32_16x16x32_bf16 v[208:211], v[108:111], v[52:55], v[208:211]
  v_mfma_f32_16x16x32_bf16 v[224:227], v[240:243], v[52:55], v[224:227]
  v_mfma_f32_16x16x32_bf16 v[248:251], v[244:247], v[52:55], v[248:251]
  s_waitcnt vmcnt(11)
  v_mfma_f32_16x16x32_bf16 v[8:11], v[80:83], v[56:59], v[8:11]
  s_mov_b64 exec, s[34:35]
  buffer_load_dwordx4 v[52:55], v2, s[36:39], s24 offen offset:2048 sc1
  s_mov_b64 exec, -1
  s_waitcnt vmcnt(11)
  v_mfma_f32_16x16x32_bf16 v[24:27], v[84:87], v[56:59], v[24:27]
  s_mov_b64 exec, s[34:35]
  buffer_load_dwordx4 v[100:103], v2, s[36:39], s25 offen offset:0 sc1
  s_mov_b64 exec, -1
  s_waitcnt vmcnt(11)
  v_mfma_f32_16x16x32_bf16 v[116:119], v[88:91], v[56:59], v[116:119]
  s_mov_b64 exec, s[34:35]
  buffer_load_dwordx4 v[104:107], v2, s[36:39], s25 offen offset:1024 sc1
  s_mov_b64 exec, -1
  s_waitcnt vmcnt(11)
  v_mfma_f32_16x16x32_bf16 v[132:135], v[92:95], v[56:59], v[132:135]
  s_mov_b64 exec, s[34:35]
  buffer_load_dwordx4 v[108:111], v2, s[36:39], s25 offen offset:2048 sc1
  s_mov_b64 exec, -1
  s_waitcnt vmcnt(10)
  v_mfma_f32_16x16x32_bf16 v[148:151], v[96:99], v[56:59], v[148:151]
  s_mov_b64 exec, s[34:35]
  buffer_load_dwordx4 v[240:243], v2, s[36:39], s25 offen offset:3072 sc1
  s_mov_b64 exec, -1
  v_mfma_f32_16x16x32_bf16 v[12:15], v[80:83], v[60:63], v[12:15]
  s_mov_b64 exec, s[34:35]
  buffer_load_dwordx4 v[56:59], v2, s[36:39], s24 offen offset:3072 sc1
  s_add_u32 s24, s24, 4096
  s_cmp_eq_u32 s24, s9
  s_cselect_b32 s24, s10, s24
  s_mov_b64 exec, -1
  s_mov_b64 exec, s[34:35]
  buffer_load_dwordx4 v[244:247], v2, s[36:39], s26 offen offset:0 sc1
  s_add_u32 s25, s25, 5120
  s_cmp_eq_u32 s25, s11
  s_cselect_b32 s25, s12, s25
  s_add_u32 s26, s25, 4096
  s_mov_b64 exec, -1
  v_mfma_f32_16x16x32_bf16 v[28:31], v[84:87], v[60:63], v[28:31]
  v_mfma_f32_16x16x32_bf16 v[120:123], v[88:91], v[60:63], v[120:123]
  v_mfma_f32_16x16x32_bf16 v[136:139], v[92:95], v[60:63], v[136:139]
  v_mfma_f32_16x16x32_bf16 v[152:155], v[96:99], v[60:63], v[152:155]
  v_mfma_f32_16x16x32_bf16 v[16:19], v[80:83], v[64:67], v[16:19]
  s_mov_b64 exec, s[34:35]
  buffer_load_dwordx4 v[60:63], v2, s[36:39], s27 offen offset:0 sc1
  s_mov_b64 exec, -1
  v_mfma_f32_16x16x32_bf16 v[48:51], v[84:87], v[64:67], v[48:51]
  v_mfma_f32_16x16x32_bf16 v[124:127], v[88:91], v[64:67], v[124:127]
  v_mfma_f32_16x16x32_bf16 v[140:143], v[92:95], v[64:67], v[140:143]
  v_mfma_f32_16x16x32_bf16 v[156:159], v[96:99], v[64:67], v[156:159]
  v_mfma_f32_16x16x32_bf16 v[20:23], v[80:83], v[68:71], v[20:23]
  s_mov_b64 exec, s[34:35]
  buffer_load_dwordx4 v[64:67], v2, s[36:39], s27 offen offset:1024 sc1
  s_mov_b64 exec, -1
  v_mfma_f32_16x16x32_bf16 v[112:115], v[84:87], v[68:71], v[112:115]
  v_mfma_f32_16x16x32_bf16 v[128:131], v[88:91], v[68:71], v[128:131]
  v_mfma_f32_16x16x32_bf16 v[144:147], v[92:95], v[68:71], v[144:147]
  v_mfma_f32_16x16x32_bf16 v[160:163], v[96:99], v[68:71], v[160:163]
  s_waitcnt vmcnt(14)
  v_mfma_f32_16x16x32_bf16 v[164:167], v[80:83], v[72:75], v[164:167]
  s_mov_b64 exec, s[34:35]
  buffer_load_dwordx4 v[68:71], v2, s[36:39], s27 offen offset:2048 sc1
  s_mov_b64 exec, -1
  v_mfma_f32_16x16x32_bf16 v[180:183], v[84:87], v[72:75], v[180:183]
  v_mfma_f32_16x16x32_bf16 v[196:199], v[88:91], v[72:75], v[196:199]
  v_mfma_f32_16x16x32_bf16 v[212:215], v[92:95], v[72:75], v[212:215]
  v_mfma_f32_16x16x32_bf16 v[228:231], v[96:99], v[72:75], v[228:231]
  s_waitcnt vmcnt(14)
  v_mfma_f32_16x16x32_bf16 v[168:171], v[80:83], v[76:79], v[168:171]
  s_mov_b64 exec, s[34:35]
  buffer_load_dwordx4 v[72:75], v2, s[36:39], s27 offen offset:3072 sc1
  s_add_u32 s27, s24, s8
  s_mov_b64 exec, -1
  v_mfma_f32_16x16x32_bf16 v[184:187], v[84:87], v[76:79], v[184:187]
  v_mfma_f32_16x16x32_bf16 v[200:203], v[88:91], v[76:79], v[200:203]
  v_mfma_f32_16x16x32_bf16 v[216:219], v[92:95], v[76:79], v[216:219]
  v_mfma_f32_16x16x32_bf16 v[232:235], v[96:99], v[76:79], v[232:235]
  s_waitcnt vmcnt(14)
  v_mfma_f32_16x16x32_bf16 v[172:175], v[80:83], v[32:35], v[172:175]
  v_mfma_f32_16x16x32_bf16 v[188:191], v[84:87], v[32:35], v[188:191]
  v_mfma_f32_16x16x32_bf16 v[204:207], v[88:91], v[32:35], v[204:207]
  v_mfma_f32_16x16x32_bf16 v[220:223], v[92:95], v[32:35], v[220:223]
  v_mfma_f32_16x16x32_bf16 v[236:239], v[96:99], v[32:35], v[236:239]
  s_waitcnt vmcnt(13)
  v_mfma_f32_16x16x32_bf16 v[176:179], v[80:83], v[36:39], v[176:179]
  v_mfma_f32_16x16x32_bf16 v[192:195], v[84:87], v[36:39], v[192:195]
  v_mfma_f32_16x16x32_bf16 v[208:211], v[88:91], v[36:39], v[208:211]
  v_mfma_f32_16x16x32_bf16 v[224:227], v[92:95], v[36:39], v[224:227]
  v_mfma_f32_16x16x32_bf16 v[248:251], v[96:99], v[36:39], v[248:251]
  s_cmp_eq_u32 s34, 0
  s_cbranch_scc1 K3_DONE
  s_waitcnt vmcnt(9)
  v_mfma_f32_16x16x32_bf16 v[8:11], v[100:103], v[40:43], v[8:11]
  s_waitcnt vmcnt(8)
  v_mfma_f32_16x16x32_bf16 v[24:27], v[104:107], v[40:43], v[24:27]
  s_waitcnt vmcnt(7)
  v_mfma_f32_16x16x32_bf16 v[116:119], v[108:111], v[40:43], v[116:119]
  s_waitcnt vmcnt(6)
  v_mfma_f32_16x16x32_bf16 v[132:135], v[240:243], v[40:43], v[132:135]
  s_waitcnt vmcnt(4)
  v_mfma_f32_16x16x32_bf16 v[148:151], v[244:247], v[40:43], v[148:151]
  v_mfma_f32_16x16x32_bf16 v[12:15], v[100:103], v[44:47], v[12:15]
  v_mfma_f32_16x16x32_bf16 v[28:31], v[104:107], v[44:47], v[28:31]
  v_mfma_f32_16x16x32_bf16 v[120:123], v[108:111], v[44:47], v[120:123]
  v_mfma_f32_16x16x32_bf16 v[136:139], v[240:243], v[44:47], v[136:139]
  v_mfma_f32_16x16x32_bf16 v[152:155], v[244:247], v[44:47], v[152:155]
  v_mfma_f32_16x16x32_bf16 v[16:19], v[100:103], v[52:55], v[16:19]
  v_mfma_f32_16x16x32_bf16 v[48:51], v[104:107], v[52:55], v[48:51]
  v_mfma_f32_16x16x32_bf16 v[124:127], v[108:111], v[52:55], v[124:127]
  v_mfma_f32_16x16x32_bf16 v[140:143], v[240:243], v[52:55], v[140:143]
  v_mfma_f32_16x16x32_bf16 v[156:159], v[244:247], v[52:55], v[156:159]
  v_mfma_f32_16x16x32_bf16 v[20:23], v[100:103], v[56:59], v[20:23]
  v_mfma_f32_16x16x32_bf16 v[112:115], v[104:107], v[56:59], v[112:115]
  v_mfma_f32_16x16x32_bf16 v[128:131], v[108:111], v[56:59], v[128:131]
  v_mfma_f32_16x16x32_bf16 v[144:147], v[240:243], v[56:59], v[144:147]
  v_mfma_f32_16x16x32_bf16 v[160:163], v[244:247], v[56:59], v[160:163]
  s_waitcnt vmcnt(3)
  v_mfma_f32_16x16x32_bf16 v[164:167], v[100:103], v[60:63], v[164:167]
  v_mfma_f32_16x16x32_bf16 v[180:183], v[104:107], v[60:63], v[180:183]
  v_mfma_f32_16x16x32_bf16 v[196:199], v[108:111], v[60:63], v[196:199]
  v_mfma_f32_16x16x32_bf16 v[212:215], v[240:243], v[60:63], v[212:215]
  v_mfma_f32_16x16x32_bf16 v[228:231], v[244:247], v[60:63], v[228:231]
  s_waitcnt vmcnt(2)
  v_mfma_f32_16x16x32_bf16 v[168:171], v[100:103], v[64:67], v[168:171]
  v_mfma_f32_16x16x32_bf16 v[184:187], v[104:107], v[64:67], v[184:187]
  v_mfma_f32_16x16x32_bf16 v[200:203], v[108:111], v[64:67], v[200:203]
  v_mfma_f32_16x16x32_bf16 v[216:219], v[240:243], v[64:67], v[216:219]
  v_mfma_f32_16x16x32_bf16 v[232:235], v[244:247], v[64:67], v[232:235]
  s_waitcnt vmcnt(1)
  v_mfma_f32_16x16x32_bf16 v[172:175], v[100:103], v[68:71], v[172:175]
  v_mfma_f32_16x16x32_bf16 v[188:191], v[104:107], v[68:71], v[188:191]
  v_mfma_f32_16x16x32_bf16 v[204:207], v[108:111], v[68:71], v[204:207]
  v_mfma_f32_16x16x32_bf16 v[220:223], v[240:243], v[68:71], v[220:223]
  v_mfma_f32_16x16x32_bf16 v[236:239], v[244:247], v[68:71], v[236:239]
  s_waitcnt vmcnt(0)
  v_mfma_f32_16x16x32_bf16 v[176:179], v[100:103], v[72:75], v[176:179]
  v_mfma_f32_16x16x32_bf16 v[192:195], v[104:107], v[72:75], v[192:195]
  v_mfma_f32_16x16x32_bf16 v[208:211], v[108:111], v[72:75], v[208:211]
  v_mfma_f32_16x16x32_bf16 v[224:227], v[240:243], v[72:75], v[224:227]
  v_mfma_f32_16x16x32_bf16 v[248:251], v[244:247], v[72:75], v[248:251]
K3_DONE:
  v_and_b32 v4, 15, v0
  v_mul_u32_u24 v4, 2560, v4
  v_lshrrev_b32 v3, 8, v2
  v_lshl_add_u32 v3, v3, 3, v4
  s_mov_b32 s101, 0xffff0000
  s_lshl2_add_u32 s97, s3, 143360
  v_mov_b32 v252, s97
  v_mov_b32 v253, s50
  ds_write_b32 v252, v253
  v_and_b32 v254, 0x70, v2
  v_lshrrev_b32 v254, 2, v254
  v_add_u32 v254, 143360, v254
  s_sub_u32 s100, s3, 1
  s_cbranch_scc1 K3_A
  s_mul_i32 s97, s100, 20480
  v_add_u32 v255, s97, v2
  ds_write_b128 v255, v[8:11] offset:0
  ds_write_b128 v255, v[12:15] offset:1024
  ds_write_b128 v255, v[16:19] offset:2048
  ds_write_b128 v255, v[20:23] offset:3072
  ds_write_b128 v255, v[24:27] offset:4096
  ds_write_b128 v255, v[28:31] offset:5120
  ds_write_b128 v255, v[48:51] offset:6144
  ds_write_b128 v255, v[112:115] offset:7168
  ds_write_b128 v255, v[116:119] offset:8192
  ds_write_b128 v255, v[120:123] offset:9216
  ds_write_b128 v255, v[124:127] offset:10240
  ds_write_b128 v255, v[128:131] offset:11264
  ds_write_b128 v255, v[132:135] offset:12288
  ds_write_b128 v255, v[136:139] offset:13312
  ds_write_b128 v255, v[140:143] offset:14336
  ds_write_b128 v255, v[144:147] offset:15360
  ds_write_b128 v255, v[148:151] offset:16384
  ds_write_b128 v255, v[152:155] offset:17408
  ds_write_b128 v255, v[156:159] offset:18432
  ds_write_b128 v255, v[160:163] offset:19456
  s_mul_i32 s97, s100, 3072
  v_add_u32 v4, s97, v2
  v_add_u32 v5, 61440, v4
  v_add_u32 v6, 122880, v4
  s_lshl_b32 s97, s100, 11
  s_add_u32 s13, s13, s97
  s_add_u32 s14, s14, s97
  s_waitcnt lgkmcnt(0)
  s_barrier
  ds_read_b32 v253, v254
  ds_read_b128 v[80:83], v4 offset:0
  ds_read_b128 v[84:87], v4 offset:20480
  ds_read_b128 v[88:91], v4 offset:40960
  ds_read_b128 v[92:95], v5 offset:0
  ds_read_b128 v[96:99], v5 offset:20480
  s_waitcnt vmcnt(9)
  ds_read_b128 v[100:103], v5 offset:40960
  s_waitcnt vmcnt(8)
  ds_read_b128 v[104:107], v6 offset:0
  s_waitcnt vmcnt(7)
  ds_read_b128 v[108:111], v4 offset:1024
  s_waitcnt vmcnt(6)
  ds_read_b128 v[240:243], v4 offset:21504
  s_waitcnt vmcnt(4)
  ds_read_b128 v[244:247], v4 offset:41984
  s_waitcnt vmcnt(2)
  ds_read_b128 v[64:67], v5 offset:1024
  s_waitcnt vmcnt(1)
  ds_read_b128 v[68:71], v5 offset:21504
  s_waitcnt vmcnt(0)
  ds_read_b128 v[72:75], v5 offset:41984
  ds_read_b128 v[76:79], v6 offset:1024
  ds_read_b128 v[32:35], v4 offset:2048
  ds_read_b128 v[36:39], v4 offset:22528
  ds_read_b128 v[40:43], v4 offset:43008
  ds_read_b128 v[44:47], v5 offset:2048
  ds_read_b128 v[52:55], v5 offset:22528
  ds_read_b128 v[56:59], v5 offset:43008
  ds_read_b128 v[60:63], v6 offset:2048
  s_waitcnt lgkmcnt(15)
  v_cmp_ne_u32 vcc, -1, v253
  s_nop 0
  s_cbranch_vccnz K3_BAIL
  v_pk_add_f32 v[80:81], v[80:81], v[84:85]
  v_pk_add_f32 v[82:83], v[82:83], v[86:87]
  v_pk_add_f32 v[88:89], v[88:89], v[92:93]
  v_pk_add_f32 v[90:91], v[90:91], v[94:95]
  v_pk_add_f32 v[96:97], v[96:97], v[100:101]
  v_pk_add_f32 v[98:99], v[98:99], v[102:103]
  v_pk_add_f32 v[80:81], v[80:81], v[88:89]
  v_pk_add_f32 v[82:83], v[82:83], v[90:91]
  s_waitcnt lgkmcnt(14)
  v_pk_add_f32 v[96:97], v[96:97], v[104:105]
  v_pk_add_f32 v[98:99], v[98:99], v[106:107]
  v_pk_add_f32 v[80:81], v[80:81], v[96:97]
  v_pk_add_f32 v[82:83], v[82:83], v[98:99]
  v_cvt_pk_bf16_f32 v8, v80, v81
  v_cvt_pk_bf16_f32 v9, v82, v83
  s_waitcnt lgkmcnt(12)
  v_pk_add_f32 v[108:109], v[108:109], v[240:241]
  v_pk_add_f32 v[110:111], v[110:111], v[242:243]
  s_waitcnt lgkmcnt(10)
  v_pk_add_f32 v[244:245], v[244:245], v[64:65]
  v_pk_add_f32 v[246:247], v[246:247], v[66:67]
  s_waitcnt lgkmcnt(8)
  v_pk_add_f32 v[68:69], v[68:69], v[72:73]
  v_pk_add_f32 v[70:71], v[70:71], v[74:75]
  v_pk_add_f32 v[108:109], v[108:109], v[244:245]
  v_pk_add_f32 v[110:111], v[110:111], v[246:247]
  s_waitcnt lgkmcnt(7)
  v_pk_add_f32 v[68:69], v[68:69], v[76:77]
  v_pk_add_f32 v[70:71], v[70:71], v[78:79]
  v_pk_add_f32 v[108:109], v[108:109], v[68:69]
  v_pk_add_f32 v[110:111], v[110:111], v[70:71]
  v_cvt_pk_bf16_f32 v10, v108, v109
  v_cvt_pk_bf16_f32 v11, v110, v111
  buffer_store_dwordx4 v[8:11], v2, s[36:39], s13 offen sc1
  s_waitcnt lgkmcnt(5)
  v_pk_add_f32 v[32:33], v[32:33], v[36:37]
  v_pk_add_f32 v[34:35], v[34:35], v[38:39]
  s_waitcnt lgkmcnt(3)
  v_pk_add_f32 v[40:41], v[40:41], v[44:45]
  v_pk_add_f32 v[42:43], v[42:43], v[46:47]
  s_waitcnt lgkmcnt(1)
  v_pk_add_f32 v[52:53], v[52:53], v[56:57]
  v_pk_add_f32 v[54:55], v[54:55], v[58:59]
  v_pk_add_f32 v[32:33], v[32:33], v[40:41]
  v_pk_add_f32 v[34:35], v[34:35], v[42:43]
  s_waitcnt lgkmcnt(0)
  v_pk_add_f32 v[52:53], v[52:53], v[60:61]
  v_pk_add_f32 v[54:55], v[54:55], v[62:63]
  v_pk_add_f32 v[32:33], v[32:33], v[52:53]
  v_pk_add_f32 v[34:35], v[34:35], v[54:55]
  v_cvt_pk_bf16_f32 v12, v32, v33
  v_cvt_pk_bf16_f32 v13, v34, v35
  s_cmp_eq_u32 s3, 7
  s_cbranch_scc0 K3_N7
  v_mov_b32 v12, 0
  v_mov_b32 v13, 0
K3_N7:
  buffer_store_dwordx2 v[12:13], v2, s[36:39], s13 offen offset:1024 sc1
  s_cmp_lg_u32 s86, 0
  s_cbranch_scc1 K3_HX
  s_barrier
  ds_write_b128 v255, v[164:167] offset:0
  ds_write_b128 v255, v[168:171] offset:1024
  ds_write_b128 v255, v[172:175] offset:2048
  ds_write_b128 v255, v[176:179] offset:3072
  ds_write_b128 v255, v[180:183] offset:4096
  ds_write_b128 v255, v[184:187] offset:5120
  ds_write_b128 v255, v[188:191] offset:6144
  ds_write_b128 v255, v[192:195] offset:7168
  ds_write_b128 v255, v[196:199] offset:8192
  ds_write_b128 v255, v[200:203] offset:9216
  ds_write_b128 v255, v[204:207] offset:10240
  ds_write_b128 v255, v[208:211] offset:11264
  ds_write_b128 v255, v[212:215] offset:12288
  ds_write_b128 v255, v[216:219] offset:13312
  ds_write_b128 v255, v[220:223] offset:14336
  ds_write_b128 v255, v[224:227] offset:15360
  ds_write_b128 v255, v[228:231] offset:16384
  ds_write_b128 v255, v[232:235] offset:17408
  ds_write_b128 v255, v[236:239] offset:18432
  ds_write_b128 v255, v[248:251] offset:19456
  buffer_load_dwordx4 v[16:19], v2, s[36:39], s14 offen sc1
  buffer_load_dwordx2 v[20:21], v2, s[36:39], s14 offen offset:1024 sc1
  s_mul_i32 s97, s100, 3
  s_waitcnt lgkmcnt(0)
  s_barrier
  ds_read_b128 v[80:83], v4 offset:0
  ds_read_b128 v[84:87], v4 offset:20480
  ds_read_b128 v[88:91], v4 offset:40960
  ds_read_b128 v[92:95], v5 offset:0
  ds_read_b128 v[96:99], v5 offset:20480
  ds_read_b128 v[100:103], v5 offset:40960
  ds_read_b128 v[104:107], v6 offset:0
  ds_read_b128 v[108:111], v4 offset:1024
  ds_read_b128 v[240:243], v4 offset:21504
  ds_read_b128 v[244:247], v4 offset:41984
  ds_read_b128 v[64:67], v5 offset:1024
  ds_read_b128 v[68:71], v5 offset:21504
  ds_read_b128 v[72:75], v5 offset:41984
  ds_read_b128 v[76:79], v6 offset:1024
  ds_read_b128 v[32:35], v4 offset:2048
  ds_read_b128 v[36:39], v4 offset:22528
  ds_read_b128 v[40:43], v4 offset:43008
  ds_read_b128 v[44:47], v5 offset:2048
  ds_read_b128 v[52:55], v5 offset:22528
  ds_read_b128 v[56:59], v5 offset:43008
  ds_read_b128 v[60:63], v6 offset:2048
  s_waitcnt lgkmcnt(15)
  v_pk_add_f32 v[80:81], v[80:81], v[84:85]
  v_pk_add_f32 v[82:83], v[82:83], v[86:87]
  v_pk_add_f32 v[88:89], v[88:89], v[92:93]
  v_pk_add_f32 v[90:91], v[90:91], v[94:95]
  v_pk_add_f32 v[96:97], v[96:97], v[100:101]
  v_pk_add_f32 v[98:99], v[98:99], v[102:103]
  v_pk_add_f32 v[80:81], v[80:81], v[88:89]
  v_pk_add_f32 v[82:83], v[82:83], v[90:91]
  s_waitcnt lgkmcnt(14)
  v_pk_add_f32 v[96:97], v[96:97], v[104:105]
  v_pk_add_f32 v[98:99], v[98:99], v[106:107]
  v_pk_add_f32 v[80:81], v[80:81], v[96:97]
  v_pk_add_f32 v[82:83], v[82:83], v[98:99]
  s_waitcnt lgkmcnt(12)
  v_pk_add_f32 v[108:109], v[108:109], v[240:241]
  v_pk_add_f32 v[110:111], v[110:111], v[242:243]
  s_waitcnt lgkmcnt(10)
  v_pk_add_f32 v[244:245], v[244:245], v[64:65]
  v_pk_add_f32 v[246:247], v[246:247], v[66:67]
  s_waitcnt lgkmcnt(8)
  v_pk_add_f32 v[68:69], v[68:69], v[72:73]
  v_pk_add_f32 v[70:71], v[70:71], v[74:75]
  v_pk_add_f32 v[108:109], v[108:109], v[244:245]
  v_pk_add_f32 v[110:111], v[110:111], v[246:247]
  s_waitcnt lgkmcnt(7)
  v_pk_add_f32 v[68:69], v[68:69], v[76:77]
  v_pk_add_f32 v[70:71], v[70:71], v[78:79]
  v_pk_add_f32 v[108:109], v[108:109], v[68:69]
  v_pk_add_f32 v[110:111], v[110:111], v[70:71]
  s_waitcnt lgkmcnt(5)
  v_pk_add_f32 v[32:33], v[32:33], v[36:37]
  v_pk_add_f32 v[34:35], v[34:35], v[38:39]
  s_waitcnt lgkmcnt(3)
  v_pk_add_f32 v[40:41], v[40:41], v[44:45]
  v_pk_add_f32 v[42:43], v[42:43], v[46:47]
  s_waitcnt lgkmcnt(1)
  v_pk_add_f32 v[52:53], v[52:53], v[56:57]
  v_pk_add_f32 v[54:55], v[54:55], v[58:59]
  v_pk_add_f32 v[32:33], v[32:33], v[40:41]
  v_pk_add_f32 v[34:35], v[34:35], v[42:43]
  s_waitcnt lgkmcnt(0)
  v_pk_add_f32 v[52:53], v[52:53], v[60:61]
  v_pk_add_f32 v[54:55], v[54:55], v[62:63]
  v_pk_add_f32 v[32:33], v[32:33], v[52:53]
  v_pk_add_f32 v[34:35], v[34:35], v[54:55]
  s_cmp_lt_u32 s89, 524288
  s_cselect_b32 s51, 240, 32
K3_IS:
  s_waitcnt vmcnt(1)
  v_max_u32 v6, v16, v17
  v_max3_u32 v6, v18, v19, v6
  s_waitcnt vmcnt(0)
  v_max3_u32 v6, v20, v21, v6
  v_cmp_eq_u32 vcc, -1, v6
  s_nop 0
  s_cbranch_vccz K3_IR
  s_sleep 1
  buffer_load_dwordx4 v[16:19], v2, s[36:39], s14 offen sc1
  buffer_load_dwordx2 v[20:21], v2, s[36:39], s14 offen offset:1024 sc1
  s_sub_u32 s51, s51, 1
  s_cbranch_scc0 K3_IS
  s_and_b32 s50, s89, 255
  s_branch K3_ST
K3_IR:
  v_lshlrev_b32 v24, 16, v16
  v_and_b32 v25, s101, v16
  v_lshlrev_b32 v26, 16, v17
  v_and_b32 v27, s101, v17
  v_pk_add_f32 v[80:81], v[80:81], v[24:25]
  v_pk_add_f32 v[82:83], v[82:83], v[26:27]
  v_cvt_pk_bf16_f32 v80, v80, v81
  v_cvt_pk_bf16_f32 v81, v82, v83
  s_and_b32 s98, s97, 3
  s_mul_i32 s98, s98, 40960
  s_lshr_b32 s99, s97, 2
  s_lshl_b32 s99, s99, 5
  s_add_u32 s98, s98, s99
  s_add_u32 s98, s98, s15
  buffer_store_dwordx2 v[80:81], v3, s[20:23], s98 offen offset:1280
  s_add_u32 s97, s97, 1
  v_lshlrev_b32 v28, 16, v18
  v_and_b32 v29, s101, v18
  v_lshlrev_b32 v30, 16, v19
  v_and_b32 v31, s101, v19
  v_pk_add_f32 v[108:109], v[108:109], v[28:29]
  v_pk_add_f32 v[110:111], v[110:111], v[30:31]
  v_cvt_pk_bf16_f32 v108, v108, v109
  v_cvt_pk_bf16_f32 v109, v110, v111
  s_and_b32 s98, s97, 3
  s_mul_i32 s98, s98, 40960
  s_lshr_b32 s99, s97, 2
  s_lshl_b32 s99, s99, 5
  s_add_u32 s98, s98, s99
  s_add_u32 s98, s98, s15
  buffer_store_dwordx2 v[108:109], v3, s[20:23], s98 offen offset:1280
  s_add_u32 s97, s97, 1
  v_lshlrev_b32 v48, 16, v20
  v_and_b32 v49, s101, v20
  v_lshlrev_b32 v50, 16, v21
  v_and_b32 v51, s101, v21
  v_pk_add_f32 v[32:33], v[32:33], v[48:49]
  v_pk_add_f32 v[34:35], v[34:35], v[50:51]
  v_cvt_pk_bf16_f32 v32, v32, v33
  v_cvt_pk_bf16_f32 v33, v34, v35
  s_and_b32 s98, s97, 3
  s_mul_i32 s98, s98, 40960
  s_lshr_b32 s99, s97, 2
  s_lshl_b32 s99, s99, 5
  s_add_u32 s98, s98, s99
  s_add_u32 s98, s98, s15
  s_cmp_eq_u32 s3, 7
  s_cbranch_scc1 K3_ST
  buffer_store_dwordx2 v[32:33], v3, s[20:23], s98 offen offset:1280
  s_add_u32 s97, s97, 1
K3_ST:
  v_mov_b32 v253, s50
  ds_write_b32 v252, v253 offset:1024
  s_waitcnt lgkmcnt(0)
  s_barrier
  ds_read_b32 v253, v254 offset:1024
  s_waitcnt lgkmcnt(0)
  v_cmp_ne_u32 vcc, -1, v253
  s_nop 0
  s_cbranch_vccnz K3_BAIL
  s_endpgm
K3_A:
  s_add_u32 s13, s13, 14336
  s_add_u32 s14, s14, 14336
  s_add_u32 s98, s14, 4096
  s_add_u32 s99, s14, 8192
  s_cmp_lg_u32 s50, -1
  s_cbranch_scc1 K3_AN
  v_cvt_pk_bf16_f32 v8, v8, v9
  v_cvt_pk_bf16_f32 v9, v10, v11
  v_cvt_pk_bf16_f32 v10, v12, v13
  v_cvt_pk_bf16_f32 v11, v14, v15
  buffer_store_dwordx4 v[8:11], v2, s[36:39], s13 offen offset:0 sc1
  v_cvt_pk_bf16_f32 v16, v16, v17
  v_cvt_pk_bf16_f32 v17, v18, v19
  v_cvt_pk_bf16_f32 v18, v20, v21
  v_cvt_pk_bf16_f32 v19, v22, v23
  buffer_store_dwordx4 v[16:19], v2, s[36:39], s13 offen offset:1024 sc1
  v_cvt_pk_bf16_f32 v24, v24, v25
  v_cvt_pk_bf16_f32 v25, v26, v27
  v_cvt_pk_bf16_f32 v26, v28, v29
  v_cvt_pk_bf16_f32 v27, v30, v31
  buffer_store_dwordx4 v[24:27], v2, s[36:39], s13 offen offset:2048 sc1
  v_cvt_pk_bf16_f32 v48, v48, v49
  v_cvt_pk_bf16_f32 v49, v50, v51
  v_cvt_pk_bf16_f32 v50, v112, v113
  v_cvt_pk_bf16_f32 v51, v114, v115
  buffer_store_dwordx4 v[48:51], v2, s[36:39], s13 offen offset:3072 sc1
  s_add_u32 s13, s13, 4096
  v_cvt_pk_bf16_f32 v116, v116, v117
  v_cvt_pk_bf16_f32 v117, v118, v119
  v_cvt_pk_bf16_f32 v118, v120, v121
  v_cvt_pk_bf16_f32 v119, v122, v123
  buffer_store_dwordx4 v[116:119], v2, s[36:39], s13 offen offset:0 sc1
  v_cvt_pk_bf16_f32 v124, v124, v125
  v_cvt_pk_bf16_f32 v125, v126, v127
  v_cvt_pk_bf16_f32 v126, v128, v129
  v_cvt_pk_bf16_f32 v127, v130, v131
  buffer_store_dwordx4 v[124:127], v2, s[36:39], s13 offen offset:1024 sc1
  v_cvt_pk_bf16_f32 v132, v132, v133
  v_cvt_pk_bf16_f32 v133, v134, v135
  v_cvt_pk_bf16_f32 v134, v136, v137
  v_cvt_pk_bf16_f32 v135, v138, v139
  buffer_store_dwordx4 v[132:135], v2, s[36:39], s13 offen offset:2048 sc1
  v_cvt_pk_bf16_f32 v140, v140, v141
  v_cvt_pk_bf16_f32 v141, v142, v143
  v_cvt_pk_bf16_f32 v142, v144, v145
  v_cvt_pk_bf16_f32 v143, v146, v147
  buffer_store_dwordx4 v[140:143], v2, s[36:39], s13 offen offset:3072 sc1
  s_add_u32 s13, s13, 4096
  v_cvt_pk_bf16_f32 v148, v148, v149
  v_cvt_pk_bf16_f32 v149, v150, v151
  v_cvt_pk_bf16_f32 v150, v152, v153
  v_cvt_pk_bf16_f32 v151, v154, v155
  buffer_store_dwordx4 v[148:151], v2, s[36:39], s13 offen offset:0 sc1
  v_cvt_pk_bf16_f32 v156, v156, v157
  v_cvt_pk_bf16_f32 v157, v158, v159
  v_cvt_pk_bf16_f32 v158, v160, v161
  v_cvt_pk_bf16_f32 v159, v162, v163
  buffer_store_dwordx4 v[156:159], v2, s[36:39], s13 offen offset:1024 sc1
K3_AN:
  s_waitcnt lgkmcnt(0)
  s_barrier
  ds_read_b32 v253, v254
  buffer_load_dwordx4 v[80:83], v2, s[36:39], s14 offen offset:0 sc1
  buffer_load_dwordx4 v[84:87], v2, s[36:39], s14 offen offset:1024 sc1
  buffer_load_dwordx4 v[88:91], v2, s[36:39], s14 offen offset:2048 sc1
  buffer_load_dwordx4 v[92:95], v2, s[36:39], s14 offen offset:3072 sc1
  buffer_load_dwordx4 v[96:99], v2, s[36:39], s98 offen offset:0 sc1
  buffer_load_dwordx4 v[100:103], v2, s[36:39], s98 offen offset:1024 sc1
  buffer_load_dwordx4 v[104:107], v2, s[36:39], s98 offen offset:2048 sc1
  buffer_load_dwordx4 v[108:111], v2, s[36:39], s98 offen offset:3072 sc1
  buffer_load_dwordx4 v[240:243], v2, s[36:39], s99 offen offset:0 sc1
  buffer_load_dwordx4 v[244:247], v2, s[36:39], s99 offen offset:1024 sc1
  s_waitcnt lgkmcnt(0)
  v_cmp_ne_u32 vcc, -1, v253
  s_nop 0
  s_cbranch_vccnz K3_BAIL
  s_cmp_lg_u32 s86, 0
  s_cbranch_scc1 K3_HX
  s_barrier
  s_waitcnt vmcnt(9)
  v_max_u32 v6, v80, v81
  v_max3_u32 v6, v82, v83, v6
  s_waitcnt vmcnt(8)
  v_max3_u32 v6, v84, v85, v6
  v_max3_u32 v6, v86, v87, v6
  s_waitcnt vmcnt(7)
  v_max3_u32 v6, v88, v89, v6
  v_max3_u32 v6, v90, v91, v6
  s_waitcnt vmcnt(6)
  v_max3_u32 v6, v92, v93, v6
  v_max3_u32 v6, v94, v95, v6
  s_waitcnt vmcnt(5)
  v_max3_u32 v6, v96, v97, v6
  v_max3_u32 v6, v98, v99, v6
  s_waitcnt vmcnt(4)
  v_max3_u32 v6, v100, v101, v6
  v_max3_u32 v6, v102, v103, v6
  s_waitcnt vmcnt(3)
  v_max3_u32 v6, v104, v105, v6
  v_max3_u32 v6, v106, v107, v6
  s_waitcnt vmcnt(2)
  v_max3_u32 v6, v108, v109, v6
  v_max3_u32 v6, v110, v111, v6
  s_waitcnt vmcnt(1)
  v_max3_u32 v6, v240, v241, v6
  v_max3_u32 v6, v242, v243, v6
  s_waitcnt vmcnt(0)
  v_max3_u32 v6, v244, v245, v6
  v_max3_u32 v6, v246, v247, v6
  v_cmp_eq_u32 vcc, -1, v6
  s_nop 0
  s_cbranch_vccnz K3_AL
K3_JR:
  s_add_u32 s97, s15, 40960
  s_add_u32 s98, s15, 81920
  s_add_u32 s99, s15, 122880
  v_lshlrev_b32 v8, 16, v80
  v_and_b32 v9, s101, v80
  v_lshlrev_b32 v10, 16, v81
  v_and_b32 v11, s101, v81
  v_pk_add_f32 v[164:165], v[164:165], v[8:9]
  v_pk_add_f32 v[166:167], v[166:167], v[10:11]
  v_cvt_pk_bf16_f32 v164, v164, v165
  v_cvt_pk_bf16_f32 v165, v166, v167
  buffer_store_dwordx2 v[164:165], v3, s[20:23], s15 offen offset:0
  v_lshlrev_b32 v12, 16, v82
  v_and_b32 v13, s101, v82
  v_lshlrev_b32 v14, 16, v83
  v_and_b32 v15, s101, v83
  v_pk_add_f32 v[168:169], v[168:169], v[12:13]
  v_pk_add_f32 v[170:171], v[170:171], v[14:15]
  v_cvt_pk_bf16_f32 v168, v168, v169
  v_cvt_pk_bf16_f32 v169, v170, v171
  buffer_store_dwordx2 v[168:169], v3, s[20:23], s97 offen offset:0
  v_lshlrev_b32 v16, 16, v84
  v_and_b32 v17, s101, v84
  v_lshlrev_b32 v18, 16, v85
  v_and_b32 v19, s101, v85
  v_pk_add_f32 v[172:173], v[172:173], v[16:17]
  v_pk_add_f32 v[174:175], v[174:175], v[18:19]
  v_cvt_pk_bf16_f32 v172, v172, v173
  v_cvt_pk_bf16_f32 v173, v174, v175
  buffer_store_dwordx2 v[172:173], v3, s[20:23], s98 offen offset:0
  v_lshlrev_b32 v20, 16, v86
  v_and_b32 v21, s101, v86
  v_lshlrev_b32 v22, 16, v87
  v_and_b32 v23, s101, v87
  v_pk_add_f32 v[176:177], v[176:177], v[20:21]
  v_pk_add_f32 v[178:179], v[178:179], v[22:23]
  v_cvt_pk_bf16_f32 v176, v176, v177
  v_cvt_pk_bf16_f32 v177, v178, v179
  buffer_store_dwordx2 v[176:177], v3, s[20:23], s99 offen offset:0
  v_lshlrev_b32 v8, 16, v88
  v_and_b32 v9, s101, v88
  v_lshlrev_b32 v10, 16, v89
  v_and_b32 v11, s101, v89
  v_pk_add_f32 v[180:181], v[180:181], v[8:9]
  v_pk_add_f32 v[182:183], v[182:183], v[10:11]
  v_cvt_pk_bf16_f32 v180, v180, v181
  v_cvt_pk_bf16_f32 v181, v182, v183
  buffer_store_dwordx2 v[180:181], v3, s[20:23], s15 offen offset:32
  v_lshlrev_b32 v12, 16, v90
  v_and_b32 v13, s101, v90
  v_lshlrev_b32 v14, 16, v91
  v_and_b32 v15, s101, v91
  v_pk_add_f32 v[184:185], v[184:185], v[12:13]
  v_pk_add_f32 v[186:187], v[186:187], v[14:15]
  v_cvt_pk_bf16_f32 v184, v184, v185
  v_cvt_pk_bf16_f32 v185, v186, v187
  buffer_store_dwordx2 v[184:185], v3, s[20:23], s97 offen offset:32
  v_lshlrev_b32 v16, 16, v92
  v_and_b32 v17, s101, v92
  v_lshlrev_b32 v18, 16, v93
  v_and_b32 v19, s101, v93
  v_pk_add_f32 v[188:189], v[188:189], v[16:17]
  v_pk_add_f32 v[190:191], v[190:191], v[18:19]
  v_cvt_pk_bf16_f32 v188, v188, v189
  v_cvt_pk_bf16_f32 v189, v190, v191
  buffer_store_dwordx2 v[188:189], v3, s[20:23], s98 offen offset:32
  v_lshlrev_b32 v20, 16, v94
  v_and_b32 v21, s101, v94
  v_lshlrev_b32 v22, 16, v95
  v_and_b32 v23, s101, v95
  v_pk_add_f32 v[192:193], v[192:193], v[20:21]
  v_pk_add_f32 v[194:195], v[194:195], v[22:23]
  v_cvt_pk_bf16_f32 v192, v192, v193
  v_cvt_pk_bf16_f32 v193, v194, v195
  buffer_store_dwordx2 v[192:193], v3, s[20:23], s99 offen offset:32
  v_lshlrev_b32 v8, 16, v96
  v_and_b32 v9, s101, v96
  v_lshlrev_b32 v10, 16, v97
  v_and_b32 v11, s101, v97
  v_pk_add_f32 v[196:197], v[196:197], v[8:9]
  v_pk_add_f32 v[198:199], v[198:199], v[10:11]
  v_cvt_pk_bf16_f32 v196, v196, v197
  v_cvt_pk_bf16_f32 v197, v198, v199
  buffer_store_dwordx2 v[196:197], v3, s[20:23], s15 offen offset:64
  v_lshlrev_b32 v12, 16, v98
  v_and_b32 v13, s101, v98
  v_lshlrev_b32 v14, 16, v99
  v_and_b32 v15, s101, v99
  v_pk_add_f32 v[200:201], v[200:201], v[12:13]
  v_pk_add_f32 v[202:203], v[202:203], v[14:15]
  v_cvt_pk_bf16_f32 v200, v200, v201
  v_cvt_pk_bf16_f32 v201, v202, v203
  buffer_store_dwordx2 v[200:201], v3, s[20:23], s97 offen offset:64
  s_cmp_eq_u32 s100, 0
  s_cbranch_scc1 K3_AB9
  s_barrier
K3_AB9:
  v_lshlrev_b32 v16, 16, v100
  v_and_b32 v17, s101, v100
  v_lshlrev_b32 v18, 16, v101
  v_and_b32 v19, s101, v101
  v_pk_add_f32 v[204:205], v[204:205], v[16:17]
  v_pk_add_f32 v[206:207], v[206:207], v[18:19]
  v_cvt_pk_bf16_f32 v204, v204, v205
  v_cvt_pk_bf16_f32 v205, v206, v207
  buffer_store_dwordx2 v[204:205], v3, s[20:23], s98 offen offset:64
  v_lshlrev_b32 v20, 16, v102
  v_and_b32 v21, s101, v102
  v_lshlrev_b32 v22, 16, v103
  v_and_b32 v23, s101, v103
  v_pk_add_f32 v[208:209], v[208:209], v[20:21]
  v_pk_add_f32 v[210:211], v[210:211], v[22:23]
  v_cvt_pk_bf16_f32 v208, v208, v209
  v_cvt_pk_bf16_f32 v209, v210, v211
  buffer_store_dwordx2 v[208:209], v3, s[20:23], s99 offen offset:64
  v_lshlrev_b32 v8, 16, v104
  v_and_b32 v9, s101, v104
  v_lshlrev_b32 v10, 16, v105
  v_and_b32 v11, s101, v105
  v_pk_add_f32 v[212:213], v[212:213], v[8:9]
  v_pk_add_f32 v[214:215], v[214:215], v[10:11]
  v_cvt_pk_bf16_f32 v212, v212, v213
  v_cvt_pk_bf16_f32 v213, v214, v215
  buffer_store_dwordx2 v[212:213], v3, s[20:23], s15 offen offset:96
  v_lshlrev_b32 v12, 16, v106
  v_and_b32 v13, s101, v106
  v_lshlrev_b32 v14, 16, v107
  v_and_b32 v15, s101, v107
  v_pk_add_f32 v[216:217], v[216:217], v[12:13]
  v_pk_add_f32 v[218:219], v[218:219], v[14:15]
  v_cvt_pk_bf16_f32 v216, v216, v217
  v_cvt_pk_bf16_f32 v217, v218, v219
  buffer_store_dwordx2 v[216:217], v3, s[20:23], s97 offen offset:96
  v_lshlrev_b32 v16, 16, v108
  v_and_b32 v17, s101, v108
  v_lshlrev_b32 v18, 16, v109
  v_and_b32 v19, s101, v109
  v_pk_add_f32 v[220:221], v[220:221], v[16:17]
  v_pk_add_f32 v[222:223], v[222:223], v[18:19]
  v_cvt_pk_bf16_f32 v220, v220, v221
  v_cvt_pk_bf16_f32 v221, v222, v223
  buffer_store_dwordx2 v[220:221], v3, s[20:23], s98 offen offset:96
  v_lshlrev_b32 v20, 16, v110
  v_and_b32 v21, s101, v110
  v_lshlrev_b32 v22, 16, v111
  v_and_b32 v23, s101, v111
  v_pk_add_f32 v[224:225], v[224:225], v[20:21]
  v_pk_add_f32 v[226:227], v[226:227], v[22:23]
  v_cvt_pk_bf16_f32 v224, v224, v225
  v_cvt_pk_bf16_f32 v225, v226, v227
  buffer_store_dwordx2 v[224:225], v3, s[20:23], s99 offen offset:96
  v_lshlrev_b32 v8, 16, v240
  v_and_b32 v9, s101, v240
  v_lshlrev_b32 v10, 16, v241
  v_and_b32 v11, s101, v241
  v_pk_add_f32 v[228:229], v[228:229], v[8:9]
  v_pk_add_f32 v[230:231], v[230:231], v[10:11]
  v_cvt_pk_bf16_f32 v228, v228, v229
  v_cvt_pk_bf16_f32 v229, v230, v231
  buffer_store_dwordx2 v[228:229], v3, s[20:23], s15 offen offset:128
  v_lshlrev_b32 v12, 16, v242
  v_and_b32 v13, s101, v242
  v_lshlrev_b32 v14, 16, v243
  v_and_b32 v15, s101, v243
  v_pk_add_f32 v[232:233], v[232:233], v[12:13]
  v_pk_add_f32 v[234:235], v[234:235], v[14:15]
  v_cvt_pk_bf16_f32 v232, v232, v233
  v_cvt_pk_bf16_f32 v233, v234, v235
  buffer_store_dwordx2 v[232:233], v3, s[20:23], s97 offen offset:128
  v_lshlrev_b32 v16, 16, v244
  v_and_b32 v17, s101, v244
  v_lshlrev_b32 v18, 16, v245
  v_and_b32 v19, s101, v245
  v_pk_add_f32 v[236:237], v[236:237], v[16:17]
  v_pk_add_f32 v[238:239], v[238:239], v[18:19]
  v_cvt_pk_bf16_f32 v236, v236, v237
  v_cvt_pk_bf16_f32 v237, v238, v239
  buffer_store_dwordx2 v[236:237], v3, s[20:23], s98 offen offset:128
  v_lshlrev_b32 v20, 16, v246
  v_and_b32 v21, s101, v246
  v_lshlrev_b32 v22, 16, v247
  v_and_b32 v23, s101, v247
  v_pk_add_f32 v[248:249], v[248:249], v[20:21]
  v_pk_add_f32 v[250:251], v[250:251], v[22:23]
  v_cvt_pk_bf16_f32 v248, v248, v249
  v_cvt_pk_bf16_f32 v249, v250, v251
  buffer_store_dwordx2 v[248:249], v3, s[20:23], s99 offen offset:128
  s_branch K3_ST
K3_AL:
  buffer_load_dwordx4 v[80:83], v2, s[36:39], s14 offen offset:0 sc1
  buffer_load_dwordx4 v[84:87], v2, s[36:39], s14 offen offset:1024 sc1
  buffer_load_dwordx4 v[88:91], v2, s[36:39], s14 offen offset:2048 sc1
  buffer_load_dwordx4 v[92:95], v2, s[36:39], s14 offen offset:3072 sc1
  buffer_load_dwordx4 v[96:99], v2, s[36:39], s98 offen offset:0 sc1
  buffer_load_dwordx4 v[100:103], v2, s[36:39], s98 offen offset:1024 sc1
  buffer_load_dwordx4 v[104:107], v2, s[36:39], s98 offen offset:2048 sc1
  buffer_load_dwordx4 v[108:111], v2, s[36:39], s98 offen offset:3072 sc1
  buffer_load_dwordx4 v[240:243], v2, s[36:39], s99 offen offset:0 sc1
  buffer_load_dwordx4 v[244:247], v2, s[36:39], s99 offen offset:1024 sc1
  s_barrier
  s_mov_b32 s100, 0
  s_cmp_lt_u32 s89, 524288
  s_cselect_b32 s51, 240, 32
K3_JS:
  s_waitcnt vmcnt(9)
  v_max_u32 v6, v80, v81
  v_max3_u32 v6, v82, v83, v6
  s_waitcnt vmcnt(8)
  v_max3_u32 v6, v84, v85, v6
  v_max3_u32 v6, v86, v87, v6
  s_waitcnt vmcnt(7)
  v_max3_u32 v6, v88, v89, v6
  v_max3_u32 v6, v90, v91, v6
  s_waitcnt vmcnt(6)
  v_max3_u32 v6, v92, v93, v6
  v_max3_u32 v6, v94, v95, v6
  s_waitcnt vmcnt(5)
  v_max3_u32 v6, v96, v97, v6
  v_max3_u32 v6, v98, v99, v6
  s_waitcnt vmcnt(4)
  v_max3_u32 v6, v100, v101, v6
  v_max3_u32 v6, v102, v103, v6
  s_waitcnt vmcnt(3)
  v_max3_u32 v6, v104, v105, v6
  v_max3_u32 v6, v106, v107, v6
  s_waitcnt vmcnt(2)
  v_max3_u32 v6, v108, v109, v6
  v_max3_u32 v6, v110, v111, v6
  s_waitcnt vmcnt(1)
  v_max3_u32 v6, v240, v241, v6
  v_max3_u32 v6, v242, v243, v6
  s_waitcnt vmcnt(0)
  v_max3_u32 v6, v244, v245, v6
  v_max3_u32 v6, v246, v247, v6
  v_cmp_eq_u32 vcc, -1, v6
  s_nop 0
  s_cbranch_vccz K3_JR
  s_sleep 1
  buffer_load_dwordx4 v[80:83], v2, s[36:39], s14 offen offset:0 sc1
  buffer_load_dwordx4 v[84:87], v2, s[36:39], s14 offen offset:1024 sc1
  buffer_load_dwordx4 v[88:91], v2, s[36:39], s14 offen offset:2048 sc1
  buffer_load_dwordx4 v[92:95], v2, s[36:39], s14 offen offset:3072 sc1
  buffer_load_dwordx4 v[96:99], v2, s[36:39], s98 offen offset:0 sc1
  buffer_load_dwordx4 v[100:103], v2, s[36:39], s98 offen offset:1024 sc1
  buffer_load_dwordx4 v[104:107], v2, s[36:39], s98 offen offset:2048 sc1
  buffer_load_dwordx4 v[108:111], v2, s[36:39], s98 offen offset:3072 sc1
  buffer_load_dwordx4 v[240:243], v2, s[36:39], s99 offen offset:0 sc1
  buffer_load_dwordx4 v[244:247], v2, s[36:39], s99 offen offset:1024 sc1
  s_sub_u32 s51, s51, 1
  s_cbranch_scc0 K3_JS
  s_and_b32 s50, s89, 255
  s_branch K3_ST
K3_BAIL:
  s_ff1_i32_b64 s51, vcc
  v_readlane_b32 s50, v253, s51
  s_branch K2_BAIL
K3_LATE:
  buffer_load_dword v253, v252, s[36:39], 0 offen sc1
  s_waitcnt vmcnt(1)
  s_barrier
  s_mov_b32 s51, 24
K3_QS:
  s_waitcnt vmcnt(0)
  v_cmp_gt_u32 vcc, s48, v253
  s_nop 0
  s_cbranch_vccz K3_BR
  buffer_load_dword v253, v252, s[36:39], 0 offen sc1
  s_sub_u32 s51, s51, 1
  s_cbranch_scc0 K3_QS
K3_SPB:
  s_cmp_lt_u32 s89, 524288
  s_cselect_b32 s51, 0, 52
  s_branch K3_BPOLL
K3_BSPIN:
  s_cmp_ge_u32 s51, 60
  s_cbranch_scc1 K3_BDO
  s_sleep 4
  s_add_u32 s51, s51, 1
K3_BPOLL:
  buffer_load_ubyte v255, v254, s[28:31], 0 offen sc1
  s_waitcnt vmcnt(0)
  v_and_b32 v6, 8, v255
  v_and_b32 v255, 1, v255
  v_cmp_ne_u32 s[18:19], 1, v255
  buffer_load_dword v253, v252, s[36:39], 0 offen sc1
  s_waitcnt vmcnt(0)
  v_cmp_gt_u32 vcc, s48, v253
  s_nop 0
  s_or_b64 vcc, vcc, s[18:19]
  v_cmp_eq_u32 s[18:19], 0, v6
  s_nop 0
  s_and_b64 vcc, vcc, s[18:19]
  s_cbranch_scc1 K3_BSPIN
K3_BR:
  buffer_load_dwordx4 v[64:67], v2, s[36:39], s24 offen offset:0 sc1
  buffer_load_dwordx4 v[68:71], v2, s[36:39], s24 offen offset:1024 sc1
  buffer_load_dwordx4 v[72:75], v2, s[36:39], s24 offen offset:2048 sc1
  buffer_load_dwordx4 v[76:79], v2, s[36:39], s24 offen offset:3072 sc1
  s_add_u32 s24, s24, 4096
  s_cmp_eq_u32 s24, s9
  s_cselect_b32 s24, s10, s24
  buffer_load_dwordx4 v[32:35], v2, s[36:39], s27 offen offset:0 sc1
  buffer_load_dwordx4 v[36:39], v2, s[36:39], s27 offen offset:1024 sc1
  buffer_load_dwordx4 v[40:43], v2, s[36:39], s27 offen offset:2048 sc1
  buffer_load_dwordx4 v[44:47], v2, s[36:39], s27 offen offset:3072 sc1
  s_add_u32 s27, s24, s8
  buffer_load_dwordx4 v[52:55], v2, s[36:39], s24 offen offset:0 sc1
  buffer_load_dwordx4 v[56:59], v2, s[36:39], s24 offen offset:1024 sc1
  buffer_load_dwordx4 v[60:63], v2, s[36:39], s24 offen offset:2048 sc1
  s_branch K3_GO
K3_BDO:
  s_ff1_i32_b64 s51, vcc
  v_readlane_b32 s51, v254, s51
  s_nop 0
  s_bfe_u32 s50, s51, 0x20004
  s_and_b32 s18, s51, 7
  s_lshl3_add_u32 s50, s50, s18
  s_bfe_u32 s18, s51, 0x20006
  s_lshl2_add_u32 s50, s50, s18
  s_bfe_u32 s18, s51, 0x10003
  s_lshl1_add_u32 s50, s50, s18
  s_or_b32 s50, s50, 256
  s_branch K3_BR
K3_FOR:
  s_waitcnt vmcnt(0)
  s_barrier
  s_cmp_eq_u32 s3, 0
  s_cbranch_scc0 K3_FOR1
  s_lshl_b32 s51, s16, 3
  s_lshl_b32 s51, 14, s51
  v_mov_b32 v6, s51
  s_and_b32 s51, s16, 0xfc
  s_mov_b64 exec, 1
  buffer_atomic_or v6, off, s[28:31], s51 sc1
  s_mov_b64 exec, -1
K3_FOR1:
  s_and_b32 s50, s89, 255
  s_branch K2_BAIL
K3_HX:
  s_waitcnt vmcnt(0) lgkmcnt(0)
  s_barrier
  s_mov_b32 s49, s2
  s_branch K3_RE2
K3_RE:
  s_xor_b32 s49, s2, 2
K3_RE2:
  s_mov_b32 s50, -1
  s_andn2_b32 s97, 1, s49
  s_bfe_u32 s98, s49, 65538
  s_lshl1_add_u32 s97, s97, s98
  s_bfe_u32 s98, s49, 0x20003
  s_lshl2_add_u32 s97, s97, s98
  s_lshr_b32 s98, s49, 5
  s_bfe_u32 s96, s49, 0x10001
  s_lshl1_add_u32 s99, s97, s96
  s_mul_i32 s15, s99, 163840
  s_mul_i32 s8, s98, 160
  s_add_u32 s15, s15, s8
  s_xor_b32 s99, s99, 1
  s_mul_i32 s10, s99, 606208
  s_add_u32 s10, s10, 50331648
  s_mul_i32 s12, s98, 757760
  s_add_u32 s12, s12, 71303168
  s_mul_i32 s8, s96, 1212416
  s_sub_u32 s8, s8, 606208
  s_lshr_b32 s48, s97, 3
  s_add_u32 s48, s48, 4
  s_mul_i32 s13, s49, 24576
  s_xor_b32 s14, s49, 2
  s_mul_i32 s14, s14, 24576
  s_add_u32 s13, s13, 117440512
  s_add_u32 s14, s14, 117440512
  s_xor_b32 s98, s97, 15
  s_min_u32 s97, s97, s98
  s_and_b32 s98, s97, 6
  s_and_b32 s97, s97, 1
  s_lshl1_add_u32 s97, s98, s97
  s_lshl_b32 s97, s97, 2
  s_lshl_b32 s98, s96, 7
  s_or_b32 s97, s97, s98
  s_mul_i32 s98, s3, 9
  s_sub_u32 s98, s98, 8
  s_cmp_lt_u32 s3, 2
  s_cselect_b32 s98, 0, s98
  s_cselect_b64 s[34:35], -1, 0
  s_cselect_b32 s99, 9, 8
  v_lshrrev_b32 v254, 2, v2
  v_min_u32 v254, s99, v254
  v_add_u32 v252, s98, v254
  v_bfe_u32 v254, v252, 2, 2
  v_or_b32 v254, s97, v254
  v_bfe_u32 v253, v252, 4, 1
  v_lshl_or_b32 v254, v253, 6, v254
  v_bfe_u32 v253, v252, 5, 1
  v_lshl_or_b32 v254, v253, 3, v254
  v_xor_b32 v254, 8, v254
  v_lshlrev_b32 v252, 8, v254
  v_add_u32 v252, 93323264, v252
  s_and_b32 s97, s98, 31
  s_and_b32 s99, s97, 16
  s_add_u32 s99, s99, s97
  s_andn2_b32 s97, 32, s98
  s_lshr_b32 s97, s97, 1
  s_or_b32 s99, s99, s97
  s_add_u32 s98, s98, 16
  s_and_b32 s100, s98, 16
  s_lshl_b32 s100, s100, 1
  s_andn2_b32 s97, 32, s98
  s_lshr_b32 s97, s97, 1
  s_or_b32 s100, s100, s97
  s_lshl_b32 s97, s96, 6
  s_add_u32 s99, s99, s97
  s_add_u32 s100, s100, s97
  s_or_b32 s98, s99, 15
  s_add_u32 s98, s98, 1
  s_mul_i32 s96, s96, 10
  s_add_u32 s96, s96, 128
  s_cmp_eq_u32 s3, 0
  s_cselect_b32 s99, s96, s99
  s_cselect_b32 s98, 0, s98
  s_cselect_b32 s48, 0, s48
  s_lshl_b32 s24, s99, 12
  s_lshl_b32 s9, s98, 12
  s_lshl_b32 s96, s100, 12
  s_add_u32 s24, s24, s10
  s_add_u32 s9, s9, s10
  s_add_u32 s10, s10, s96
  s_add_u32 s27, s24, s8
  s_mul_i32 s25, s99, 5120
  s_mul_i32 s11, s98, 5120
  s_mul_i32 s96, s100, 5120
  s_add_u32 s25, s25, s12
  s_add_u32 s11, s11, s12
  s_add_u32 s12, s12, s96
  s_add_u32 s26, s25, 4096
  s_mov_b64 s[18:19], 0
  s_mov_b32 s86, 0
  s_mov_b32 s22, 5242880
  s_mov_b32 s23, 0x00020000
  s_load_dwordx2 s[20:21], s[0:1], 80
  s_xor_b32 s86, s49, s2
K3_RA:
  s_cmp_lt_u32 s89, 524288
  s_cselect_b32 s51, 120, 16
K3_RAL:
  v_lshrrev_b32 v253, 2, v2
  buffer_load_dword v255, v253, s[28:31], 0 offen sc1
  s_waitcnt vmcnt(0)
  v_lshl_or_b32 v255, v255, 1, v255
  v_and_b32 v253, 0x10101010, v255
  v_cmp_ne_u32 vcc, 0x10101010, v253
  s_nop 0
  s_cbranch_vccz K3_RR
  s_sleep 4
  s_sub_u32 s51, s51, 1
  s_cbranch_scc0 K3_RAL
  v_xor_b32 v253, 0x10101010, v253
  v_ffbl_b32 v253, v253
  v_lshrrev_b32 v255, 2, v2
  v_bfe_u32 v253, v253, 3, 2
  v_or_b32 v253, v253, v255
  s_ff1_i32_b64 s51, vcc
  v_readlane_b32 s51, v253, s51
  s_nop 0
  s_bfe_u32 s50, s51, 0x20004
  s_and_b32 s18, s51, 7
  s_lshl3_add_u32 s50, s50, s18
  s_bfe_u32 s18, s51, 0x20006
  s_lshl2_add_u32 s50, s50, s18
  s_bfe_u32 s18, s51, 0x10003
  s_lshl1_add_u32 s50, s50, s18
  s_or_b32 s50, s50, 256
  s_mov_b64 s[18:19], 0
  s_branch K3_RR
K3_RR:
  buffer_load_dwordx4 v[80:83], v2, s[36:39], s25 offen offset:0 sc1
  buffer_load_dwordx4 v[84:87], v2, s[36:39], s25 offen offset:1024 sc1
  buffer_load_dwordx4 v[88:91], v2, s[36:39], s25 offen offset:2048 sc1
  buffer_load_dwordx4 v[92:95], v2, s[36:39], s25 offen offset:3072 sc1
  buffer_load_dwordx4 v[96:99], v2, s[36:39], s26 offen offset:0 sc1
  s_add_u32 s25, s25, 5120
  s_cmp_eq_u32 s25, s11
  s_cselect_b32 s25, s12, s25
  s_add_u32 s26, s25, 4096
  buffer_load_dwordx4 v[100:103], v2, s[36:39], s25 offen offset:0 sc1
  buffer_load_dwordx4 v[104:107], v2, s[36:39], s25 offen offset:1024 sc1
  buffer_load_dwordx4 v[108:111], v2, s[36:39], s25 offen offset:2048 sc1
  buffer_load_dwordx4 v[240:243], v2, s[36:39], s25 offen offset:3072 sc1
  buffer_load_dwordx4 v[244:247], v2, s[36:39], s26 offen offset:0 sc1
  s_add_u32 s25, s25, 5120
  s_cmp_eq_u32 s25, s11
  s_cselect_b32 s25, s12, s25
  s_add_u32 s26, s25, 4096
  s_mov_b32 s49, 1
  s_cmp_eq_u32 s3, 0
  s_cbranch_scc1 K3_BR
  s_branch K3_SPB
K1_ESLOW:
  s_cmp_lt_u32 s89, 524288
  s_cselect_b32 s65, 0, 52
  s_branch K1_EPOLL
K1_ESPIN:
  s_cmp_ge_u32 s65, 60
  s_cbranch_scc1 K1_EDO
  s_sleep 4
  s_add_u32 s65, s65, 1
K1_EPOLL:
  buffer_load_ubyte v92, v89, s[28:31], 0 offen sc1
  s_waitcnt vmcnt(0)
  v_and_b32 v87, 2, v92
  v_and_b32 v92, 1, v92
  v_cmp_ne_u32 s[18:19], 1, v92
  buffer_load_dword v90, v93, s[36:39], 0 offen sc1
  s_waitcnt vmcnt(0)
  v_cmp_eq_u32 vcc, 0, v90
  s_nop 0
  s_or_b64 vcc, vcc, s[18:19]
  v_cmp_eq_u32 s[18:19], 0, v87
  s_nop 0
  s_and_b64 vcc, vcc, s[18:19]
  s_cbranch_scc1 K1_ESPIN
K1_ERET:
  s_cmp_eq_u32 s6, 0
  s_cbranch_scc1 K1_LOOPK_EC
  s_branch K1_LOOPV_EC
K1_EDO:
  s_add_u32 s89, s89, 1048576
  s_cmp_ge_u32 s89, 4194304000
  s_cbranch_scc1 K1_ERET
  s_ff1_i32_b64 s82, vcc
  v_readlane_b32 s66, v89, s82
  s_nop 0
  s_and_b32 s66, s66, 255
  s_lshr_b32 s67, s66, 4
  s_and_b32 s81, s66, 15
  s_mov_b32 s82, 0
K1_ELOOP:
  s_and_b32 s64, s67, 3
  s_mul_i32 s64, s64, 10
  s_add_u32 s64, s64, s82
  s_lshr_b32 s61, s67, 2
  s_lshl2_add_u32 s61, s81, s61
  s_mul_i32 s61, s61, 40960
  s_and_b32 s59, s64, 1
  s_mul_i32 s59, s59, 20448
  s_add_u32 s59, s59, s61
  s_lshl_b32 s64, s64, 5
  s_add_u32 s59, s59, s64
  s_lshl_b32 s64, s64, 5
  s_add_u32 s61, s61, s64
  s_mul_i32 s64, s81, 10
  s_add_u32 s64, s64, s82
  s_mul_i32 s62, s64, 15360
  s_mul_i32 s63, s67, 80
  s_add_u32 s62, s62, s63
  s_lshl1_add_u32 s63, s63, s64
  s_lshl_b32 s63, s63, 10
  s_add_u32 s63, s63, 88080384
  s_lshl_b32 s64, s64, 6
  s_and_b32 s64, s64, 128
  v_xor_b32 v87, s64, v2
  buffer_load_dwordx4 v[72:75], v84, s[68:71], s59 offen
  buffer_load_dwordx4 v[76:79], v85, s[72:75], s62 offen
  s_waitcnt vmcnt(1)
  buffer_store_dwordx4 v[72:75], v2, s[36:39], s61 offen sc1
  s_waitcnt vmcnt(1)
  buffer_store_dwordx4 v[76:79], v87, s[36:39], s63 offen sc1
  s_add_u32 s82, s82, 1
  s_cmp_lt_u32 s82, 10
  s_cbranch_scc1 K1_ELOOP
  s_waitcnt vmcnt(0)
  s_lshl_b32 s82, s66, 3
  s_lshl_b32 s82, 2, s82
  v_mov_b32 v87, s82
  s_and_b32 s82, s66, 0xfc
  s_mov_b64 exec, 1
  buffer_atomic_or v87, off, s[28:31], s82 sc1
  s_mov_b64 exec, -1
  s_waitcnt vmcnt(0)
  s_branch K1_EPOLL
K1_END:
K3_END:
  s_endpgm
.section .rodata,"a"
.p2align 6
.amdhsa_kernel k1_kernel
  .amdhsa_next_free_vgpr 256
  .amdhsa_next_free_sgpr 102
  .amdhsa_accum_offset 256
  .amdhsa_group_segment_fixed_size 0
  .amdhsa_kernarg_size 104
  .amdhsa_user_sgpr_count 2
  .amdhsa_user_sgpr_kernarg_segment_ptr 1
  .amdhsa_system_sgpr_workgroup_id_x 1
  .amdhsa_float_denorm_mode_32 3
.end_amdhsa_kernel
```
